```python
import torch

def _softmax(x, axis=-1):
    return torch.softmax(x, dim=axis)
def _gelu(x):
    return torch.nn.functional.gelu(x, approximate="tanh")
def _silu(x):
    return torch.nn.functional.silu(x)
def _sigmoid(x):
    return torch.sigmoid(x)
def _layernorm(x, axis=-1, eps=1e-5):
    m = x.mean(dim=axis, keepdim=True)
    v = x.var(dim=axis, keepdim=True, unbiased=False)
    return (x - m) / torch.sqrt(v + eps)
def _scatter_add(tgt, idx, src, axis=0):
    return tgt.clone().index_add_(axis, idx, src)
def _segment_sum(src, seg, n):
    out = torch.zeros((n,) + src.shape[1:], dtype=src.dtype)
    return out.index_add_(0, seg, src)
def _pad(x, pw):
    flat = tuple(v for pair in reversed(pw) for v in pair)
    return torch.nn.functional.pad(x, flat)

kernel_name = 'gated_mix__compressed_kv_cla__moe_arch_mod__prompt'

def setup_inputs():

    _w = (lambda a: (lambda t: t.to(torch.bfloat16) if t.is_floating_point() else t)(torch.as_tensor(a)))
    def _A_setup():
        B, H, Sq, Sk, D, M = 1, 32, 2048, 2048, 128, 512
        Dc = 4 * D
        return {
            "x": _w((lambda *s: torch.randn(*s, dtype=torch.bfloat16) * 0.05)(B, Sq, M)),
            "c_kv": _w((lambda *s: torch.randn(*s, dtype=torch.bfloat16) * 0.8)(B, Sk, Dc)),
            "w_q": _w((lambda *s: torch.randn(*s, dtype=torch.bfloat16) * 6.4)(M, H, D) * (M ** -0.5)),
            "w_uk": _w((lambda *s: torch.randn(*s, dtype=torch.bfloat16) * 6.4)(Dc, H, D) * (Dc ** -0.5)),
            "w_uv": _w((lambda *s: torch.randn(*s, dtype=torch.bfloat16) * 0.8)(Dc, H, D) * (Dc ** -0.5)),
            "w_o": _w((lambda *s: torch.randn(*s, dtype=torch.bfloat16) * 0.8)(H, D, M) * ((H * D) ** -0.5)),
        }
    _A_in = _A_setup()

    def _B_setup():
        B, S, D, F, C = 1, 2048, 512, 1792, 2
        return {
            "x": _w((lambda *s: torch.randn(*s, dtype=torch.bfloat16) * 0.05)(B, S, D)),
            "w_r": _w((lambda *s: torch.randn(*s, dtype=torch.bfloat16) * 3.2)(D)),
            "w_gate": _w((lambda *s: torch.randn(*s, dtype=torch.bfloat16) * 0.2)(D, F)),
            "w_up": _w((lambda *s: torch.randn(*s, dtype=torch.bfloat16) * 0.2)(D, F)),
            "w_down": _w((lambda *s: torch.randn(*s, dtype=torch.bfloat16) * 0.2)(F, D)),
        }
    _B_in = _B_setup()

    return {
        "A_x": _A_in["x"],
        "A_c_kv": _A_in["c_kv"],
        "A_w_q": _A_in["w_q"],
        "A_w_uk": _A_in["w_uk"],
        "A_w_uv": _A_in["w_uv"],
        "A_w_o": _A_in["w_o"],
        "B_x": _B_in["x"],
        "B_w_r": _B_in["w_r"],
        "B_w_gate": _B_in["w_gate"],
        "B_w_up": _B_in["w_up"],
        "B_w_down": _B_in["w_down"],
        "gate_w": _w((lambda *s: torch.randn(*s, dtype=torch.bfloat16) * 0.05)(512) * 16.0),
    }

def reference(A_x, A_c_kv, A_w_q, A_w_uk, A_w_uv, A_w_o, B_x, B_w_r, B_w_gate, B_w_up, B_w_down, gate_w):
    def _A_ref(x, c_kv, w_q, w_uk, w_uv, w_o):
        B, Sq, M = x.shape[0], x.shape[1], x.shape[2]
        Sk = c_kv.shape[1]
        H, D = w_q.shape[1], w_q.shape[2]
        q = torch.einsum("bqm,mhd->bhqd", x, w_q)
        k = torch.einsum("bkc,chd->bhkd", c_kv, w_uk)
        v = torch.einsum("bkc,chd->bhkd", c_kv, w_uv)
        scores = torch.einsum("bhqd,bhkd->bhqk", q, k) * (D ** -0.5)
        off = Sk - Sq
        qi = torch.arange(Sq)[:, None]
        kj = torch.arange(Sk)[None, :]
        cmask = kj <= (qi + off)
        scores = torch.where(cmask[None, None], scores, -1e9)
        p = _softmax(scores, axis=-1)
        ctx = torch.einsum("bhqk,bhkd->bhqd", p, v)
        return torch.einsum("bhqd,hdm->bqm", ctx, w_o)

    def _B_ref(x, w_r, w_gate, w_up, w_down):
        B, S, D = x.shape
        C = 2
        r = x @ w_r
        idx = torch.argsort(-r, axis=-1)[:, :C]
        idx_e = (lambda x, n, axis: torch.repeat_interleave(x, n, dim=axis))(idx.reshape(B, C, 1), D, axis=2)
        x_sel = (lambda x, i, axis: torch.take_along_dim(x, i, dim=axis))(x, idx_e, axis=1)
        g = _silu(x_sel @ w_gate)
        u = x_sel @ w_up
        y = (g * u) @ w_down
        r_sel = _sigmoid((lambda x, i, axis: torch.take_along_dim(x, i, dim=axis))(r, idx, axis=1))
        y = y * r_sel.reshape(B, C, 1)
        b_off = (torch.arange(B) * S).reshape(B, 1)
        flat_idx = (idx + b_off).reshape(B * C)
        zero = (x * 0.0).reshape(B * S, D)
        upd = _scatter_add(zero, flat_idx, y.reshape(B * C, D), axis=0)
        return x + upd.reshape(B, S, D)

    x = A_x
    g = _sigmoid((x * gate_w).sum(-1, keepdims=True))
    a = _A_ref(x, A_c_kv, A_w_q, A_w_uk, A_w_uv, A_w_o)
    b = _B_ref(x, B_w_r, B_w_gate, B_w_up, B_w_down)
    return g * a + (1 - g) * b
```

```asm
; @launch grid=(256,1,1) block=(256,1,1) lds=163840
.amdgcn_target "amdgcn-amd-amdhsa--gfx950"
.text
.p2align 8
.globl gated_mix__compressed_kv_cla__moe_arch_mod__prompt_kernel
.type gated_mix__compressed_kv_cla__moe_arch_mod__prompt_kernel,@function
gated_mix__compressed_kv_cla__moe_arch_mod__prompt_kernel:
s_cmp_ge_u32 s2, 256
s_cbranch_scc1 L_end_KN
s_load_dwordx2 s[24:25], s[0:1], 8
s_load_dwordx2 s[28:29], s[0:1], 24
s_load_dwordx2 s[20:21], s[0:1], 0
s_load_dwordx2 s[32:33], s[0:1], 32
s_load_dwordx2 s[48:49], s[0:1], 56
s_load_dwordx2 s[52:53], s[0:1], 88
s_load_dwordx2 s[36:37], s[0:1], 112
s_load_dwordx2 s[4:5], s[0:1], 104
s_load_dwordx2 s[12:13], s[0:1], 16
s_getpc_b64 s[62:63]
L_pc_KN:
v_lshrrev_b32 v1, 6, v0
v_and_b32 v2, 7, v0
v_lshl_or_b32 v1, v1, 3, v2
s_lshr_b32 s44, s2, 3
s_lshl_b32 s44, s44, 11
v_lshl_add_u32 v1, v1, 6, s44
v_min_u32 v1, L_last_KN-L_pc_KN-4, v1
global_load_dword v30, v1, s[62:63]
v_lshrrev_b32 v1, 6, v0
v_and_b32 v0, 63, v0
v_readfirstlane_b32 s42, v1
s_and_b32 s40, s2, 7
s_lshl_b32 s40, s40, 2
s_bfe_u32 s41, s2, 0x20003
s_or_b32 s40, s40, s41
s_lshr_b32 s41, s2, 5
v_lshrrev_b32 v22, 4, v0
v_and_b32 v23, 15, v0
s_lshl_b32 s43, s42, 13
s_and_b32 s44, s42, 1
s_lshl_b32 s44, s44, 3
v_lshlrev_b32 v24, 1, v22
v_xor_b32 v24, v24, v23
v_xor_b32 v24, s44, v24
v_lshlrev_b32 v16, 13, v22
v_lshl_or_b32 v16, v24, 4, v16
v_lshrrev_b32 v23, 3, v0
v_and_b32 v24, 7, v0
v_xor_b32 v25, v24, v22
v_lshlrev_b32 v19, 10, v23
v_lshl_or_b32 v19, v25, 4, v19
v_xor_b32 v20, 64, v19
v_lshlrev_b32 v21, 4, v0
s_mov_b32 s26, 2097152
s_mov_b32 s27, 0x20000
s_mov_b32 s30, 4194304
s_mov_b32 s31, 0x20000
s_mov_b32 s22, 2097152
s_mov_b32 s23, 0x20000
s_mov_b32 s34, 4194304
s_mov_b32 s35, 0x20000
s_mov_b32 s38, 268435456
s_mov_b32 s39, 0x20000
s_mov_b32 s50, 1024
s_mov_b32 s51, 0x20000
s_mov_b32 s54, 1024
s_mov_b32 s55, 0x20000
s_mov_b32 s6, 256
s_mov_b32 s7, 0x20000
s_lshl_b32 s45, s41, 2
s_add_u32 s45, s45, s42
s_lshl_b32 s46, s45, 16
s_lshl_b32 s47, s40, 8
s_lshl_b32 s56, s42, 16
s_add_u32 s56, s56, s47
s_lshl_b32 s57, s42, 17
s_add_u32 s57, s57, s47
s_lshl_b32 s60, s2, 2
s_add_u32 s60, s60, s42
s_lshl_b32 s61, s60, 11
s_mov_b32 s101, 0
s_and_b32 s101, s101, 7
s_lshl_b32 s101, s101, 7
s_lshr_b32 s66, s2, 3
s_lshl_b32 s66, s66, 2
s_add_u32 s66, s66, s42
s_lshl_b32 s66, s66, 5
s_and_b32 s67, s2, 7
s_add_u32 s66, s66, s67
s_lshl_b32 s66, s66, 10
v_and_b32 v32, 15, v0
v_lshlrev_b32 v32, 6, v32
v_lshl_or_b32 v32, v22, 13, v32
v_lshlrev_b32 v33, 5, v0
s_lshr_b32 s67, s2, 3
s_lshl_b32 s67, s67, 2
s_add_u32 s67, s67, s42
s_lshl_b32 s67, s67, 14
s_mov_b32 s63, 50331648
s_lshl_b32 s58, s40, 19
s_add_u32 s62, s58, 16777216
v_lshlrev_b32 v38, 7, v0
v_lshrrev_b32 v39, 2, v0
v_and_b32 v1, 3, v0
v_lshlrev_b32 v39, 13, v39
v_lshl_or_b32 v39, v1, 6, v39
s_lshl_b32 s19, s45, 17
s_add_u32 s19, s19, s47
s_waitcnt lgkmcnt(0)
s_and_b32 s29, s29, 0xffff
s_and_b32 s25, s25, 0xffff
buffer_load_dword v35, v33, s[24:27], s61 offen
buffer_load_dword v34, v32, s[28:31], s66 offen
s_and_b32 s21, s21, 0xffff
s_and_b32 s33, s33, 0xffff
s_and_b32 s49, s49, 0xffff
s_and_b32 s53, s53, 0xffff
s_and_b32 s37, s37, 0xffff
s_and_b32 s5, s5, 0xffff
s_add_u32 s100, s101, 0
s_and_b32 s100, s100, 1023
s_add_u32 m0, s43, 98304
s_add_u32 s100, s100, s46
buffer_load_dwordx4 v19, s[24:27], s100 offen lds
s_add_u32 m0, s43, 99328
s_add_u32 s100, s100, 8192
buffer_load_dwordx4 v20, s[24:27], s100 offen lds
s_add_u32 m0, s43, 100352
s_add_u32 s100, s100, 8192
buffer_load_dwordx4 v19, s[24:27], s100 offen lds
s_add_u32 m0, s43, 101376
s_add_u32 s100, s100, 8192
buffer_load_dwordx4 v20, s[24:27], s100 offen lds
s_add_u32 m0, s43, 102400
s_add_u32 s100, s100, 8192
buffer_load_dwordx4 v19, s[24:27], s100 offen lds
s_add_u32 m0, s43, 103424
s_add_u32 s100, s100, 8192
buffer_load_dwordx4 v20, s[24:27], s100 offen lds
s_add_u32 m0, s43, 104448
s_add_u32 s100, s100, 8192
buffer_load_dwordx4 v19, s[24:27], s100 offen lds
s_add_u32 m0, s43, 105472
s_add_u32 s100, s100, 8192
buffer_load_dwordx4 v20, s[24:27], s100 offen lds
s_add_u32 s18, s101, 0
s_and_b32 s18, s18, 1023
s_lshl_b32 s18, s18, 12
s_add_u32 s18, s18, s56
s_add_u32 m0, s43, 0
s_nop 0
buffer_load_dwordx4 v16, s[28:31], s18 offen lds
s_add_u32 m0, s43, 1024
s_add_u32 s18, s18, 32768
buffer_load_dwordx4 v16, s[28:31], s18 offen lds
s_add_u32 s18, s101, 64
s_and_b32 s18, s18, 1023
s_lshl_b32 s18, s18, 12
s_add_u32 s18, s18, s56
s_add_u32 m0, s43, 2048
s_nop 0
buffer_load_dwordx4 v16, s[28:31], s18 offen lds
s_add_u32 m0, s43, 3072
s_add_u32 s18, s18, 32768
buffer_load_dwordx4 v16, s[28:31], s18 offen lds
buffer_load_dwordx4 v[192:195], v21, s[20:23], s61 offen
buffer_load_dwordx4 v[196:199], v21, s[20:23], s61 offen offset:1024
buffer_load_dwordx4 v[200:203], v21, s[48:51], 0 offen
buffer_load_dwordx4 v[204:207], v21, s[52:55], 0 offen
s_add_u32 s100, s101, 128
s_and_b32 s100, s100, 1023
s_add_u32 m0, s43, 131072
s_add_u32 s100, s100, s46
buffer_load_dwordx4 v19, s[24:27], s100 offen lds
s_add_u32 m0, s43, 132096
s_add_u32 s100, s100, 8192
buffer_load_dwordx4 v20, s[24:27], s100 offen lds
s_add_u32 m0, s43, 133120
s_add_u32 s100, s100, 8192
buffer_load_dwordx4 v19, s[24:27], s100 offen lds
s_add_u32 m0, s43, 134144
s_add_u32 s100, s100, 8192
buffer_load_dwordx4 v20, s[24:27], s100 offen lds
s_add_u32 m0, s43, 135168
s_add_u32 s100, s100, 8192
buffer_load_dwordx4 v19, s[24:27], s100 offen lds
s_add_u32 m0, s43, 136192
s_add_u32 s100, s100, 8192
buffer_load_dwordx4 v20, s[24:27], s100 offen lds
s_add_u32 m0, s43, 137216
s_add_u32 s100, s100, 8192
buffer_load_dwordx4 v19, s[24:27], s100 offen lds
s_add_u32 m0, s43, 138240
s_add_u32 s100, s100, 8192
buffer_load_dwordx4 v20, s[24:27], s100 offen lds
s_add_u32 s18, s101, 128
s_and_b32 s18, s18, 1023
s_lshl_b32 s18, s18, 12
s_add_u32 s18, s18, s56
s_add_u32 m0, s43, 4096
s_nop 0
buffer_load_dwordx4 v16, s[28:31], s18 offen lds
s_add_u32 m0, s43, 5120
s_add_u32 s18, s18, 32768
buffer_load_dwordx4 v16, s[28:31], s18 offen lds
s_add_u32 s18, s101, 192
s_and_b32 s18, s18, 1023
s_lshl_b32 s18, s18, 12
s_add_u32 s18, s18, s56
s_add_u32 m0, s43, 6144
s_nop 0
buffer_load_dwordx4 v16, s[28:31], s18 offen lds
s_add_u32 m0, s43, 7168
s_add_u32 s18, s18, 32768
buffer_load_dwordx4 v16, s[28:31], s18 offen lds
s_add_u32 s100, s101, 256
s_and_b32 s100, s100, 1023
s_add_u32 m0, s43, 65536
s_add_u32 s100, s100, s46
buffer_load_dwordx4 v19, s[24:27], s100 offen lds
s_add_u32 m0, s43, 66560
s_add_u32 s100, s100, 8192
buffer_load_dwordx4 v20, s[24:27], s100 offen lds
s_add_u32 m0, s43, 67584
s_add_u32 s100, s100, 8192
buffer_load_dwordx4 v19, s[24:27], s100 offen lds
s_add_u32 m0, s43, 68608
s_add_u32 s100, s100, 8192
buffer_load_dwordx4 v20, s[24:27], s100 offen lds
s_add_u32 m0, s43, 69632
s_add_u32 s100, s100, 8192
buffer_load_dwordx4 v19, s[24:27], s100 offen lds
s_add_u32 m0, s43, 70656
s_add_u32 s100, s100, 8192
buffer_load_dwordx4 v20, s[24:27], s100 offen lds
s_add_u32 m0, s43, 71680
s_add_u32 s100, s100, 8192
buffer_load_dwordx4 v19, s[24:27], s100 offen lds
s_add_u32 m0, s43, 72704
s_add_u32 s100, s100, 8192
buffer_load_dwordx4 v20, s[24:27], s100 offen lds
s_add_u32 s18, s101, 256
s_and_b32 s18, s18, 1023
s_lshl_b32 s18, s18, 12
s_add_u32 s18, s18, s56
s_add_u32 m0, s43, 32768
s_nop 0
buffer_load_dwordx4 v16, s[28:31], s18 offen lds
s_add_u32 m0, s43, 33792
s_add_u32 s18, s18, 32768
buffer_load_dwordx4 v16, s[28:31], s18 offen lds
s_add_u32 s18, s101, 320
s_and_b32 s18, s18, 1023
s_lshl_b32 s18, s18, 12
s_add_u32 s18, s18, s56
s_add_u32 m0, s43, 34816
s_nop 0
buffer_load_dwordx4 v16, s[28:31], s18 offen lds
s_add_u32 m0, s43, 35840
s_add_u32 s18, s18, 32768
buffer_load_dwordx4 v16, s[28:31], s18 offen lds
v_bfe_u32 v23, v0, 2, 2
v_and_b32 v24, 3, v0
v_and_b32 v25, 1, v22
v_lshl_or_b32 v25, v25, 2, v23
v_lshlrev_b32 v2, 13, v22
v_lshl_or_b32 v2, v23, 8, v2
v_lshl_or_b32 v2, v25, 5, v2
v_lshl_or_b32 v2, v24, 3, v2
v_xor_b32 v3, 32, v2
v_xor_b32 v4, 64, v2
v_xor_b32 v5, 96, v2
v_xor_b32 v6, 128, v2
v_xor_b32 v7, 160, v2
v_xor_b32 v8, 192, v2
v_xor_b32 v9, 224, v2
v_lshrrev_b32 v10, 1, v22
v_lshlrev_b32 v10, 13, v10
v_and_b32 v25, 1, v22
v_lshl_or_b32 v10, v25, 10, v10
v_lshl_or_b32 v10, v23, 7, v10
v_lshl_or_b32 v10, v25, 6, v10
v_lshrrev_b32 v25, 1, v23
v_lshl_or_b32 v10, v25, 5, v10
v_lshl_or_b32 v10, v24, 3, v10
v_xor_b32 v11, 32, v10
v_xor_b32 v12, 64, v10
v_xor_b32 v13, 96, v10
v_and_b32 v23, 15, v0
v_lshrrev_b32 v24, 1, v23
v_xor_b32 v24, v24, v22
v_lshlrev_b32 v14, 7, v23
v_lshl_or_b32 v14, v24, 4, v14
v_add_u32 v14, s43, v14
v_add_u32 v14, 0x10000, v14
v_xor_b32 v15, 64, v14
v_add_u32 v26, 0x10000, v14
v_add_u32 v27, 0x10000, v15
v_lshrrev_b32 v23, 3, v0
v_and_b32 v24, 7, v0
v_and_b32 v25, 1, v22
v_lshlrev_b32 v25, 1, v25
v_xor_b32 v25, v25, v24
v_lshlrev_b32 v17, 13, v23
v_lshl_or_b32 v17, v25, 4, v17
v_xor_b32 v18, 64, v17
s_lshl_b32 s58, s40, 6
s_lshl_b32 s63, s45, 1
s_add_u32 s58, s58, s63
s_lshl_b32 s58, s58, 13
s_lshl_b32 s8, s41, 17
s_lshl_b32 s44, s42, 15
s_lshl_b32 s9, s41, 18
s_sub_u32 s9, 1941504, s9
s_add_u32 s8, s8, s44
s_mov_b32 s10, s56
s_lshl_b32 s11, s42, 12
s_cmp_eq_u32 s42, 0
s_cselect_b32 s3, 0, 0x1000
s_cselect_b32 s14, 0, -1
s_and_b32 s44, s40, 24
s_lshl_b32 s15, 1, s44
s_lshr_b32 s63, s41, 1
s_lshr_b32 s16, 255, s63
s_lshl_b32 s16, s16, s44
s_and_b32 s44, s40, 7
s_lshl_b32 s44, s44, 4
v_lshl_add_u32 v28, v0, 8, s44
s_lshl_b32 s44, s15, s41
v_mov_b32 v31, s44
s_lshl_b32 s63, s63, 3
s_lshr_b32 s16, -1, s63
s_not_b32 s16, s16
s_lshl_b32 s15, s40, 10
s_add_u32 s15, s15, 57671680
s_and_b32 s44, s40, 7
s_lshl_b32 s44, s44, 4
v_min_u32 v28, 1, v0
v_lshl_add_u32 v28, v28, 30, s44
s_cmp_eq_u32 s42, 0
s_cselect_b32 s15, s15, 1073741824
s_mov_b32 s63, 0x3e0293ee
s_waitcnt vmcnt(32)
ds_read_b128 a[0:3], v14 offset:32768
ds_read_b128 a[4:7], v14 offset:34816
ds_read_b128 a[8:11], v14 offset:36864
ds_read_b128 a[12:15], v14 offset:38912
ds_read_b128 a[16:19], v15 offset:32768
ds_read_b128 a[20:23], v15 offset:34816
ds_read_b128 a[24:27], v15 offset:36864
ds_read_b128 a[28:31], v15 offset:38912
s_waitcnt lgkmcnt(0)
s_add_u32 s100, s101, 384
s_and_b32 s100, s100, 1023
s_add_u32 m0, s43, 98304
s_add_u32 s100, s100, s46
buffer_load_dwordx4 v19, s[24:27], s100 offen lds
s_add_u32 m0, s43, 99328
s_add_u32 s100, s100, 8192
buffer_load_dwordx4 v20, s[24:27], s100 offen lds
s_add_u32 m0, s43, 100352
s_add_u32 s100, s100, 8192
buffer_load_dwordx4 v19, s[24:27], s100 offen lds
s_add_u32 m0, s43, 101376
s_add_u32 s100, s100, 8192
buffer_load_dwordx4 v20, s[24:27], s100 offen lds
s_add_u32 m0, s43, 102400
s_add_u32 s100, s100, 8192
buffer_load_dwordx4 v19, s[24:27], s100 offen lds
s_add_u32 m0, s43, 103424
s_add_u32 s100, s100, 8192
buffer_load_dwordx4 v20, s[24:27], s100 offen lds
s_add_u32 m0, s43, 104448
s_add_u32 s100, s100, 8192
buffer_load_dwordx4 v19, s[24:27], s100 offen lds
s_add_u32 m0, s43, 105472
s_add_u32 s100, s100, 8192
buffer_load_dwordx4 v20, s[24:27], s100 offen lds
s_waitcnt vmcnt(38)
s_barrier
ds_read_b64_tr_b16 v[40:41], v2 offset:0
ds_read_b64_tr_b16 v[42:43], v2 offset:1024
s_add_u32 s18, s101, 384
s_and_b32 s18, s18, 1023
s_lshl_b32 s18, s18, 12
s_add_u32 s18, s18, s56
s_add_u32 m0, s43, 36864
s_nop 0
buffer_load_dwordx4 v16, s[28:31], s18 offen lds
ds_read_b64_tr_b16 v[44:45], v3 offset:0
ds_read_b64_tr_b16 v[46:47], v3 offset:1024
s_add_u32 m0, s43, 37888
s_add_u32 s18, s18, 32768
buffer_load_dwordx4 v16, s[28:31], s18 offen lds
ds_read_b64_tr_b16 v[48:49], v4 offset:0
ds_read_b64_tr_b16 v[50:51], v4 offset:1024
ds_read_b64_tr_b16 v[52:53], v5 offset:0
ds_read_b64_tr_b16 v[54:55], v5 offset:1024
s_waitcnt lgkmcnt(6)
v_mfma_f32_16x16x32_bf16 v[64:67], v[40:43], a[0:3], 0
ds_read_b64_tr_b16 v[56:57], v6 offset:0
s_waitcnt vmcnt(34)
v_mfma_f32_16x16x32_bf16 v[68:71], v[40:43], a[4:7], 0
ds_read_b64_tr_b16 v[58:59], v6 offset:1024
s_lshl_b32 s67, s60, 1
v_mfma_f32_16x16x32_bf16 v[72:75], v[40:43], a[8:11], 0
s_waitcnt lgkmcnt(4)
s_sub_u32 s67, 2047, s67
s_mov_b32 s65, 0x3f803f80
v_mfma_f32_16x16x32_bf16 v[76:79], v[40:43], a[12:15], 0
v_lshlrev_b32 v208, 16, v204
v_mfma_f32_16x16x32_bf16 v[80:83], v[44:47], a[0:3], 0
ds_read_b64_tr_b16 v[60:61], v7 offset:0
v_and_b32 v209, 0xffff0000, v204
v_mfma_f32_16x16x32_bf16 v[84:87], v[44:47], a[4:7], 0
ds_read_b64_tr_b16 v[62:63], v7 offset:1024
v_lshlrev_b32 v210, 16, v205
v_mfma_f32_16x16x32_bf16 v[88:91], v[44:47], a[8:11], 0
s_waitcnt vmcnt(26)
ds_read_b128 a[32:35], v26 offset:0
v_and_b32 v211, 0xffff0000, v205
v_mfma_f32_16x16x32_bf16 v[92:95], v[44:47], a[12:15], 0
v_lshlrev_b32 v212, 16, v206
v_mfma_f32_16x16x32_bf16 v[96:99], v[48:51], a[0:3], 0
ds_read_b64_tr_b16 v[40:41], v8 offset:0
v_and_b32 v213, 0xffff0000, v206
v_mfma_f32_16x16x32_bf16 v[100:103], v[48:51], a[4:7], 0
ds_read_b64_tr_b16 v[42:43], v8 offset:1024
v_lshlrev_b32 v214, 16, v207
v_mfma_f32_16x16x32_bf16 v[104:107], v[48:51], a[8:11], 0
s_waitcnt lgkmcnt(5)
ds_read_b128 a[36:39], v26 offset:2048
v_and_b32 v215, 0xffff0000, v207
v_mfma_f32_16x16x32_bf16 v[108:111], v[48:51], a[12:15], 0
v_lshlrev_b32 v216, 16, v192
v_mfma_f32_16x16x32_bf16 v[112:115], v[52:55], a[0:3], 0
ds_read_b64_tr_b16 v[44:45], v9 offset:0
v_lshlrev_b32 v218, 16, v196
v_mfma_f32_16x16x32_bf16 v[116:119], v[52:55], a[4:7], 0
ds_read_b64_tr_b16 v[46:47], v9 offset:1024
v_and_b32 v217, 0xffff0000, v192
v_mfma_f32_16x16x32_bf16 v[120:123], v[52:55], a[8:11], 0
ds_read_b128 a[40:43], v26 offset:4096
v_and_b32 v219, 0xffff0000, v196
v_mfma_f32_16x16x32_bf16 v[124:127], v[52:55], a[12:15], 0
s_barrier
v_dot2_f32_bf16 v224, v192, v200, 0
v_mfma_f32_16x16x32_bf16 v[128:131], v[56:59], a[0:3], 0
ds_read_b64_tr_b16 v[48:49], v2 offset:2048
v_dot2_f32_bf16 v226, v196, v200, 0
v_mfma_f32_16x16x32_bf16 v[132:135], v[56:59], a[4:7], 0
ds_read_b64_tr_b16 v[50:51], v2 offset:3072
v_mul_f32 v216, v216, v208
v_mfma_f32_16x16x32_bf16 v[136:139], v[56:59], a[8:11], 0
s_waitcnt lgkmcnt(6)
ds_read_b128 a[44:47], v26 offset:6144
s_add_u32 s18, s101, 448
v_mfma_f32_16x16x32_bf16 v[140:143], v[56:59], a[12:15], 0
s_and_b32 s18, s18, 1023
s_lshl_b32 s18, s18, 12
s_add_u32 s18, s18, s56
v_mfma_f32_16x16x32_bf16 v[144:147], v[60:63], a[0:3], 0
s_add_u32 m0, s43, 38912
ds_read_b64_tr_b16 v[52:53], v3 offset:2048
v_mul_f32 v218, v218, v208
v_mfma_f32_16x16x32_bf16 v[148:151], v[60:63], a[4:7], 0
buffer_load_dwordx4 v16, s[28:31], s18 offen lds
v_mfma_f32_16x16x32_bf16 v[152:155], v[60:63], a[8:11], 0
buffer_load_dword v36, v32, s[32:35], s66 offen
v_mfma_f32_16x16x32_bf16 v[156:159], v[60:63], a[12:15], 0
s_add_u32 m0, s43, 39936
ds_read_b64_tr_b16 v[54:55], v3 offset:3072
ds_read_b128 a[48:51], v27 offset:0
v_mfma_f32_16x16x32_bf16 v[160:163], v[40:43], a[0:3], 0
s_add_u32 s18, s18, 32768
ds_read_b64_tr_b16 v[56:57], v4 offset:2048
v_mul_f32 v217, v217, v209
v_mfma_f32_16x16x32_bf16 v[164:167], v[40:43], a[4:7], 0
buffer_load_dwordx4 v16, s[28:31], s18 offen lds
v_mfma_f32_16x16x32_bf16 v[168:171], v[40:43], a[8:11], 0
s_waitcnt lgkmcnt(5)
ds_read_b64_tr_b16 v[58:59], v4 offset:3072
ds_read_b128 a[52:55], v27 offset:2048
v_mfma_f32_16x16x32_bf16 v[172:175], v[40:43], a[12:15], 0
v_mul_f32 v219, v219, v209
v_cvt_pk_bf16_f32 v216, v216, v217
v_mfma_f32_16x16x32_bf16 v[176:179], v[44:47], a[0:3], 0
ds_read_b64_tr_b16 v[60:61], v5 offset:2048
v_cvt_pk_bf16_f32 v218, v218, v219
v_mfma_f32_16x16x32_bf16 v[180:183], v[44:47], a[4:7], 0
ds_read_b64_tr_b16 v[62:63], v5 offset:3072
v_dot2_f32_bf16 v225, v216, s65, 0
v_mfma_f32_16x16x32_bf16 v[184:187], v[44:47], a[8:11], 0
ds_read_b128 a[56:59], v27 offset:4096
v_dot2_f32_bf16 v227, v218, s65, 0
v_mfma_f32_16x16x32_bf16 v[188:191], v[44:47], a[12:15], 0
v_lshlrev_b32 v220, 16, v193
v_lshlrev_b32 v222, 16, v197
v_mfma_f32_16x16x32_bf16 v[64:67], v[48:51], a[16:19], v[64:67]
ds_read_b64_tr_b16 v[40:41], v6 offset:2048
v_and_b32 v221, 0xffff0000, v193
v_mfma_f32_16x16x32_bf16 v[68:71], v[48:51], a[20:23], v[68:71]
ds_read_b64_tr_b16 v[42:43], v6 offset:3072
v_and_b32 v223, 0xffff0000, v197
v_mfma_f32_16x16x32_bf16 v[72:75], v[48:51], a[24:27], v[72:75]
s_waitcnt lgkmcnt(9)
ds_read_b128 a[60:63], v27 offset:6144
v_dot2_f32_bf16 v224, v193, v201, v224
v_mfma_f32_16x16x32_bf16 v[76:79], v[48:51], a[28:31], v[76:79]
v_dot2_f32_bf16 v226, v197, v201, v226
v_mul_f32 v220, v220, v210
v_mfma_f32_16x16x32_bf16 v[80:83], v[52:55], a[16:19], v[80:83]
ds_read_b64_tr_b16 v[44:45], v7 offset:2048
v_mul_f32 v222, v222, v210
v_mfma_f32_16x16x32_bf16 v[84:87], v[52:55], a[20:23], v[84:87]
ds_read_b64_tr_b16 v[46:47], v7 offset:3072
v_mul_f32 v221, v221, v211
v_mfma_f32_16x16x32_bf16 v[88:91], v[52:55], a[24:27], v[88:91]
s_waitcnt lgkmcnt(6)
v_mul_f32 v223, v223, v211
v_cvt_pk_bf16_f32 v220, v220, v221
v_mfma_f32_16x16x32_bf16 v[92:95], v[52:55], a[28:31], v[92:95]
v_cvt_pk_bf16_f32 v222, v222, v223
v_dot2_f32_bf16 v225, v220, s65, v225
v_mfma_f32_16x16x32_bf16 v[96:99], v[56:59], a[16:19], v[96:99]
ds_read_b64_tr_b16 v[48:49], v8 offset:2048
v_dot2_f32_bf16 v227, v222, s65, v227
v_mfma_f32_16x16x32_bf16 v[100:103], v[56:59], a[20:23], v[100:103]
ds_read_b64_tr_b16 v[50:51], v8 offset:3072
v_lshlrev_b32 v216, 16, v194
v_mfma_f32_16x16x32_bf16 v[104:107], v[56:59], a[24:27], v[104:107]
v_lshlrev_b32 v218, 16, v198
v_and_b32 v217, 0xffff0000, v194
v_mfma_f32_16x16x32_bf16 v[108:111], v[56:59], a[28:31], v[108:111]
v_and_b32 v219, 0xffff0000, v198
v_dot2_f32_bf16 v224, v194, v202, v224
v_mfma_f32_16x16x32_bf16 v[112:115], v[60:63], a[16:19], v[112:115]
ds_read_b64_tr_b16 v[52:53], v9 offset:2048
v_dot2_f32_bf16 v226, v198, v202, v226
v_mfma_f32_16x16x32_bf16 v[116:119], v[60:63], a[20:23], v[116:119]
ds_read_b64_tr_b16 v[54:55], v9 offset:3072
v_mul_f32 v216, v216, v212
v_mfma_f32_16x16x32_bf16 v[120:123], v[60:63], a[24:27], v[120:123]
s_waitcnt lgkmcnt(4)
s_add_u32 s100, s101, 512
s_and_b32 s100, s100, 1023
v_mfma_f32_16x16x32_bf16 v[124:127], v[60:63], a[28:31], v[124:127]
s_add_u32 m0, s43, 131072
s_add_u32 s100, s100, s46
v_mul_f32 v218, v218, v212
v_mfma_f32_16x16x32_bf16 v[128:131], v[40:43], a[16:19], v[128:131]
buffer_load_dwordx4 v19, s[24:27], s100 offen lds
v_mfma_f32_16x16x32_bf16 v[132:135], v[40:43], a[20:23], v[132:135]
s_waitcnt vmcnt(28)
s_barrier
ds_read_b64_tr_b16 v[56:57], v2 offset:4096
v_mfma_f32_16x16x32_bf16 v[136:139], v[40:43], a[24:27], v[136:139]
s_add_u32 m0, s43, 132096
ds_read_b64_tr_b16 v[58:59], v2 offset:5120
s_add_u32 s100, s100, 8192
v_mfma_f32_16x16x32_bf16 v[140:143], v[40:43], a[28:31], v[140:143]
buffer_load_dwordx4 v20, s[24:27], s100 offen lds
v_mfma_f32_16x16x32_bf16 v[144:147], v[44:47], a[16:19], v[144:147]
s_add_u32 s18, s101, 512
ds_read_b64_tr_b16 v[60:61], v3 offset:4096
s_and_b32 s18, s18, 1023
v_mfma_f32_16x16x32_bf16 v[148:151], v[44:47], a[20:23], v[148:151]
s_lshl_b32 s18, s18, 12
ds_read_b64_tr_b16 v[62:63], v3 offset:5120
s_add_u32 s18, s18, s56
v_mfma_f32_16x16x32_bf16 v[152:155], v[44:47], a[24:27], v[152:155]
s_waitcnt lgkmcnt(4)
s_add_u32 m0, s43, 0
s_add_u32 s100, s100, 8192
v_mfma_f32_16x16x32_bf16 v[156:159], v[44:47], a[28:31], v[156:159]
buffer_load_dwordx4 v16, s[28:31], s18 offen lds
v_mfma_f32_16x16x32_bf16 v[160:163], v[48:51], a[16:19], v[160:163]
s_add_u32 m0, s43, 133120
ds_read_b64_tr_b16 v[40:41], v4 offset:4096
s_add_u32 s18, s18, 32768
v_mfma_f32_16x16x32_bf16 v[164:167], v[48:51], a[20:23], v[164:167]
buffer_load_dwordx4 v19, s[24:27], s100 offen lds
v_mfma_f32_16x16x32_bf16 v[168:171], v[48:51], a[24:27], v[168:171]
s_add_u32 m0, s43, 134144
ds_read_b64_tr_b16 v[42:43], v4 offset:5120
s_add_u32 s100, s100, 8192
v_mfma_f32_16x16x32_bf16 v[172:175], v[48:51], a[28:31], v[172:175]
buffer_load_dwordx4 v20, s[24:27], s100 offen lds
v_mfma_f32_16x16x32_bf16 v[176:179], v[52:55], a[16:19], v[176:179]
s_add_u32 m0, s43, 1024
ds_read_b64_tr_b16 v[44:45], v5 offset:4096
s_add_u32 s100, s100, 8192
v_mfma_f32_16x16x32_bf16 v[180:183], v[52:55], a[20:23], v[180:183]
buffer_load_dwordx4 v16, s[28:31], s18 offen lds
v_mfma_f32_16x16x32_bf16 v[184:187], v[52:55], a[24:27], v[184:187]
s_waitcnt lgkmcnt(3)
ds_read_b64_tr_b16 v[46:47], v5 offset:5120
s_add_u32 m0, s43, 135168
v_mfma_f32_16x16x32_bf16 v[188:191], v[52:55], a[28:31], v[188:191]
buffer_load_dwordx4 v19, s[24:27], s100 offen lds
v_mfma_f32_16x16x32_bf16 v[64:67], v[56:59], a[32:35], v[64:67]
s_add_u32 m0, s43, 136192
ds_read_b64_tr_b16 v[48:49], v6 offset:4096
s_add_u32 s100, s100, 8192
v_mfma_f32_16x16x32_bf16 v[68:71], v[56:59], a[36:39], v[68:71]
buffer_load_dwordx4 v20, s[24:27], s100 offen lds
v_mfma_f32_16x16x32_bf16 v[72:75], v[56:59], a[40:43], v[72:75]
s_add_u32 m0, s43, 137216
ds_read_b64_tr_b16 v[50:51], v6 offset:5120
s_add_u32 s100, s100, 8192
v_mfma_f32_16x16x32_bf16 v[76:79], v[56:59], a[44:47], v[76:79]
buffer_load_dwordx4 v19, s[24:27], s100 offen lds
v_mfma_f32_16x16x32_bf16 v[80:83], v[60:63], a[32:35], v[80:83]
s_add_u32 m0, s43, 138240
ds_read_b64_tr_b16 v[52:53], v7 offset:4096
s_add_u32 s100, s100, 8192
v_mfma_f32_16x16x32_bf16 v[84:87], v[60:63], a[36:39], v[84:87]
buffer_load_dwordx4 v20, s[24:27], s100 offen lds
v_mfma_f32_16x16x32_bf16 v[88:91], v[60:63], a[40:43], v[88:91]
s_waitcnt lgkmcnt(5)
ds_read_b64_tr_b16 v[54:55], v7 offset:5120
s_waitcnt vmcnt(27)
v_mfma_f32_16x16x32_bf16 v[92:95], v[60:63], a[44:47], v[92:95]
ds_read_b128 a[64:67], v14 offset:0
v_mul_f32 v217, v217, v213
v_mfma_f32_16x16x32_bf16 v[96:99], v[40:43], a[32:35], v[96:99]
ds_read_b64_tr_b16 v[56:57], v8 offset:4096
v_mul_f32 v219, v219, v213
v_mfma_f32_16x16x32_bf16 v[100:103], v[40:43], a[36:39], v[100:103]
ds_read_b64_tr_b16 v[58:59], v8 offset:5120
v_cvt_pk_bf16_f32 v216, v216, v217
v_mfma_f32_16x16x32_bf16 v[104:107], v[40:43], a[40:43], v[104:107]
s_waitcnt lgkmcnt(7)
ds_read_b128 a[68:71], v14 offset:2048
v_cvt_pk_bf16_f32 v218, v218, v219
v_mfma_f32_16x16x32_bf16 v[108:111], v[40:43], a[44:47], v[108:111]
v_dot2_f32_bf16 v225, v216, s65, v225
v_dot2_f32_bf16 v227, v218, s65, v227
v_mfma_f32_16x16x32_bf16 v[112:115], v[44:47], a[32:35], v[112:115]
ds_read_b64_tr_b16 v[60:61], v9 offset:4096
v_lshlrev_b32 v220, 16, v195
v_mfma_f32_16x16x32_bf16 v[116:119], v[44:47], a[36:39], v[116:119]
ds_read_b64_tr_b16 v[62:63], v9 offset:5120
v_lshlrev_b32 v222, 16, v199
v_mfma_f32_16x16x32_bf16 v[120:123], v[44:47], a[40:43], v[120:123]
s_waitcnt lgkmcnt(8)
ds_read_b128 a[72:75], v14 offset:4096
v_and_b32 v221, 0xffff0000, v195
v_mfma_f32_16x16x32_bf16 v[124:127], v[44:47], a[44:47], v[124:127]
s_barrier
v_and_b32 v223, 0xffff0000, v199
v_dot2_f32_bf16 v224, v195, v203, v224
v_mfma_f32_16x16x32_bf16 v[128:131], v[48:51], a[32:35], v[128:131]
ds_read_b64_tr_b16 v[40:41], v2 offset:6144
v_dot2_f32_bf16 v226, v199, v203, v226
v_mfma_f32_16x16x32_bf16 v[132:135], v[48:51], a[36:39], v[132:135]
ds_read_b64_tr_b16 v[42:43], v2 offset:7168
v_mul_f32 v220, v220, v214
v_mfma_f32_16x16x32_bf16 v[136:139], v[48:51], a[40:43], v[136:139]
s_waitcnt lgkmcnt(6)
ds_read_b128 a[76:79], v14 offset:6144
s_add_u32 s18, s101, 576
v_mfma_f32_16x16x32_bf16 v[140:143], v[48:51], a[44:47], v[140:143]
s_and_b32 s18, s18, 1023
s_lshl_b32 s18, s18, 12
s_add_u32 s18, s18, s56
v_mfma_f32_16x16x32_bf16 v[144:147], v[52:55], a[32:35], v[144:147]
s_add_u32 m0, s43, 2048
ds_read_b64_tr_b16 v[44:45], v3 offset:6144
v_mul_f32 v222, v222, v214
v_mfma_f32_16x16x32_bf16 v[148:151], v[52:55], a[36:39], v[148:151]
buffer_load_dwordx4 v16, s[28:31], s18 offen lds
v_mfma_f32_16x16x32_bf16 v[152:155], v[52:55], a[40:43], v[152:155]
s_add_u32 m0, s43, 3072
ds_read_b64_tr_b16 v[46:47], v3 offset:7168
ds_read_b128 a[80:83], v15 offset:0
v_mfma_f32_16x16x32_bf16 v[156:159], v[52:55], a[44:47], v[156:159]
s_add_u32 s18, s18, 32768
v_mul_f32 v221, v221, v215
v_mul_f32 v223, v223, v215
v_mfma_f32_16x16x32_bf16 v[160:163], v[56:59], a[32:35], v[160:163]
buffer_load_dwordx4 v16, s[28:31], s18 offen lds
v_mfma_f32_16x16x32_bf16 v[164:167], v[56:59], a[36:39], v[164:167]
ds_read_b64_tr_b16 v[48:49], v4 offset:6144
ds_read_b64_tr_b16 v[50:51], v4 offset:7168
v_mfma_f32_16x16x32_bf16 v[168:171], v[56:59], a[40:43], v[168:171]
s_waitcnt lgkmcnt(6)
ds_read_b128 a[84:87], v15 offset:2048
v_cvt_pk_bf16_f32 v220, v220, v221
v_mfma_f32_16x16x32_bf16 v[172:175], v[56:59], a[44:47], v[172:175]
v_cvt_pk_bf16_f32 v222, v222, v223
v_dot2_f32_bf16 v225, v220, s65, v225
v_mfma_f32_16x16x32_bf16 v[176:179], v[60:63], a[32:35], v[176:179]
ds_read_b64_tr_b16 v[52:53], v5 offset:6144
v_dot2_f32_bf16 v227, v222, s65, v227
v_mfma_f32_16x16x32_bf16 v[180:183], v[60:63], a[36:39], v[180:183]
ds_read_b64_tr_b16 v[54:55], v5 offset:7168
v_and_b32 v217, 1, v22
v_mfma_f32_16x16x32_bf16 v[184:187], v[60:63], a[40:43], v[184:187]
ds_read_b128 a[88:91], v15 offset:4096
v_lshrrev_b32 v218, 1, v22
v_mfma_f32_16x16x32_bf16 v[188:191], v[60:63], a[44:47], v[188:191]
v_permlane32_swap_b32 v224, v225
v_permlane32_swap_b32 v226, v227
v_mfma_f32_16x16x32_bf16 v[64:67], v[40:43], a[48:51], v[64:67]
ds_read_b64_tr_b16 v[56:57], v6 offset:6144
v_sub_u32 v219, s67, v217
v_mfma_f32_16x16x32_bf16 v[68:71], v[40:43], a[52:55], v[68:71]
ds_read_b64_tr_b16 v[58:59], v6 offset:7168
v_lshlrev_b32 v217, 2, v217
v_mfma_f32_16x16x32_bf16 v[72:75], v[40:43], a[56:59], v[72:75]
s_waitcnt lgkmcnt(6)
ds_read_b128 a[92:95], v15 offset:6144
v_add_f32 v224, v224, v225
v_mfma_f32_16x16x32_bf16 v[76:79], v[40:43], a[60:63], v[76:79]
v_add_f32 v226, v226, v227
v_lshl_or_b32 v217, v218, 13, v217
v_mfma_f32_16x16x32_bf16 v[80:83], v[44:47], a[48:51], v[80:83]
ds_read_b64_tr_b16 v[60:61], v7 offset:6144
v_cmp_eq_u32 vcc, 0, v218
v_mfma_f32_16x16x32_bf16 v[84:87], v[44:47], a[52:55], v[84:87]
ds_read_b64_tr_b16 v[62:63], v7 offset:7168
v_permlane16_swap_b32 v224, v226
v_mfma_f32_16x16x32_bf16 v[88:91], v[44:47], a[56:59], v[88:91]
v_add_f32 v224, v224, v226
v_mfma_f32_16x16x32_bf16 v[92:95], v[44:47], a[60:63], v[92:95]
v_mfma_f32_16x16x32_bf16 v[96:99], v[48:51], a[48:51], v[96:99]
ds_read_b64_tr_b16 v[40:41], v8 offset:6144
v_add_f32_dpp v224, v224, v224 quad_perm:[1,0,3,2] row_mask:0xf bank_mask:0xf
v_mfma_f32_16x16x32_bf16 v[100:103], v[48:51], a[52:55], v[100:103]
ds_read_b64_tr_b16 v[42:43], v8 offset:7168
v_add_f32_dpp v224, v224, v224 quad_perm:[2,3,0,1] row_mask:0xf bank_mask:0xf
v_mfma_f32_16x16x32_bf16 v[104:107], v[48:51], a[56:59], v[104:107]
s_waitcnt lgkmcnt(5)
v_add_f32_dpp v224, v224, v224 row_half_mirror row_mask:0xf bank_mask:0xf
v_mfma_f32_16x16x32_bf16 v[108:111], v[48:51], a[60:63], v[108:111]
v_mfma_f32_16x16x32_bf16 v[112:115], v[52:55], a[48:51], v[112:115]
ds_read_b64_tr_b16 v[44:45], v9 offset:6144
v_add_f32_dpp v224, v224, v224 row_mirror row_mask:0xf bank_mask:0xf
v_mfma_f32_16x16x32_bf16 v[116:119], v[52:55], a[52:55], v[116:119]
ds_read_b64_tr_b16 v[46:47], v9 offset:7168
v_cvt_pk_bf16_f32 v224, v224, v224
v_mfma_f32_16x16x32_bf16 v[120:123], v[52:55], a[56:59], v[120:123]
s_waitcnt lgkmcnt(6)
v_and_b32 v224, 0xffff0000, v224
v_ashrrev_i32 v225, 31, v224
v_mfma_f32_16x16x32_bf16 v[124:127], v[52:55], a[60:63], v[124:127]
s_lshl_b32 s62, s60, 3
v_mul_f32 v226, 0xbfb8aa3b, v224
v_or_b32 v225, 0x80000000, v225
v_mfma_f32_16x16x32_bf16 v[128:131], v[56:59], a[48:51], v[128:131]
s_add_u32 s62, s62, 50331648
v_xor_b32 v225, v224, v225
v_and_b32 v225, 0xffff0000, v225
v_mfma_f32_16x16x32_bf16 v[132:135], v[56:59], a[52:55], v[132:135]
s_cmp_eq_u32 s41, 0
v_or_b32 v225, v225, v219
v_mov_b64 v[192:193], 0
v_mfma_f32_16x16x32_bf16 v[136:139], v[56:59], a[56:59], v[136:139]
s_waitcnt lgkmcnt(2)
v_mov_b64 v[194:195], 0
s_cselect_b32 s49, s15, 1073741824
v_mfma_f32_16x16x32_bf16 v[140:143], v[56:59], a[60:63], v[140:143]
s_add_u32 s100, s101, 640
s_and_b32 s100, s100, 1023
s_add_u32 m0, s43, 65536
v_mfma_f32_16x16x32_bf16 v[144:147], v[60:63], a[48:51], v[144:147]
s_add_u32 s100, s100, s46
v_mov_b32 v30, -1
s_and_b32 s17, s40, 8
v_mfma_f32_16x16x32_bf16 v[148:151], v[60:63], a[52:55], v[148:151]
buffer_load_dwordx4 v19, s[24:27], s100 offen lds
v_mfma_f32_16x16x32_bf16 v[152:155], v[60:63], a[56:59], v[152:155]
s_waitcnt vmcnt(28)
s_barrier
ds_read_b64_tr_b16 v[48:49], v2 offset:32768
v_mfma_f32_16x16x32_bf16 v[156:159], v[60:63], a[60:63], v[156:159]
s_add_u32 m0, s43, 66560
ds_read_b64_tr_b16 v[50:51], v2 offset:33792
ds_read_b64_tr_b16 v[52:53], v3 offset:32768
v_mfma_f32_16x16x32_bf16 v[160:163], v[40:43], a[48:51], v[160:163]
s_add_u32 s100, s100, 8192
ds_read_b64_tr_b16 v[54:55], v3 offset:33792
ds_read_b64_tr_b16 v[56:57], v4 offset:32768
v_mfma_f32_16x16x32_bf16 v[164:167], v[40:43], a[52:55], v[164:167]
s_add_u32 s18, s101, 640
ds_read_b64_tr_b16 v[58:59], v4 offset:33792
s_and_b32 s18, s18, 1023
v_mfma_f32_16x16x32_bf16 v[168:171], v[40:43], a[56:59], v[168:171]
s_waitcnt lgkmcnt(6)
s_lshl_b32 s18, s18, 12
s_add_u32 s18, s18, s56
v_exp_f32 v226, v226
s_nop 0
v_add_f32 v226, 1.0, v226
v_rcp_f32 v226, v226
s_nop 0
v_cvt_pk_bf16_f32 v226, v226, v226
v_and_b32 v226, 0xffff0000, v226
v_cndmask_b32 v216, v226, v225, vcc
buffer_store_dword v216, v217, s[36:39], s62 offen sc1
v_mfma_f32_16x16x32_bf16 v[172:175], v[40:43], a[60:63], v[172:175]
buffer_load_dwordx4 v20, s[24:27], s100 offen lds
buffer_store_dwordx4 v[192:195], v21, s[36:39], s49 offen sc1
v_mfma_f32_16x16x32_bf16 v[176:179], v[44:47], a[48:51], v[176:179]
s_add_u32 m0, s43, 4096
ds_read_b64_tr_b16 v[60:61], v5 offset:32768
s_add_u32 s100, s100, 8192
v_mfma_f32_16x16x32_bf16 v[180:183], v[44:47], a[52:55], v[180:183]
buffer_load_dwordx4 v16, s[28:31], s18 offen lds
s_add_u32 m0, s43, 67584
s_nop 0
buffer_load_dwordx4 v19, s[24:27], s100 offen lds
v_mfma_f32_16x16x32_bf16 v[184:187], v[44:47], a[56:59], v[184:187]
s_waitcnt lgkmcnt(5)
ds_read_b64_tr_b16 v[62:63], v5 offset:33792
s_add_u32 m0, s43, 68608
v_mfma_f32_16x16x32_bf16 v[188:191], v[44:47], a[60:63], v[188:191]
s_add_u32 s100, s100, 8192
s_add_u32 s18, s18, 32768
s_add_u32 s17, s17, s41
buffer_load_dwordx4 v20, s[24:27], s100 offen lds
v_mfma_f32_16x16x32_bf16 v[64:67], v[48:51], a[64:67], v[64:67]
s_add_u32 m0, s43, 5120
ds_read_b64_tr_b16 v[40:41], v6 offset:32768
s_add_u32 s100, s100, 8192
v_mfma_f32_16x16x32_bf16 v[68:71], v[48:51], a[68:71], v[68:71]
buffer_load_dwordx4 v16, s[28:31], s18 offen lds
s_add_u32 m0, s43, 69632
s_nop 0
buffer_load_dwordx4 v19, s[24:27], s100 offen lds
v_mfma_f32_16x16x32_bf16 v[72:75], v[48:51], a[72:75], v[72:75]
s_waitcnt lgkmcnt(3)
ds_read_b64_tr_b16 v[42:43], v6 offset:33792
s_add_u32 m0, s43, 70656
v_mfma_f32_16x16x32_bf16 v[76:79], v[48:51], a[76:79], v[76:79]
s_add_u32 s100, s100, 8192
s_add_u32 s17, s17, s3
s_and_b32 s62, s40, 16
buffer_load_dwordx4 v20, s[24:27], s100 offen lds
v_mfma_f32_16x16x32_bf16 v[80:83], v[52:55], a[64:67], v[80:83]
s_add_u32 m0, s43, 71680
ds_read_b64_tr_b16 v[44:45], v7 offset:32768
s_add_u32 s100, s100, 8192
v_mfma_f32_16x16x32_bf16 v[84:87], v[52:55], a[68:71], v[84:87]
buffer_load_dwordx4 v19, s[24:27], s100 offen lds
v_mfma_f32_16x16x32_bf16 v[88:91], v[52:55], a[72:75], v[88:91]
s_add_u32 m0, s43, 72704
ds_read_b64_tr_b16 v[46:47], v7 offset:33792
s_add_u32 s100, s100, 8192
v_mfma_f32_16x16x32_bf16 v[92:95], v[52:55], a[76:79], v[92:95]
buffer_load_dwordx4 v20, s[24:27], s100 offen lds
v_mfma_f32_16x16x32_bf16 v[96:99], v[56:59], a[64:67], v[96:99]
s_waitcnt vmcnt(29)
ds_read_b128 a[96:99], v14 offset:32768
ds_read_b64_tr_b16 v[48:49], v8 offset:32768
v_mfma_f32_16x16x32_bf16 v[100:103], v[56:59], a[68:71], v[100:103]
ds_read_b64_tr_b16 v[50:51], v8 offset:33792
s_lshl_b32 s62, s62, 3
v_mfma_f32_16x16x32_bf16 v[104:107], v[56:59], a[72:75], v[104:107]
s_waitcnt lgkmcnt(7)
ds_read_b128 a[100:103], v14 offset:34816
s_add_u32 s17, s17, s62
v_mfma_f32_16x16x32_bf16 v[108:111], v[56:59], a[76:79], v[108:111]
v_mfma_f32_16x16x32_bf16 v[112:115], v[60:63], a[64:67], v[112:115]
ds_read_b64_tr_b16 v[52:53], v9 offset:32768
v_mfma_f32_16x16x32_bf16 v[116:119], v[60:63], a[68:71], v[116:119]
ds_read_b64_tr_b16 v[54:55], v9 offset:33792
v_mfma_f32_16x16x32_bf16 v[120:123], v[60:63], a[72:75], v[120:123]
s_waitcnt lgkmcnt(8)
ds_read_b128 a[104:107], v14 offset:36864
v_mfma_f32_16x16x32_bf16 v[124:127], v[60:63], a[76:79], v[124:127]
s_barrier
v_mfma_f32_16x16x32_bf16 v[128:131], v[40:43], a[64:67], v[128:131]
ds_read_b64_tr_b16 v[56:57], v2 offset:34816
v_mfma_f32_16x16x32_bf16 v[132:135], v[40:43], a[68:71], v[132:135]
ds_read_b64_tr_b16 v[58:59], v2 offset:35840
v_mfma_f32_16x16x32_bf16 v[136:139], v[40:43], a[72:75], v[136:139]
s_waitcnt lgkmcnt(6)
ds_read_b128 a[108:111], v14 offset:38912
s_add_u32 s18, s101, 704
v_mfma_f32_16x16x32_bf16 v[140:143], v[40:43], a[76:79], v[140:143]
s_and_b32 s18, s18, 1023
s_lshl_b32 s18, s18, 12
s_add_u32 s18, s18, s56
v_mfma_f32_16x16x32_bf16 v[144:147], v[44:47], a[64:67], v[144:147]
s_add_u32 m0, s43, 6144
ds_read_b64_tr_b16 v[60:61], v3 offset:34816
v_mfma_f32_16x16x32_bf16 v[148:151], v[44:47], a[68:71], v[148:151]
buffer_load_dwordx4 v16, s[28:31], s18 offen lds
v_mfma_f32_16x16x32_bf16 v[152:155], v[44:47], a[72:75], v[152:155]
s_add_u32 m0, s43, 7168
ds_read_b64_tr_b16 v[62:63], v3 offset:35840
ds_read_b128 a[112:115], v15 offset:32768
v_mfma_f32_16x16x32_bf16 v[156:159], v[44:47], a[76:79], v[156:159]
s_add_u32 s18, s18, 32768
v_mfma_f32_16x16x32_bf16 v[160:163], v[48:51], a[64:67], v[160:163]
buffer_load_dwordx4 v16, s[28:31], s18 offen lds
v_mfma_f32_16x16x32_bf16 v[164:167], v[48:51], a[68:71], v[164:167]
ds_read_b64_tr_b16 v[40:41], v4 offset:34816
ds_read_b64_tr_b16 v[42:43], v4 offset:35840
v_mfma_f32_16x16x32_bf16 v[168:171], v[48:51], a[72:75], v[168:171]
s_waitcnt lgkmcnt(6)
ds_read_b128 a[116:119], v15 offset:34816
v_mfma_f32_16x16x32_bf16 v[172:175], v[48:51], a[76:79], v[172:175]
v_mfma_f32_16x16x32_bf16 v[176:179], v[52:55], a[64:67], v[176:179]
ds_read_b64_tr_b16 v[44:45], v5 offset:34816
v_mfma_f32_16x16x32_bf16 v[180:183], v[52:55], a[68:71], v[180:183]
ds_read_b64_tr_b16 v[46:47], v5 offset:35840
v_mfma_f32_16x16x32_bf16 v[184:187], v[52:55], a[72:75], v[184:187]
ds_read_b128 a[120:123], v15 offset:36864
v_mfma_f32_16x16x32_bf16 v[188:191], v[52:55], a[76:79], v[188:191]
v_mfma_f32_16x16x32_bf16 v[64:67], v[56:59], a[80:83], v[64:67]
ds_read_b64_tr_b16 v[48:49], v6 offset:34816
v_mfma_f32_16x16x32_bf16 v[68:71], v[56:59], a[84:87], v[68:71]
ds_read_b64_tr_b16 v[50:51], v6 offset:35840
v_mfma_f32_16x16x32_bf16 v[72:75], v[56:59], a[88:91], v[72:75]
s_waitcnt lgkmcnt(6)
ds_read_b128 a[124:127], v15 offset:38912
v_mfma_f32_16x16x32_bf16 v[76:79], v[56:59], a[92:95], v[76:79]
v_mfma_f32_16x16x32_bf16 v[80:83], v[60:63], a[80:83], v[80:83]
ds_read_b64_tr_b16 v[52:53], v7 offset:34816
v_mfma_f32_16x16x32_bf16 v[84:87], v[60:63], a[84:87], v[84:87]
ds_read_b64_tr_b16 v[54:55], v7 offset:35840
v_mfma_f32_16x16x32_bf16 v[88:91], v[60:63], a[88:91], v[88:91]
v_mfma_f32_16x16x32_bf16 v[92:95], v[60:63], a[92:95], v[92:95]
v_mfma_f32_16x16x32_bf16 v[96:99], v[40:43], a[80:83], v[96:99]
ds_read_b64_tr_b16 v[56:57], v8 offset:34816
v_mfma_f32_16x16x32_bf16 v[100:103], v[40:43], a[84:87], v[100:103]
ds_read_b64_tr_b16 v[58:59], v8 offset:35840
v_mfma_f32_16x16x32_bf16 v[104:107], v[40:43], a[88:91], v[104:107]
s_waitcnt lgkmcnt(5)
v_mfma_f32_16x16x32_bf16 v[108:111], v[40:43], a[92:95], v[108:111]
v_mfma_f32_16x16x32_bf16 v[112:115], v[44:47], a[80:83], v[112:115]
ds_read_b64_tr_b16 v[60:61], v9 offset:34816
v_mfma_f32_16x16x32_bf16 v[116:119], v[44:47], a[84:87], v[116:119]
ds_read_b64_tr_b16 v[62:63], v9 offset:35840
v_mfma_f32_16x16x32_bf16 v[120:123], v[44:47], a[88:91], v[120:123]
s_waitcnt lgkmcnt(6)
s_add_u32 s100, s101, 768
s_and_b32 s100, s100, 1023
v_mfma_f32_16x16x32_bf16 v[124:127], v[44:47], a[92:95], v[124:127]
s_add_u32 m0, s43, 98304
s_add_u32 s100, s100, s46
v_mfma_f32_16x16x32_bf16 v[128:131], v[48:51], a[80:83], v[128:131]
buffer_load_dwordx4 v19, s[24:27], s100 offen lds
v_mfma_f32_16x16x32_bf16 v[132:135], v[48:51], a[84:87], v[132:135]
s_waitcnt vmcnt(30)
s_barrier
ds_read_b64_tr_b16 v[40:41], v2 offset:36864
v_mfma_f32_16x16x32_bf16 v[136:139], v[48:51], a[88:91], v[136:139]
s_waitcnt lgkmcnt(3)
ds_read_b64_tr_b16 v[42:43], v2 offset:37888
s_add_u32 m0, s43, 99328
v_mfma_f32_16x16x32_bf16 v[140:143], v[48:51], a[92:95], v[140:143]
s_add_u32 s100, s100, 8192
s_add_u32 s18, s101, 768
s_and_b32 s18, s18, 1023
v_mfma_f32_16x16x32_bf16 v[144:147], v[52:55], a[80:83], v[144:147]
buffer_load_dwordx4 v20, s[24:27], s100 offen lds
v_mfma_f32_16x16x32_bf16 v[148:151], v[52:55], a[84:87], v[148:151]
s_lshl_b32 s18, s18, 12
ds_read_b64_tr_b16 v[44:45], v3 offset:36864
ds_read_b64_tr_b16 v[46:47], v3 offset:37888
v_mfma_f32_16x16x32_bf16 v[152:155], v[52:55], a[88:91], v[152:155]
s_add_u32 s18, s18, s56
s_add_u32 m0, s43, 32768
s_add_u32 s100, s100, 8192
v_mfma_f32_16x16x32_bf16 v[156:159], v[52:55], a[92:95], v[156:159]
buffer_load_dwordx4 v16, s[28:31], s18 offen lds
v_mfma_f32_16x16x32_bf16 v[160:163], v[56:59], a[80:83], v[160:163]
s_add_u32 m0, s43, 100352
ds_read_b64_tr_b16 v[48:49], v4 offset:36864
s_add_u32 s18, s18, 32768
v_mfma_f32_16x16x32_bf16 v[164:167], v[56:59], a[84:87], v[164:167]
buffer_load_dwordx4 v19, s[24:27], s100 offen lds
v_mfma_f32_16x16x32_bf16 v[168:171], v[56:59], a[88:91], v[168:171]
s_waitcnt lgkmcnt(5)
ds_read_b64_tr_b16 v[50:51], v4 offset:37888
s_add_u32 m0, s43, 101376
v_mfma_f32_16x16x32_bf16 v[172:175], v[56:59], a[92:95], v[172:175]
s_add_u32 s100, s100, 8192
v_mfma_f32_16x16x32_bf16 v[176:179], v[60:63], a[80:83], v[176:179]
buffer_load_dwordx4 v20, s[24:27], s100 offen lds
v_mfma_f32_16x16x32_bf16 v[180:183], v[60:63], a[84:87], v[180:183]
s_add_u32 m0, s43, 33792
ds_read_b64_tr_b16 v[52:53], v5 offset:36864
ds_read_b64_tr_b16 v[54:55], v5 offset:37888
v_mfma_f32_16x16x32_bf16 v[184:187], v[60:63], a[88:91], v[184:187]
buffer_load_dwordx4 v16, s[28:31], s18 offen lds
v_mfma_f32_16x16x32_bf16 v[188:191], v[60:63], a[92:95], v[188:191]
s_waitcnt lgkmcnt(4)
s_add_u32 m0, s43, 102400
s_add_u32 s100, s100, 8192
v_mfma_f32_16x16x32_bf16 v[64:67], v[40:43], a[96:99], v[64:67]
buffer_load_dwordx4 v19, s[24:27], s100 offen lds
v_mfma_f32_16x16x32_bf16 v[68:71], v[40:43], a[100:103], v[68:71]
s_add_u32 m0, s43, 103424
ds_read_b64_tr_b16 v[56:57], v6 offset:36864
ds_read_b64_tr_b16 v[58:59], v6 offset:37888
v_mfma_f32_16x16x32_bf16 v[72:75], v[40:43], a[104:107], v[72:75]
s_add_u32 s100, s100, 8192
v_mfma_f32_16x16x32_bf16 v[76:79], v[40:43], a[108:111], v[76:79]
buffer_load_dwordx4 v20, s[24:27], s100 offen lds
v_mfma_f32_16x16x32_bf16 v[80:83], v[44:47], a[96:99], v[80:83]
s_add_u32 m0, s43, 104448
ds_read_b64_tr_b16 v[60:61], v7 offset:36864
s_add_u32 s100, s100, 8192
v_mfma_f32_16x16x32_bf16 v[84:87], v[44:47], a[100:103], v[84:87]
buffer_load_dwordx4 v19, s[24:27], s100 offen lds
v_mfma_f32_16x16x32_bf16 v[88:91], v[44:47], a[104:107], v[88:91]
s_waitcnt lgkmcnt(3)
ds_read_b64_tr_b16 v[62:63], v7 offset:37888
s_add_u32 m0, s43, 105472
v_mfma_f32_16x16x32_bf16 v[92:95], v[44:47], a[108:111], v[92:95]
s_add_u32 s100, s100, 8192
s_mov_b32 s48, s12
s_and_b32 s49, s13, 0xffff
buffer_load_dwordx4 v20, s[24:27], s100 offen lds
v_mfma_f32_16x16x32_bf16 v[96:99], v[48:51], a[96:99], v[96:99]
s_mov_b32 s50, 4194304
s_waitcnt vmcnt(26)
ds_read_b128 a[128:131], v26 offset:0
v_mfma_f32_16x16x32_bf16 v[100:103], v[48:51], a[100:103], v[100:103]
buffer_load_dword v37, v32, s[48:51], s66 offen
v_mfma_f32_16x16x32_bf16 v[104:107], v[48:51], a[104:107], v[104:107]
ds_read_b64_tr_b16 v[40:41], v8 offset:36864
ds_read_b64_tr_b16 v[42:43], v8 offset:37888
v_mfma_f32_16x16x32_bf16 v[108:111], v[48:51], a[108:111], v[108:111]
ds_read_b128 a[132:135], v26 offset:2048
v_mfma_f32_16x16x32_bf16 v[112:115], v[52:55], a[96:99], v[112:115]
ds_read_b64_tr_b16 v[44:45], v9 offset:36864
v_mfma_f32_16x16x32_bf16 v[116:119], v[52:55], a[100:103], v[116:119]
ds_read_b64_tr_b16 v[46:47], v9 offset:37888
v_mfma_f32_16x16x32_bf16 v[120:123], v[52:55], a[104:107], v[120:123]
s_waitcnt lgkmcnt(8)
ds_read_b128 a[136:139], v26 offset:4096
v_mfma_f32_16x16x32_bf16 v[124:127], v[52:55], a[108:111], v[124:127]
s_waitcnt vmcnt(21)
s_barrier
v_mfma_f32_16x16x32_bf16 v[128:131], v[56:59], a[96:99], v[128:131]
buffer_store_byte v30, v28, s[4:7], s17 offen sc1
v_mfma_f32_16x16x32_bf16 v[132:135], v[56:59], a[100:103], v[132:135]
ds_read_b64_tr_b16 v[48:49], v2 offset:38912
ds_read_b64_tr_b16 v[50:51], v2 offset:39936
v_mfma_f32_16x16x32_bf16 v[136:139], v[56:59], a[104:107], v[136:139]
s_waitcnt lgkmcnt(9)
ds_read_b128 a[140:143], v26 offset:6144
s_add_u32 s18, s101, 832
v_mfma_f32_16x16x32_bf16 v[140:143], v[56:59], a[108:111], v[140:143]
s_and_b32 s18, s18, 1023
s_lshl_b32 s18, s18, 12
s_add_u32 s18, s18, s56
v_mfma_f32_16x16x32_bf16 v[144:147], v[60:63], a[96:99], v[144:147]
s_add_u32 m0, s43, 34816
ds_read_b64_tr_b16 v[52:53], v3 offset:38912
v_mfma_f32_16x16x32_bf16 v[148:151], v[60:63], a[100:103], v[148:151]
buffer_load_dwordx4 v16, s[28:31], s18 offen lds
v_mfma_f32_16x16x32_bf16 v[152:155], v[60:63], a[104:107], v[152:155]
s_waitcnt lgkmcnt(5)
ds_read_b64_tr_b16 v[54:55], v3 offset:39936
ds_read_b128 a[144:147], v27 offset:0
v_mfma_f32_16x16x32_bf16 v[156:159], v[60:63], a[108:111], v[156:159]
s_add_u32 m0, s43, 35840
s_add_u32 s18, s18, 32768
v_mfma_f32_16x16x32_bf16 v[160:163], v[40:43], a[96:99], v[160:163]
buffer_load_dwordx4 v16, s[28:31], s18 offen lds
v_mfma_f32_16x16x32_bf16 v[164:167], v[40:43], a[100:103], v[164:167]
ds_read_b64_tr_b16 v[56:57], v4 offset:38912
ds_read_b64_tr_b16 v[58:59], v4 offset:39936
v_mfma_f32_16x16x32_bf16 v[168:171], v[40:43], a[104:107], v[168:171]
ds_read_b128 a[148:151], v27 offset:2048
v_mfma_f32_16x16x32_bf16 v[172:175], v[40:43], a[108:111], v[172:175]
v_mfma_f32_16x16x32_bf16 v[176:179], v[44:47], a[96:99], v[176:179]
ds_read_b64_tr_b16 v[60:61], v5 offset:38912
v_mfma_f32_16x16x32_bf16 v[180:183], v[44:47], a[100:103], v[180:183]
ds_read_b64_tr_b16 v[62:63], v5 offset:39936
v_mfma_f32_16x16x32_bf16 v[184:187], v[44:47], a[104:107], v[184:187]
s_waitcnt lgkmcnt(9)
ds_read_b128 a[152:155], v27 offset:4096
v_mfma_f32_16x16x32_bf16 v[188:191], v[44:47], a[108:111], v[188:191]
v_mfma_f32_16x16x32_bf16 v[64:67], v[48:51], a[112:115], v[64:67]
ds_read_b64_tr_b16 v[40:41], v6 offset:38912
v_mfma_f32_16x16x32_bf16 v[68:71], v[48:51], a[116:119], v[68:71]
ds_read_b64_tr_b16 v[42:43], v6 offset:39936
v_mfma_f32_16x16x32_bf16 v[72:75], v[48:51], a[120:123], v[72:75]
s_waitcnt lgkmcnt(6)
ds_read_b128 a[156:159], v27 offset:6144
v_mfma_f32_16x16x32_bf16 v[76:79], v[48:51], a[124:127], v[76:79]
v_mfma_f32_16x16x32_bf16 v[80:83], v[52:55], a[112:115], v[80:83]
ds_read_b64_tr_b16 v[44:45], v7 offset:38912
v_mfma_f32_16x16x32_bf16 v[84:87], v[52:55], a[116:119], v[84:87]
ds_read_b64_tr_b16 v[46:47], v7 offset:39936
v_mfma_f32_16x16x32_bf16 v[88:91], v[52:55], a[120:123], v[88:91]
v_mfma_f32_16x16x32_bf16 v[92:95], v[52:55], a[124:127], v[92:95]
v_mfma_f32_16x16x32_bf16 v[96:99], v[56:59], a[112:115], v[96:99]
ds_read_b64_tr_b16 v[48:49], v8 offset:38912
v_mfma_f32_16x16x32_bf16 v[100:103], v[56:59], a[116:119], v[100:103]
ds_read_b64_tr_b16 v[50:51], v8 offset:39936
v_mfma_f32_16x16x32_bf16 v[104:107], v[56:59], a[120:123], v[104:107]
s_waitcnt lgkmcnt(5)
v_mfma_f32_16x16x32_bf16 v[108:111], v[56:59], a[124:127], v[108:111]
v_mfma_f32_16x16x32_bf16 v[112:115], v[60:63], a[112:115], v[112:115]
ds_read_b64_tr_b16 v[52:53], v9 offset:38912
v_mfma_f32_16x16x32_bf16 v[116:119], v[60:63], a[116:119], v[116:119]
ds_read_b64_tr_b16 v[54:55], v9 offset:39936
v_mfma_f32_16x16x32_bf16 v[120:123], v[60:63], a[120:123], v[120:123]
s_waitcnt lgkmcnt(6)
s_add_u32 s100, s101, 896
s_and_b32 s100, s100, 1023
v_mfma_f32_16x16x32_bf16 v[124:127], v[60:63], a[124:127], v[124:127]
s_add_u32 m0, s43, 131072
s_add_u32 s100, s100, s46
v_mfma_f32_16x16x32_bf16 v[128:131], v[40:43], a[112:115], v[128:131]
buffer_load_dwordx4 v19, s[24:27], s100 offen lds
v_mfma_f32_16x16x32_bf16 v[132:135], v[40:43], a[116:119], v[132:135]
s_barrier
ds_read_b64_tr_b16 v[56:57], v2 offset:0
ds_read_b64_tr_b16 v[58:59], v2 offset:1024
v_mfma_f32_16x16x32_bf16 v[136:139], v[40:43], a[120:123], v[136:139]
s_waitcnt lgkmcnt(4)
s_add_u32 m0, s43, 132096
s_add_u32 s100, s100, 8192
v_mfma_f32_16x16x32_bf16 v[140:143], v[40:43], a[124:127], v[140:143]
buffer_load_dwordx4 v20, s[24:27], s100 offen lds
v_mfma_f32_16x16x32_bf16 v[144:147], v[44:47], a[112:115], v[144:147]
s_add_u32 s18, s101, 896
ds_read_b64_tr_b16 v[60:61], v3 offset:0
s_and_b32 s18, s18, 1023
v_mfma_f32_16x16x32_bf16 v[148:151], v[44:47], a[116:119], v[148:151]
s_lshl_b32 s18, s18, 12
ds_read_b64_tr_b16 v[62:63], v3 offset:1024
s_add_u32 s18, s18, s56
v_mfma_f32_16x16x32_bf16 v[152:155], v[44:47], a[120:123], v[152:155]
s_add_u32 m0, s43, 36864
s_add_u32 s100, s100, 8192
v_mfma_f32_16x16x32_bf16 v[156:159], v[44:47], a[124:127], v[156:159]
buffer_load_dwordx4 v16, s[28:31], s18 offen lds
v_mfma_f32_16x16x32_bf16 v[160:163], v[48:51], a[112:115], v[160:163]
s_add_u32 m0, s43, 133120
ds_read_b64_tr_b16 v[40:41], v4 offset:0
s_add_u32 s18, s18, 32768
v_mfma_f32_16x16x32_bf16 v[164:167], v[48:51], a[116:119], v[164:167]
buffer_load_dwordx4 v19, s[24:27], s100 offen lds
v_mfma_f32_16x16x32_bf16 v[168:171], v[48:51], a[120:123], v[168:171]
s_waitcnt lgkmcnt(3)
ds_read_b64_tr_b16 v[42:43], v4 offset:1024
s_add_u32 m0, s43, 134144
v_mfma_f32_16x16x32_bf16 v[172:175], v[48:51], a[124:127], v[172:175]
s_add_u32 s100, s100, 8192
v_mfma_f32_16x16x32_bf16 v[176:179], v[52:55], a[112:115], v[176:179]
buffer_load_dwordx4 v20, s[24:27], s100 offen lds
v_mfma_f32_16x16x32_bf16 v[180:183], v[52:55], a[116:119], v[180:183]
s_add_u32 m0, s43, 37888
ds_read_b64_tr_b16 v[44:45], v5 offset:0
ds_read_b64_tr_b16 v[46:47], v5 offset:1024
v_mfma_f32_16x16x32_bf16 v[184:187], v[52:55], a[120:123], v[184:187]
buffer_load_dwordx4 v16, s[28:31], s18 offen lds
v_mfma_f32_16x16x32_bf16 v[188:191], v[52:55], a[124:127], v[188:191]
s_add_u32 m0, s43, 135168
s_add_u32 s100, s100, 8192
v_mfma_f32_16x16x32_bf16 v[64:67], v[56:59], a[128:131], v[64:67]
buffer_load_dwordx4 v19, s[24:27], s100 offen lds
v_mfma_f32_16x16x32_bf16 v[68:71], v[56:59], a[132:135], v[68:71]
s_add_u32 m0, s43, 136192
ds_read_b64_tr_b16 v[48:49], v6 offset:0
ds_read_b64_tr_b16 v[50:51], v6 offset:1024
v_mfma_f32_16x16x32_bf16 v[72:75], v[56:59], a[136:139], v[72:75]
s_waitcnt lgkmcnt(6)
s_add_u32 s100, s100, 8192
v_mfma_f32_16x16x32_bf16 v[76:79], v[56:59], a[140:143], v[76:79]
buffer_load_dwordx4 v20, s[24:27], s100 offen lds
v_mfma_f32_16x16x32_bf16 v[80:83], v[60:63], a[128:131], v[80:83]
s_add_u32 m0, s43, 137216
ds_read_b64_tr_b16 v[52:53], v7 offset:0
s_add_u32 s100, s100, 8192
v_mfma_f32_16x16x32_bf16 v[84:87], v[60:63], a[132:135], v[84:87]
buffer_load_dwordx4 v19, s[24:27], s100 offen lds
v_mfma_f32_16x16x32_bf16 v[88:91], v[60:63], a[136:139], v[88:91]
s_waitcnt lgkmcnt(3)
ds_read_b64_tr_b16 v[54:55], v7 offset:1024
s_add_u32 m0, s43, 138240
v_mfma_f32_16x16x32_bf16 v[92:95], v[60:63], a[140:143], v[92:95]
s_add_u32 s100, s100, 8192
buffer_load_dwordx4 v20, s[24:27], s100 offen lds
v_mfma_f32_16x16x32_bf16 v[96:99], v[40:43], a[128:131], v[96:99]
s_waitcnt vmcnt(26)
ds_read_b128 a[160:163], v14 offset:0
ds_read_b64_tr_b16 v[56:57], v8 offset:0
v_mfma_f32_16x16x32_bf16 v[100:103], v[40:43], a[132:135], v[100:103]
ds_read_b64_tr_b16 v[58:59], v8 offset:1024
v_mfma_f32_16x16x32_bf16 v[104:107], v[40:43], a[136:139], v[104:107]
ds_read_b128 a[164:167], v14 offset:2048
v_mfma_f32_16x16x32_bf16 v[108:111], v[40:43], a[140:143], v[108:111]
v_mfma_f32_16x16x32_bf16 v[112:115], v[44:47], a[128:131], v[112:115]
ds_read_b64_tr_b16 v[60:61], v9 offset:0
v_mfma_f32_16x16x32_bf16 v[116:119], v[44:47], a[132:135], v[116:119]
ds_read_b64_tr_b16 v[62:63], v9 offset:1024
v_mfma_f32_16x16x32_bf16 v[120:123], v[44:47], a[136:139], v[120:123]
s_waitcnt lgkmcnt(8)
ds_read_b128 a[168:171], v14 offset:4096
v_mfma_f32_16x16x32_bf16 v[124:127], v[44:47], a[140:143], v[124:127]
s_barrier
v_mfma_f32_16x16x32_bf16 v[128:131], v[48:51], a[128:131], v[128:131]
ds_read_b64_tr_b16 v[40:41], v2 offset:2048
v_mfma_f32_16x16x32_bf16 v[132:135], v[48:51], a[132:135], v[132:135]
ds_read_b64_tr_b16 v[42:43], v2 offset:3072
v_mfma_f32_16x16x32_bf16 v[136:139], v[48:51], a[136:139], v[136:139]
s_waitcnt lgkmcnt(6)
ds_read_b128 a[172:175], v14 offset:6144
s_add_u32 s18, s101, 960
v_mfma_f32_16x16x32_bf16 v[140:143], v[48:51], a[140:143], v[140:143]
s_and_b32 s18, s18, 1023
s_lshl_b32 s18, s18, 12
s_add_u32 s18, s18, s56
v_mfma_f32_16x16x32_bf16 v[144:147], v[52:55], a[128:131], v[144:147]
s_add_u32 m0, s43, 38912
ds_read_b64_tr_b16 v[44:45], v3 offset:2048
v_mfma_f32_16x16x32_bf16 v[148:151], v[52:55], a[132:135], v[148:151]
buffer_load_dwordx4 v16, s[28:31], s18 offen lds
v_mfma_f32_16x16x32_bf16 v[152:155], v[52:55], a[136:139], v[152:155]
s_add_u32 m0, s43, 39936
ds_read_b64_tr_b16 v[46:47], v3 offset:3072
ds_read_b128 a[176:179], v15 offset:0
v_mfma_f32_16x16x32_bf16 v[156:159], v[52:55], a[140:143], v[156:159]
s_add_u32 s18, s18, 32768
v_mfma_f32_16x16x32_bf16 v[160:163], v[56:59], a[128:131], v[160:163]
buffer_load_dwordx4 v16, s[28:31], s18 offen lds
v_mfma_f32_16x16x32_bf16 v[164:167], v[56:59], a[132:135], v[164:167]
ds_read_b64_tr_b16 v[48:49], v4 offset:2048
ds_read_b64_tr_b16 v[50:51], v4 offset:3072
v_mfma_f32_16x16x32_bf16 v[168:171], v[56:59], a[136:139], v[168:171]
s_waitcnt lgkmcnt(6)
ds_read_b128 a[180:183], v15 offset:2048
v_mfma_f32_16x16x32_bf16 v[172:175], v[56:59], a[140:143], v[172:175]
v_mfma_f32_16x16x32_bf16 v[176:179], v[60:63], a[128:131], v[176:179]
ds_read_b64_tr_b16 v[52:53], v5 offset:2048
v_mfma_f32_16x16x32_bf16 v[180:183], v[60:63], a[132:135], v[180:183]
ds_read_b64_tr_b16 v[54:55], v5 offset:3072
v_mfma_f32_16x16x32_bf16 v[184:187], v[60:63], a[136:139], v[184:187]
ds_read_b128 a[184:187], v15 offset:4096
v_mfma_f32_16x16x32_bf16 v[188:191], v[60:63], a[140:143], v[188:191]
v_mfma_f32_16x16x32_bf16 v[64:67], v[40:43], a[144:147], v[64:67]
ds_read_b64_tr_b16 v[56:57], v6 offset:2048
v_mfma_f32_16x16x32_bf16 v[68:71], v[40:43], a[148:151], v[68:71]
ds_read_b64_tr_b16 v[58:59], v6 offset:3072
v_mfma_f32_16x16x32_bf16 v[72:75], v[40:43], a[152:155], v[72:75]
s_waitcnt lgkmcnt(6)
ds_read_b128 a[188:191], v15 offset:6144
v_mfma_f32_16x16x32_bf16 v[76:79], v[40:43], a[156:159], v[76:79]
v_mfma_f32_16x16x32_bf16 v[80:83], v[44:47], a[144:147], v[80:83]
ds_read_b64_tr_b16 v[60:61], v7 offset:2048
v_mfma_f32_16x16x32_bf16 v[84:87], v[44:47], a[148:151], v[84:87]
ds_read_b64_tr_b16 v[62:63], v7 offset:3072
v_mfma_f32_16x16x32_bf16 v[88:91], v[44:47], a[152:155], v[88:91]
v_mfma_f32_16x16x32_bf16 v[92:95], v[44:47], a[156:159], v[92:95]
v_mfma_f32_16x16x32_bf16 v[96:99], v[48:51], a[144:147], v[96:99]
ds_read_b64_tr_b16 v[40:41], v8 offset:2048
v_mfma_f32_16x16x32_bf16 v[100:103], v[48:51], a[148:151], v[100:103]
ds_read_b64_tr_b16 v[42:43], v8 offset:3072
v_mfma_f32_16x16x32_bf16 v[104:107], v[48:51], a[152:155], v[104:107]
s_waitcnt lgkmcnt(5)
v_mfma_f32_16x16x32_bf16 v[108:111], v[48:51], a[156:159], v[108:111]
v_mfma_f32_16x16x32_bf16 v[112:115], v[52:55], a[144:147], v[112:115]
ds_read_b64_tr_b16 v[44:45], v9 offset:2048
v_mfma_f32_16x16x32_bf16 v[116:119], v[52:55], a[148:151], v[116:119]
ds_read_b64_tr_b16 v[46:47], v9 offset:3072
v_mfma_f32_16x16x32_bf16 v[120:123], v[52:55], a[152:155], v[120:123]
v_mfma_f32_16x16x32_bf16 v[124:127], v[52:55], a[156:159], v[124:127]
s_barrier
v_mfma_f32_16x16x32_bf16 v[128:131], v[56:59], a[144:147], v[128:131]
ds_read_b64_tr_b16 v[48:49], v2 offset:4096
v_mfma_f32_16x16x32_bf16 v[132:135], v[56:59], a[148:151], v[132:135]
ds_read_b64_tr_b16 v[50:51], v2 offset:5120
v_mfma_f32_16x16x32_bf16 v[136:139], v[56:59], a[152:155], v[136:139]
s_waitcnt lgkmcnt(4)
s_add_u32 s18, s101, 0
s_and_b32 s18, s18, 1023
v_mfma_f32_16x16x32_bf16 v[140:143], v[56:59], a[156:159], v[140:143]
s_lshl_b32 s18, s18, 12
s_add_u32 s18, s18, s57
s_add_u32 m0, s43, 0
v_mfma_f32_16x16x32_bf16 v[144:147], v[60:63], a[144:147], v[144:147]
buffer_load_dwordx4 v17, s[32:35], s18 offen lds
v_mfma_f32_16x16x32_bf16 v[148:151], v[60:63], a[148:151], v[148:151]
ds_read_b64_tr_b16 v[52:53], v3 offset:4096
ds_read_b64_tr_b16 v[54:55], v3 offset:5120
v_mfma_f32_16x16x32_bf16 v[152:155], v[60:63], a[152:155], v[152:155]
s_add_u32 m0, s43, 1024
s_add_u32 s18, s18, 65536
v_mfma_f32_16x16x32_bf16 v[156:159], v[60:63], a[156:159], v[156:159]
buffer_load_dwordx4 v18, s[32:35], s18 offen lds
v_mfma_f32_16x16x32_bf16 v[160:163], v[40:43], a[144:147], v[160:163]
ds_read_b64_tr_b16 v[56:57], v4 offset:4096
v_mfma_f32_16x16x32_bf16 v[164:167], v[40:43], a[148:151], v[164:167]
ds_read_b64_tr_b16 v[58:59], v4 offset:5120
v_mfma_f32_16x16x32_bf16 v[168:171], v[40:43], a[152:155], v[168:171]
s_waitcnt lgkmcnt(4)
v_mfma_f32_16x16x32_bf16 v[172:175], v[40:43], a[156:159], v[172:175]
v_mfma_f32_16x16x32_bf16 v[176:179], v[44:47], a[144:147], v[176:179]
ds_read_b64_tr_b16 v[60:61], v5 offset:4096
v_mfma_f32_16x16x32_bf16 v[180:183], v[44:47], a[148:151], v[180:183]
ds_read_b64_tr_b16 v[62:63], v5 offset:5120
v_mfma_f32_16x16x32_bf16 v[184:187], v[44:47], a[152:155], v[184:187]
v_mfma_f32_16x16x32_bf16 v[188:191], v[44:47], a[156:159], v[188:191]
v_mfma_f32_16x16x32_bf16 v[64:67], v[48:51], a[160:163], v[64:67]
ds_read_b64_tr_b16 v[40:41], v6 offset:4096
v_mfma_f32_16x16x32_bf16 v[68:71], v[48:51], a[164:167], v[68:71]
ds_read_b64_tr_b16 v[42:43], v6 offset:5120
v_mfma_f32_16x16x32_bf16 v[72:75], v[48:51], a[168:171], v[72:75]
s_waitcnt lgkmcnt(4)
v_mfma_f32_16x16x32_bf16 v[76:79], v[48:51], a[172:175], v[76:79]
v_mfma_f32_16x16x32_bf16 v[80:83], v[52:55], a[160:163], v[80:83]
ds_read_b64_tr_b16 v[44:45], v7 offset:4096
v_mfma_f32_16x16x32_bf16 v[84:87], v[52:55], a[164:167], v[84:87]
ds_read_b64_tr_b16 v[46:47], v7 offset:5120
v_mfma_f32_16x16x32_bf16 v[88:91], v[52:55], a[168:171], v[88:91]
s_waitcnt vmcnt(18)
ds_read_b128 a[192:195], v14 offset:32768
v_mfma_f32_16x16x32_bf16 v[92:95], v[52:55], a[172:175], v[92:95]
v_mfma_f32_16x16x32_bf16 v[96:99], v[56:59], a[160:163], v[96:99]
ds_read_b64_tr_b16 v[48:49], v8 offset:4096
v_mfma_f32_16x16x32_bf16 v[100:103], v[56:59], a[164:167], v[100:103]
ds_read_b64_tr_b16 v[50:51], v8 offset:5120
v_mfma_f32_16x16x32_bf16 v[104:107], v[56:59], a[168:171], v[104:107]
s_waitcnt lgkmcnt(5)
ds_read_b128 a[196:199], v14 offset:34816
v_mfma_f32_16x16x32_bf16 v[108:111], v[56:59], a[172:175], v[108:111]
v_mfma_f32_16x16x32_bf16 v[112:115], v[60:63], a[160:163], v[112:115]
ds_read_b64_tr_b16 v[52:53], v9 offset:4096
v_mfma_f32_16x16x32_bf16 v[116:119], v[60:63], a[164:167], v[116:119]
ds_read_b64_tr_b16 v[54:55], v9 offset:5120
v_mfma_f32_16x16x32_bf16 v[120:123], v[60:63], a[168:171], v[120:123]
ds_read_b128 a[200:203], v14 offset:36864
v_mfma_f32_16x16x32_bf16 v[124:127], v[60:63], a[172:175], v[124:127]
s_barrier
v_mfma_f32_16x16x32_bf16 v[128:131], v[40:43], a[160:163], v[128:131]
ds_read_b64_tr_b16 v[56:57], v2 offset:6144
v_mfma_f32_16x16x32_bf16 v[132:135], v[40:43], a[164:167], v[132:135]
ds_read_b64_tr_b16 v[58:59], v2 offset:7168
v_mfma_f32_16x16x32_bf16 v[136:139], v[40:43], a[168:171], v[136:139]
s_waitcnt lgkmcnt(6)
ds_read_b128 a[204:207], v14 offset:38912
s_add_u32 s18, s101, 128
v_mfma_f32_16x16x32_bf16 v[140:143], v[40:43], a[172:175], v[140:143]
s_and_b32 s18, s18, 1023
s_lshl_b32 s18, s18, 12
s_add_u32 s18, s18, s57
v_mfma_f32_16x16x32_bf16 v[144:147], v[44:47], a[160:163], v[144:147]
s_add_u32 m0, s43, 2048
ds_read_b64_tr_b16 v[60:61], v3 offset:6144
v_mfma_f32_16x16x32_bf16 v[148:151], v[44:47], a[164:167], v[148:151]
buffer_load_dwordx4 v17, s[32:35], s18 offen lds
v_mfma_f32_16x16x32_bf16 v[152:155], v[44:47], a[168:171], v[152:155]
s_add_u32 m0, s43, 3072
ds_read_b64_tr_b16 v[62:63], v3 offset:7168
ds_read_b128 a[208:211], v15 offset:32768
v_mfma_f32_16x16x32_bf16 v[156:159], v[44:47], a[172:175], v[156:159]
s_add_u32 s18, s18, 65536
v_mfma_f32_16x16x32_bf16 v[160:163], v[48:51], a[160:163], v[160:163]
buffer_load_dwordx4 v18, s[32:35], s18 offen lds
v_mfma_f32_16x16x32_bf16 v[164:167], v[48:51], a[164:167], v[164:167]
ds_read_b64_tr_b16 v[40:41], v4 offset:6144
ds_read_b64_tr_b16 v[42:43], v4 offset:7168
v_mfma_f32_16x16x32_bf16 v[168:171], v[48:51], a[168:171], v[168:171]
s_waitcnt lgkmcnt(6)
ds_read_b128 a[212:215], v15 offset:34816
v_mfma_f32_16x16x32_bf16 v[172:175], v[48:51], a[172:175], v[172:175]
v_mfma_f32_16x16x32_bf16 v[176:179], v[52:55], a[160:163], v[176:179]
ds_read_b64_tr_b16 v[44:45], v5 offset:6144
v_mfma_f32_16x16x32_bf16 v[180:183], v[52:55], a[164:167], v[180:183]
ds_read_b64_tr_b16 v[46:47], v5 offset:7168
v_mfma_f32_16x16x32_bf16 v[184:187], v[52:55], a[168:171], v[184:187]
ds_read_b128 a[216:219], v15 offset:36864
v_mfma_f32_16x16x32_bf16 v[188:191], v[52:55], a[172:175], v[188:191]
v_mfma_f32_16x16x32_bf16 v[64:67], v[56:59], a[176:179], v[64:67]
ds_read_b64_tr_b16 v[48:49], v6 offset:6144
v_mfma_f32_16x16x32_bf16 v[68:71], v[56:59], a[180:183], v[68:71]
ds_read_b64_tr_b16 v[50:51], v6 offset:7168
v_mfma_f32_16x16x32_bf16 v[72:75], v[56:59], a[184:187], v[72:75]
s_waitcnt lgkmcnt(6)
ds_read_b128 a[220:223], v15 offset:38912
v_mfma_f32_16x16x32_bf16 v[76:79], v[56:59], a[188:191], v[76:79]
v_mfma_f32_16x16x32_bf16 v[80:83], v[60:63], a[176:179], v[80:83]
ds_read_b64_tr_b16 v[52:53], v7 offset:6144
v_mfma_f32_16x16x32_bf16 v[84:87], v[60:63], a[180:183], v[84:87]
ds_read_b64_tr_b16 v[54:55], v7 offset:7168
v_mfma_f32_16x16x32_bf16 v[88:91], v[60:63], a[184:187], v[88:91]
v_mfma_f32_16x16x32_bf16 v[92:95], v[60:63], a[188:191], v[92:95]
v_mfma_f32_16x16x32_bf16 v[96:99], v[40:43], a[176:179], v[96:99]
ds_read_b64_tr_b16 v[56:57], v8 offset:6144
v_mfma_f32_16x16x32_bf16 v[100:103], v[40:43], a[180:183], v[100:103]
ds_read_b64_tr_b16 v[58:59], v8 offset:7168
v_mfma_f32_16x16x32_bf16 v[104:107], v[40:43], a[184:187], v[104:107]
s_waitcnt lgkmcnt(5)
v_mfma_f32_16x16x32_bf16 v[108:111], v[40:43], a[188:191], v[108:111]
v_mfma_f32_16x16x32_bf16 v[112:115], v[44:47], a[176:179], v[112:115]
ds_read_b64_tr_b16 v[60:61], v9 offset:6144
v_mfma_f32_16x16x32_bf16 v[116:119], v[44:47], a[180:183], v[116:119]
ds_read_b64_tr_b16 v[62:63], v9 offset:7168
v_mfma_f32_16x16x32_bf16 v[120:123], v[44:47], a[184:187], v[120:123]
v_mfma_f32_16x16x32_bf16 v[124:127], v[44:47], a[188:191], v[124:127]
s_barrier
v_mfma_f32_16x16x32_bf16 v[128:131], v[48:51], a[176:179], v[128:131]
ds_read_b64_tr_b16 v[40:41], v2 offset:32768
v_mfma_f32_16x16x32_bf16 v[132:135], v[48:51], a[180:183], v[132:135]
ds_read_b64_tr_b16 v[42:43], v2 offset:33792
v_mfma_f32_16x16x32_bf16 v[136:139], v[48:51], a[184:187], v[136:139]
s_waitcnt lgkmcnt(4)
s_add_u32 s18, s101, 256
s_and_b32 s18, s18, 1023
v_mfma_f32_16x16x32_bf16 v[140:143], v[48:51], a[188:191], v[140:143]
s_lshl_b32 s18, s18, 12
s_add_u32 s18, s18, s57
s_add_u32 m0, s43, 4096
v_mfma_f32_16x16x32_bf16 v[144:147], v[52:55], a[176:179], v[144:147]
buffer_load_dwordx4 v17, s[32:35], s18 offen lds
v_mfma_f32_16x16x32_bf16 v[148:151], v[52:55], a[180:183], v[148:151]
ds_read_b64_tr_b16 v[44:45], v3 offset:32768
ds_read_b64_tr_b16 v[46:47], v3 offset:33792
v_mfma_f32_16x16x32_bf16 v[152:155], v[52:55], a[184:187], v[152:155]
s_add_u32 m0, s43, 5120
s_add_u32 s18, s18, 65536
v_mfma_f32_16x16x32_bf16 v[156:159], v[52:55], a[188:191], v[156:159]
buffer_load_dwordx4 v18, s[32:35], s18 offen lds
v_mfma_f32_16x16x32_bf16 v[160:163], v[56:59], a[176:179], v[160:163]
ds_read_b64_tr_b16 v[48:49], v4 offset:32768
v_mfma_f32_16x16x32_bf16 v[164:167], v[56:59], a[180:183], v[164:167]
ds_read_b64_tr_b16 v[50:51], v4 offset:33792
v_mfma_f32_16x16x32_bf16 v[168:171], v[56:59], a[184:187], v[168:171]
s_waitcnt lgkmcnt(4)
v_mfma_f32_16x16x32_bf16 v[172:175], v[56:59], a[188:191], v[172:175]
v_mfma_f32_16x16x32_bf16 v[176:179], v[60:63], a[176:179], v[176:179]
ds_read_b64_tr_b16 v[52:53], v5 offset:32768
v_mfma_f32_16x16x32_bf16 v[180:183], v[60:63], a[180:183], v[180:183]
ds_read_b64_tr_b16 v[54:55], v5 offset:33792
v_mfma_f32_16x16x32_bf16 v[184:187], v[60:63], a[184:187], v[184:187]
v_mfma_f32_16x16x32_bf16 v[188:191], v[60:63], a[188:191], v[188:191]
v_mfma_f32_16x16x32_bf16 v[64:67], v[40:43], a[192:195], v[64:67]
ds_read_b64_tr_b16 v[56:57], v6 offset:32768
v_mfma_f32_16x16x32_bf16 v[68:71], v[40:43], a[196:199], v[68:71]
ds_read_b64_tr_b16 v[58:59], v6 offset:33792
v_mfma_f32_16x16x32_bf16 v[72:75], v[40:43], a[200:203], v[72:75]
s_waitcnt lgkmcnt(4)
s_add_u32 s59, s101, 768
s_and_b32 s59, s59, 1023
v_mfma_f32_16x16x32_bf16 v[76:79], v[40:43], a[204:207], v[76:79]
s_lshl_b32 s59, s59, 12
s_add_u32 s59, s59, s57
s_add_u32 m0, s43, 65536
v_mfma_f32_16x16x32_bf16 v[80:83], v[44:47], a[192:195], v[80:83]
buffer_load_dwordx4 v17, s[32:35], s59 offen lds
v_mfma_f32_16x16x32_bf16 v[84:87], v[44:47], a[196:199], v[84:87]
ds_read_b64_tr_b16 v[60:61], v7 offset:32768
ds_read_b64_tr_b16 v[62:63], v7 offset:33792
v_mfma_f32_16x16x32_bf16 v[88:91], v[44:47], a[200:203], v[88:91]
s_waitcnt vmcnt(9)
ds_read_b128 a[224:227], v26 offset:0
s_add_u32 m0, s43, 66560
v_mfma_f32_16x16x32_bf16 v[92:95], v[44:47], a[204:207], v[92:95]
s_add_u32 s59, s59, 65536
v_mfma_f32_16x16x32_bf16 v[96:99], v[48:51], a[192:195], v[96:99]
buffer_load_dwordx4 v18, s[32:35], s59 offen lds
v_mfma_f32_16x16x32_bf16 v[100:103], v[48:51], a[196:199], v[100:103]
ds_read_b64_tr_b16 v[40:41], v8 offset:32768
ds_read_b64_tr_b16 v[42:43], v8 offset:33792
v_mfma_f32_16x16x32_bf16 v[104:107], v[48:51], a[200:203], v[104:107]
s_waitcnt lgkmcnt(5)
ds_read_b128 a[228:231], v26 offset:2048
v_mfma_f32_16x16x32_bf16 v[108:111], v[48:51], a[204:207], v[108:111]
v_mfma_f32_16x16x32_bf16 v[112:115], v[52:55], a[192:195], v[112:115]
ds_read_b64_tr_b16 v[44:45], v9 offset:32768
v_mfma_f32_16x16x32_bf16 v[116:119], v[52:55], a[196:199], v[116:119]
ds_read_b64_tr_b16 v[46:47], v9 offset:33792
v_mfma_f32_16x16x32_bf16 v[120:123], v[52:55], a[200:203], v[120:123]
s_add_u32 s59, s101, 896
ds_read_b128 a[232:235], v26 offset:4096
s_and_b32 s59, s59, 1023
v_mfma_f32_16x16x32_bf16 v[124:127], v[52:55], a[204:207], v[124:127]
s_lshl_b32 s59, s59, 12
s_add_u32 s59, s59, s57
s_add_u32 m0, s43, 67584
v_mfma_f32_16x16x32_bf16 v[128:131], v[56:59], a[192:195], v[128:131]
buffer_load_dwordx4 v17, s[32:35], s59 offen lds
v_mfma_f32_16x16x32_bf16 v[132:135], v[56:59], a[196:199], v[132:135]
s_barrier
ds_read_b64_tr_b16 v[48:49], v2 offset:34816
ds_read_b64_tr_b16 v[50:51], v2 offset:35840
v_mfma_f32_16x16x32_bf16 v[136:139], v[56:59], a[200:203], v[136:139]
s_waitcnt lgkmcnt(6)
ds_read_b128 a[236:239], v26 offset:6144
s_add_u32 s18, s101, 384
v_mfma_f32_16x16x32_bf16 v[140:143], v[56:59], a[204:207], v[140:143]
s_and_b32 s18, s18, 1023
s_lshl_b32 s18, s18, 12
s_add_u32 s18, s18, s57
v_mfma_f32_16x16x32_bf16 v[144:147], v[60:63], a[192:195], v[144:147]
s_add_u32 m0, s43, 6144
ds_read_b64_tr_b16 v[52:53], v3 offset:34816
s_add_u32 s59, s59, 65536
v_mfma_f32_16x16x32_bf16 v[148:151], v[60:63], a[196:199], v[148:151]
buffer_load_dwordx4 v17, s[32:35], s18 offen lds
v_mfma_f32_16x16x32_bf16 v[152:155], v[60:63], a[200:203], v[152:155]
s_add_u32 m0, s43, 68608
ds_read_b64_tr_b16 v[54:55], v3 offset:35840
ds_read_b128 a[240:243], v27 offset:0
v_mfma_f32_16x16x32_bf16 v[156:159], v[60:63], a[204:207], v[156:159]
buffer_load_dwordx4 v18, s[32:35], s59 offen lds
v_mfma_f32_16x16x32_bf16 v[160:163], v[40:43], a[192:195], v[160:163]
s_add_u32 m0, s43, 7168
ds_read_b64_tr_b16 v[56:57], v4 offset:34816
s_add_u32 s18, s18, 65536
v_mfma_f32_16x16x32_bf16 v[164:167], v[40:43], a[196:199], v[164:167]
buffer_load_dwordx4 v18, s[32:35], s18 offen lds
v_mfma_f32_16x16x32_bf16 v[168:171], v[40:43], a[200:203], v[168:171]
s_waitcnt lgkmcnt(5)
ds_read_b64_tr_b16 v[58:59], v4 offset:35840
ds_read_b128 a[244:247], v27 offset:2048
v_mfma_f32_16x16x32_bf16 v[172:175], v[40:43], a[204:207], v[172:175]
s_add_u32 s59, s101, 0
s_and_b32 s59, s59, 1023
s_lshl_b32 s59, s59, 12
v_mfma_f32_16x16x32_bf16 v[176:179], v[44:47], a[192:195], v[176:179]
s_add_u32 s59, s59, s57
ds_read_b64_tr_b16 v[60:61], v5 offset:34816
s_add_u32 s59, s59, 128
v_mfma_f32_16x16x32_bf16 v[180:183], v[44:47], a[196:199], v[180:183]
s_add_u32 m0, s43, 98304
ds_read_b64_tr_b16 v[62:63], v5 offset:35840
v_mfma_f32_16x16x32_bf16 v[184:187], v[44:47], a[200:203], v[184:187]
buffer_load_dwordx4 v17, s[32:35], s59 offen lds
v_mfma_f32_16x16x32_bf16 v[188:191], v[44:47], a[204:207], v[188:191]
s_add_u32 m0, s43, 99328
ds_read_b128 a[248:251], v27 offset:4096
s_add_u32 s59, s59, 65536
v_mfma_f32_16x16x32_bf16 v[64:67], v[48:51], a[208:211], v[64:67]
buffer_load_dwordx4 v18, s[32:35], s59 offen lds
v_mfma_f32_16x16x32_bf16 v[68:71], v[48:51], a[212:215], v[68:71]
ds_read_b64_tr_b16 v[40:41], v6 offset:34816
ds_read_b64_tr_b16 v[42:43], v6 offset:35840
v_mfma_f32_16x16x32_bf16 v[72:75], v[48:51], a[216:219], v[72:75]
s_waitcnt lgkmcnt(9)
ds_read_b128 a[252:255], v27 offset:6144
v_mfma_f32_16x16x32_bf16 v[76:79], v[48:51], a[220:223], v[76:79]
v_mfma_f32_16x16x32_bf16 v[80:83], v[52:55], a[208:211], v[80:83]
ds_read_b64_tr_b16 v[44:45], v7 offset:34816
v_mfma_f32_16x16x32_bf16 v[84:87], v[52:55], a[212:215], v[84:87]
ds_read_b64_tr_b16 v[46:47], v7 offset:35840
v_mfma_f32_16x16x32_bf16 v[88:91], v[52:55], a[216:219], v[88:91]
s_waitcnt lgkmcnt(6)
s_add_u32 s59, s101, 128
s_and_b32 s59, s59, 1023
v_mfma_f32_16x16x32_bf16 v[92:95], v[52:55], a[220:223], v[92:95]
s_lshl_b32 s59, s59, 12
s_add_u32 s59, s59, s57
s_add_u32 s59, s59, 128
v_mfma_f32_16x16x32_bf16 v[96:99], v[56:59], a[208:211], v[96:99]
s_add_u32 m0, s43, 100352
ds_read_b64_tr_b16 v[48:49], v8 offset:34816
v_mfma_f32_16x16x32_bf16 v[100:103], v[56:59], a[212:215], v[100:103]
buffer_load_dwordx4 v17, s[32:35], s59 offen lds
v_mfma_f32_16x16x32_bf16 v[104:107], v[56:59], a[216:219], v[104:107]
s_add_u32 m0, s43, 101376
ds_read_b64_tr_b16 v[50:51], v8 offset:35840
s_add_u32 s59, s59, 65536
v_mfma_f32_16x16x32_bf16 v[108:111], v[56:59], a[220:223], v[108:111]
buffer_load_dwordx4 v18, s[32:35], s59 offen lds
v_mfma_f32_16x16x32_bf16 v[112:115], v[60:63], a[208:211], v[112:115]
ds_read_b64_tr_b16 v[52:53], v9 offset:34816
v_mfma_f32_16x16x32_bf16 v[116:119], v[60:63], a[212:215], v[116:119]
ds_read_b64_tr_b16 v[54:55], v9 offset:35840
v_mfma_f32_16x16x32_bf16 v[120:123], v[60:63], a[216:219], v[120:123]
s_waitcnt lgkmcnt(4)
s_load_dwordx4 s[28:31], s[0:1], 64
v_mfma_f32_16x16x32_bf16 v[124:127], v[60:63], a[220:223], v[124:127]
s_barrier
v_mfma_f32_16x16x32_bf16 v[128:131], v[40:43], a[208:211], v[128:131]
ds_read_b64_tr_b16 v[56:57], v2 offset:36864
v_mfma_f32_16x16x32_bf16 v[132:135], v[40:43], a[212:215], v[132:135]
ds_read_b64_tr_b16 v[58:59], v2 offset:37888
v_mfma_f32_16x16x32_bf16 v[136:139], v[40:43], a[216:219], v[136:139]
s_add_u32 s18, s101, 512
s_and_b32 s18, s18, 1023
s_lshl_b32 s18, s18, 12
v_mfma_f32_16x16x32_bf16 v[140:143], v[40:43], a[220:223], v[140:143]
s_add_u32 s18, s18, s57
s_add_u32 m0, s43, 32768
s_add_u32 s59, s101, 256
v_mfma_f32_16x16x32_bf16 v[144:147], v[44:47], a[208:211], v[144:147]
buffer_load_dwordx4 v17, s[32:35], s18 offen lds
v_mfma_f32_16x16x32_bf16 v[148:151], v[44:47], a[212:215], v[148:151]
s_and_b32 s59, s59, 1023
ds_read_b64_tr_b16 v[60:61], v3 offset:36864
ds_read_b64_tr_b16 v[62:63], v3 offset:37888
v_mfma_f32_16x16x32_bf16 v[152:155], v[44:47], a[216:219], v[152:155]
s_waitcnt lgkmcnt(4)
s_lshl_b32 s59, s59, 12
s_add_u32 s59, s59, s57
v_mfma_f32_16x16x32_bf16 v[156:159], v[44:47], a[220:223], v[156:159]
s_add_u32 s59, s59, 128
s_add_u32 m0, s43, 102400
s_add_u32 s18, s18, 65536
v_mfma_f32_16x16x32_bf16 v[160:163], v[48:51], a[208:211], v[160:163]
buffer_load_dwordx4 v17, s[32:35], s59 offen lds
v_mfma_f32_16x16x32_bf16 v[164:167], v[48:51], a[212:215], v[164:167]
s_add_u32 m0, s43, 33792
ds_read_b64_tr_b16 v[40:41], v4 offset:36864
ds_read_b64_tr_b16 v[42:43], v4 offset:37888
v_mfma_f32_16x16x32_bf16 v[168:171], v[48:51], a[216:219], v[168:171]
buffer_load_dwordx4 v18, s[32:35], s18 offen lds
v_mfma_f32_16x16x32_bf16 v[172:175], v[48:51], a[220:223], v[172:175]
s_add_u32 m0, s43, 103424
s_add_u32 s59, s59, 65536
v_mfma_f32_16x16x32_bf16 v[176:179], v[52:55], a[208:211], v[176:179]
buffer_load_dwordx4 v18, s[32:35], s59 offen lds
v_mfma_f32_16x16x32_bf16 v[180:183], v[52:55], a[212:215], v[180:183]
ds_read_b64_tr_b16 v[44:45], v5 offset:36864
ds_read_b64_tr_b16 v[46:47], v5 offset:37888
v_mfma_f32_16x16x32_bf16 v[184:187], v[52:55], a[216:219], v[184:187]
s_waitcnt lgkmcnt(4)
s_add_u32 s59, s101, 384
s_and_b32 s59, s59, 1023
v_mfma_f32_16x16x32_bf16 v[188:191], v[52:55], a[220:223], v[188:191]
s_lshl_b32 s59, s59, 12
s_add_u32 s59, s59, s57
s_add_u32 s59, s59, 128
v_mfma_f32_16x16x32_bf16 v[64:67], v[56:59], a[224:227], v[64:67]
s_add_u32 m0, s43, 104448
ds_read_b64_tr_b16 v[48:49], v6 offset:36864
v_mfma_f32_16x16x32_bf16 v[68:71], v[56:59], a[228:231], v[68:71]
buffer_load_dwordx4 v17, s[32:35], s59 offen lds
v_mfma_f32_16x16x32_bf16 v[72:75], v[56:59], a[232:235], v[72:75]
s_add_u32 m0, s43, 105472
ds_read_b64_tr_b16 v[50:51], v6 offset:37888
s_add_u32 s59, s59, 65536
v_mfma_f32_16x16x32_bf16 v[76:79], v[56:59], a[236:239], v[76:79]
buffer_load_dwordx4 v18, s[32:35], s59 offen lds
v_mfma_f32_16x16x32_bf16 v[80:83], v[60:63], a[224:227], v[80:83]
ds_read_b64_tr_b16 v[52:53], v7 offset:36864
v_mfma_f32_16x16x32_bf16 v[84:87], v[60:63], a[228:231], v[84:87]
ds_read_b64_tr_b16 v[54:55], v7 offset:37888
v_mfma_f32_16x16x32_bf16 v[88:91], v[60:63], a[232:235], v[88:91]
s_waitcnt lgkmcnt(4)
v_mfma_f32_16x16x32_bf16 v[92:95], v[60:63], a[236:239], v[92:95]
v_mfma_f32_16x16x32_bf16 v[96:99], v[40:43], a[224:227], v[96:99]
ds_read_b64_tr_b16 v[56:57], v8 offset:36864
v_mfma_f32_16x16x32_bf16 v[100:103], v[40:43], a[228:231], v[100:103]
ds_read_b64_tr_b16 v[58:59], v8 offset:37888
v_mfma_f32_16x16x32_bf16 v[104:107], v[40:43], a[232:235], v[104:107]
s_add_u32 s59, s101, 512
s_and_b32 s59, s59, 1023
s_lshl_b32 s59, s59, 12
v_mfma_f32_16x16x32_bf16 v[108:111], v[40:43], a[236:239], v[108:111]
s_add_u32 s59, s59, s57
s_add_u32 s59, s59, 128
s_add_u32 m0, s43, 131072
v_mfma_f32_16x16x32_bf16 v[112:115], v[44:47], a[224:227], v[112:115]
buffer_load_dwordx4 v17, s[32:35], s59 offen lds
v_mfma_f32_16x16x32_bf16 v[116:119], v[44:47], a[228:231], v[116:119]
ds_read_b64_tr_b16 v[60:61], v9 offset:36864
ds_read_b64_tr_b16 v[62:63], v9 offset:37888
v_mfma_f32_16x16x32_bf16 v[120:123], v[44:47], a[232:235], v[120:123]
s_waitcnt lgkmcnt(4)
s_add_u32 m0, s43, 132096
s_add_u32 s59, s59, 65536
v_mfma_f32_16x16x32_bf16 v[124:127], v[44:47], a[236:239], v[124:127]
buffer_load_dwordx4 v18, s[32:35], s59 offen lds
v_mfma_f32_16x16x32_bf16 v[128:131], v[48:51], a[224:227], v[128:131]
s_waitcnt vmcnt(24)
s_barrier
ds_read_b64_tr_b16 v[40:41], v2 offset:38912
v_mfma_f32_16x16x32_bf16 v[132:135], v[48:51], a[228:231], v[132:135]
ds_read_b64_tr_b16 v[42:43], v2 offset:39936
v_mfma_f32_16x16x32_bf16 v[136:139], v[48:51], a[232:235], v[136:139]
s_add_u32 s18, s101, 640
s_and_b32 s18, s18, 1023
s_lshl_b32 s18, s18, 12
v_mfma_f32_16x16x32_bf16 v[140:143], v[48:51], a[236:239], v[140:143]
s_add_u32 s18, s18, s57
s_add_u32 m0, s43, 34816
v_mfma_f32_16x16x32_bf16 v[144:147], v[52:55], a[224:227], v[144:147]
buffer_load_dwordx4 v17, s[32:35], s18 offen lds
v_mfma_f32_16x16x32_bf16 v[148:151], v[52:55], a[228:231], v[148:151]
ds_read_b64_tr_b16 v[44:45], v3 offset:38912
ds_read_b64_tr_b16 v[46:47], v3 offset:39936
v_mfma_f32_16x16x32_bf16 v[152:155], v[52:55], a[232:235], v[152:155]
s_waitcnt lgkmcnt(4)
s_add_u32 m0, s43, 35840
s_add_u32 s18, s18, 65536
v_mfma_f32_16x16x32_bf16 v[156:159], v[52:55], a[236:239], v[156:159]
buffer_load_dwordx4 v18, s[32:35], s18 offen lds
v_mfma_f32_16x16x32_bf16 v[160:163], v[56:59], a[224:227], v[160:163]
s_add_u32 s59, s101, 640
ds_read_b64_tr_b16 v[48:49], v4 offset:38912
s_and_b32 s59, s59, 1023
v_mfma_f32_16x16x32_bf16 v[164:167], v[56:59], a[228:231], v[164:167]
s_lshl_b32 s59, s59, 12
ds_read_b64_tr_b16 v[50:51], v4 offset:39936
s_add_u32 s59, s59, s57
v_mfma_f32_16x16x32_bf16 v[168:171], v[56:59], a[232:235], v[168:171]
s_add_u32 s59, s59, 128
s_add_u32 m0, s43, 133120
v_mfma_f32_16x16x32_bf16 v[172:175], v[56:59], a[236:239], v[172:175]
buffer_load_dwordx4 v17, s[32:35], s59 offen lds
v_mfma_f32_16x16x32_bf16 v[176:179], v[60:63], a[224:227], v[176:179]
s_add_u32 m0, s43, 134144
ds_read_b64_tr_b16 v[52:53], v5 offset:38912
s_add_u32 s59, s59, 65536
v_mfma_f32_16x16x32_bf16 v[180:183], v[60:63], a[228:231], v[180:183]
buffer_load_dwordx4 v18, s[32:35], s59 offen lds
v_mfma_f32_16x16x32_bf16 v[184:187], v[60:63], a[232:235], v[184:187]
s_waitcnt lgkmcnt(3)
ds_read_b64_tr_b16 v[54:55], v5 offset:39936
v_lshlrev_b32 v33, 2, v0
v_mfma_f32_16x16x32_bf16 v[188:191], v[60:63], a[236:239], v[188:191]
s_waitcnt lgkmcnt(0)
v_mfma_f32_16x16x32_bf16 v[64:67], v[40:43], a[240:243], v[64:67]
buffer_load_dword v29, v33, s[4:7], s3 offen offset:0 sc0 sc1
v_mfma_f32_16x16x32_bf16 v[68:71], v[40:43], a[244:247], v[68:71]
ds_read_b64_tr_b16 v[56:57], v6 offset:38912
ds_read_b64_tr_b16 v[58:59], v6 offset:39936
v_mfma_f32_16x16x32_bf16 v[72:75], v[40:43], a[248:251], v[72:75]
s_add_u32 s59, s101, 768
s_and_b32 s59, s59, 1023
s_lshl_b32 s59, s59, 12
v_mfma_f32_16x16x32_bf16 v[76:79], v[40:43], a[252:255], v[76:79]
s_add_u32 s59, s59, s57
s_add_u32 s59, s59, 128
s_add_u32 m0, s43, 135168
v_mfma_f32_16x16x32_bf16 v[80:83], v[44:47], a[240:243], v[80:83]
buffer_load_dwordx4 v17, s[32:35], s59 offen lds
v_mfma_f32_16x16x32_bf16 v[84:87], v[44:47], a[244:247], v[84:87]
ds_read_b64_tr_b16 v[60:61], v7 offset:38912
ds_read_b64_tr_b16 v[62:63], v7 offset:39936
v_mfma_f32_16x16x32_bf16 v[88:91], v[44:47], a[248:251], v[88:91]
s_add_u32 m0, s43, 136192
s_add_u32 s59, s59, 65536
v_lshrrev_b32 v23, 3, v0
v_mfma_f32_16x16x32_bf16 v[92:95], v[44:47], a[252:255], v[92:95]
buffer_load_dwordx4 v18, s[32:35], s59 offen lds
v_mfma_f32_16x16x32_bf16 v[96:99], v[48:51], a[240:243], v[96:99]
ds_read_b64_tr_b16 v[40:41], v8 offset:38912
v_and_b32 v24, 7, v0
v_mfma_f32_16x16x32_bf16 v[100:103], v[48:51], a[244:247], v[100:103]
ds_read_b64_tr_b16 v[42:43], v8 offset:39936
v_mul_u32_u24 v23, 7168, v23
v_mfma_f32_16x16x32_bf16 v[104:107], v[48:51], a[248:251], v[104:107]
s_min_u32 s51, s40, 27
v_lshl_add_u32 v23, v24, 4, v23
s_mul_i32 s49, s45, 57344
v_mfma_f32_16x16x32_bf16 v[108:111], v[48:51], a[252:255], v[108:111]
s_lshl_b32 s50, s51, 7
s_add_u32 s49, s49, s50
v_add_u32 v23, s49, v23
v_mfma_f32_16x16x32_bf16 v[112:115], v[52:55], a[240:243], v[112:115]
ds_read_b64_tr_b16 v[44:45], v9 offset:38912
v_mfma_f32_16x16x32_bf16 v[116:119], v[52:55], a[244:247], v[116:119]
ds_read_b64_tr_b16 v[46:47], v9 offset:39936
v_mfma_f32_16x16x32_bf16 v[120:123], v[52:55], a[248:251], v[120:123]
s_waitcnt lgkmcnt(4)
s_add_u32 s59, s101, 896
s_and_b32 s59, s59, 1023
v_mfma_f32_16x16x32_bf16 v[124:127], v[52:55], a[252:255], v[124:127]
s_lshl_b32 s59, s59, 12
s_add_u32 s59, s59, s57
s_add_u32 s59, s59, 128
v_mfma_f32_16x16x32_bf16 v[128:131], v[56:59], a[240:243], v[128:131]
s_add_u32 m0, s43, 137216
v_mfma_f32_16x16x32_bf16 v[132:135], v[56:59], a[244:247], v[132:135]
buffer_load_dwordx4 v17, s[32:35], s59 offen lds
v_mfma_f32_16x16x32_bf16 v[136:139], v[56:59], a[248:251], v[136:139]
s_waitcnt vmcnt(30)
s_barrier
ds_read_b64_tr_b16 v[48:49], v10 offset:0
v_mfma_f32_16x16x32_bf16 v[140:143], v[56:59], a[252:255], v[140:143]
s_add_u32 m0, s43, 138240
ds_read_b64_tr_b16 v[50:51], v10 offset:512
s_add_u32 s59, s59, 65536
v_mfma_f32_16x16x32_bf16 v[144:147], v[60:63], a[240:243], v[144:147]
buffer_load_dwordx4 v18, s[32:35], s59 offen lds
v_mfma_f32_16x16x32_bf16 v[148:151], v[60:63], a[244:247], v[148:151]
s_add_u32 m0, s43, 69632
ds_read_b64_tr_b16 v[52:53], v11 offset:0
ds_read_b64_tr_b16 v[54:55], v11 offset:512
v_mfma_f32_16x16x32_bf16 v[152:155], v[60:63], a[248:251], v[152:155]
global_load_lds_dwordx4 v23, s[28:29] offset:0
v_mfma_f32_16x16x32_bf16 v[156:159], v[60:63], a[252:255], v[156:159]
s_waitcnt lgkmcnt(4)
v_mfma_f32_16x16x32_bf16 v[160:163], v[40:43], a[240:243], v[160:163]
ds_read_b64_tr_b16 v[56:57], v12 offset:0
v_mfma_f32_16x16x32_bf16 v[164:167], v[40:43], a[244:247], v[164:167]
ds_read_b64_tr_b16 v[58:59], v12 offset:512
v_mfma_f32_16x16x32_bf16 v[168:171], v[40:43], a[248:251], v[168:171]
s_add_u32 m0, s43, 67072
v_mfma_f32_16x16x32_bf16 v[172:175], v[40:43], a[252:255], v[172:175]
global_load_lds_dwordx4 v23, s[28:29] offset:3584
v_mfma_f32_16x16x32_bf16 v[176:179], v[44:47], a[240:243], v[176:179]
ds_read_b64_tr_b16 v[60:61], v13 offset:0
v_mfma_f32_16x16x32_bf16 v[180:183], v[44:47], a[244:247], v[180:183]
ds_read_b64_tr_b16 v[62:63], v13 offset:512
v_mfma_f32_16x16x32_bf16 v[184:187], v[44:47], a[248:251], v[184:187]
s_waitcnt lgkmcnt(4)
v_mfma_f32_16x16x32_bf16 v[188:191], v[44:47], a[252:255], v[188:191]
v_mfma_f32_16x16x32_bf16 v[192:195], a[0:3], v[48:51], 0
s_add_u32 m0, s43, 71680
ds_read_b64_tr_b16 v[40:41], v10 offset:16384
v_mfma_f32_16x16x32_bf16 v[196:199], a[4:7], v[48:51], 0
global_load_lds_dwordx4 v23, s[30:31] offset:0
v_mfma_f32_16x16x32_bf16 v[200:203], a[8:11], v[48:51], 0
ds_read_b64_tr_b16 v[42:43], v10 offset:16896
v_mfma_f32_16x16x32_bf16 v[204:207], a[12:15], v[48:51], 0
v_mfma_f32_16x16x32_bf16 v[208:211], a[0:3], v[52:55], 0
ds_read_b64_tr_b16 v[44:45], v11 offset:16384
v_mul_f32 v64, s63, v64
v_mfma_f32_16x16x32_bf16 v[212:215], a[4:7], v[52:55], 0
v_mul_f32 v65, s63, v65
ds_read_b64_tr_b16 v[46:47], v11 offset:16896
v_mfma_f32_16x16x32_bf16 v[216:219], a[8:11], v[52:55], 0
s_waitcnt lgkmcnt(4)
v_mul_f32 v66, s63, v66
v_mul_f32 v67, s63, v67
v_mfma_f32_16x16x32_bf16 v[220:223], a[12:15], v[52:55], 0
s_add_u32 m0, s43, 69120
v_mul_f32 v80, s63, v80
v_mul_f32 v81, s63, v81
v_mfma_f32_16x16x32_bf16 v[224:227], a[0:3], v[56:59], 0
global_load_lds_dwordx4 v23, s[30:31] offset:3584
v_mfma_f32_16x16x32_bf16 v[228:231], a[4:7], v[56:59], 0
s_mov_b32 s24, s12
v_mul_f32 v82, s63, v82
v_mul_f32 v83, s63, v83
v_mfma_f32_16x16x32_bf16 v[232:235], a[8:11], v[56:59], 0
s_and_b32 s25, s13, 0xffff
ds_read_b64_tr_b16 v[48:49], v12 offset:16384
v_cvt_pk_bf16_f32 v64, v64, v65
v_mfma_f32_16x16x32_bf16 v[236:239], a[12:15], v[56:59], 0
s_add_u32 s62, s58, 0
v_cvt_pk_bf16_f32 v65, v66, v67
ds_read_b64_tr_b16 v[50:51], v12 offset:16896
v_mfma_f32_16x16x32_bf16 v[240:243], a[0:3], v[60:63], 0
s_mov_b32 s26, 4194304
v_cvt_pk_bf16_f32 v66, v80, v81
v_cvt_pk_bf16_f32 v67, v82, v83
v_mfma_f32_16x16x32_bf16 v[244:247], a[4:7], v[60:63], 0
buffer_store_dwordx4 v[64:67], v21, s[36:39], s62 offen sc1
v_mfma_f32_16x16x32_bf16 v[248:251], a[8:11], v[60:63], 0
s_waitcnt lgkmcnt(2)
v_add_u32 v2, 0x18000, v2
ds_read_b64_tr_b16 v[52:53], v13 offset:16384
v_mfma_f32_16x16x32_bf16 v[252:255], a[12:15], v[60:63], 0
v_add_u32 v3, 0x18000, v3
ds_read_b64_tr_b16 v[54:55], v13 offset:16896
v_mfma_f32_16x16x32_bf16 v[192:195], a[16:19], v[40:43], v[192:195]
s_waitcnt vmcnt(34)
v_add_u32 v4, 0x18000, v4
v_add_u32 v5, 0x18000, v5
v_mfma_f32_16x16x32_bf16 v[196:199], a[20:23], v[40:43], v[196:199]
s_barrier
v_add_u32 v6, 0x18000, v6
ds_read_b64_tr_b16 v[56:57], v10 offset:2048
v_mfma_f32_16x16x32_bf16 v[200:203], a[24:27], v[40:43], v[200:203]
v_add_u32 v7, 0x18000, v7
ds_read_b64_tr_b16 v[58:59], v10 offset:2560
v_mfma_f32_16x16x32_bf16 v[204:207], a[28:31], v[40:43], v[204:207]
v_add_u32 v8, 0x18000, v8
v_add_u32 v9, 0x18000, v9
v_mfma_f32_16x16x32_bf16 v[208:211], a[16:19], v[44:47], v[208:211]
v_subrev_u32 v14, 0x10000, v14
ds_read_b64_tr_b16 v[60:61], v11 offset:2048
v_mfma_f32_16x16x32_bf16 v[212:215], a[20:23], v[44:47], v[212:215]
v_subrev_u32 v15, 0x10000, v15
ds_read_b64_tr_b16 v[62:63], v11 offset:2560
v_mfma_f32_16x16x32_bf16 v[216:219], a[24:27], v[44:47], v[216:219]
s_waitcnt lgkmcnt(6)
v_subrev_u32 v26, 0x10000, v26
v_subrev_u32 v27, 0x10000, v27
v_mfma_f32_16x16x32_bf16 v[220:223], a[28:31], v[44:47], v[220:223]
v_mfma_f32_16x16x32_bf16 v[224:227], a[16:19], v[48:51], v[224:227]
ds_read_b64_tr_b16 v[40:41], v12 offset:2048
v_mul_f32 v68, s63, v68
v_mfma_f32_16x16x32_bf16 v[228:231], a[20:23], v[48:51], v[228:231]
v_mul_f32 v69, s63, v69
ds_read_b64_tr_b16 v[42:43], v12 offset:2560
v_mfma_f32_16x16x32_bf16 v[232:235], a[24:27], v[48:51], v[232:235]
s_waitcnt lgkmcnt(6)
v_mul_f32 v70, s63, v70
v_mul_f32 v71, s63, v71
v_mfma_f32_16x16x32_bf16 v[236:239], a[28:31], v[48:51], v[236:239]
v_mul_f32 v84, s63, v84
v_mul_f32 v85, s63, v85
v_mfma_f32_16x16x32_bf16 v[240:243], a[16:19], v[52:55], v[240:243]
v_mul_f32 v86, s63, v86
v_mul_f32 v87, s63, v87
v_mfma_f32_16x16x32_bf16 v[244:247], a[20:23], v[52:55], v[244:247]
ds_read_b64_tr_b16 v[44:45], v13 offset:2048
v_cvt_pk_bf16_f32 v68, v68, v69
v_mfma_f32_16x16x32_bf16 v[248:251], a[24:27], v[52:55], v[248:251]
s_waitcnt lgkmcnt(3)
v_cvt_pk_bf16_f32 v69, v70, v71
ds_read_b64_tr_b16 v[46:47], v13 offset:2560
v_mfma_f32_16x16x32_bf16 v[252:255], a[28:31], v[52:55], v[252:255]
s_add_u32 s62, s58, 4096
v_cvt_pk_bf16_f32 v70, v84, v85
v_cvt_pk_bf16_f32 v71, v86, v87
v_mfma_f32_16x16x32_bf16 v[192:195], a[32:35], v[56:59], v[192:195]
buffer_store_dwordx4 v[68:71], v21, s[36:39], s62 offen sc1
v_mfma_f32_16x16x32_bf16 v[196:199], a[36:39], v[56:59], v[196:199]
ds_read_b64_tr_b16 v[48:49], v10 offset:18432
ds_read_b64_tr_b16 v[50:51], v10 offset:18944
v_mfma_f32_16x16x32_bf16 v[200:203], a[40:43], v[56:59], v[200:203]
v_mfma_f32_16x16x32_bf16 v[204:207], a[44:47], v[56:59], v[204:207]
v_mfma_f32_16x16x32_bf16 v[208:211], a[32:35], v[60:63], v[208:211]
ds_read_b64_tr_b16 v[52:53], v11 offset:18432
v_mfma_f32_16x16x32_bf16 v[212:215], a[36:39], v[60:63], v[212:215]
ds_read_b64_tr_b16 v[54:55], v11 offset:18944
v_mfma_f32_16x16x32_bf16 v[216:219], a[40:43], v[60:63], v[216:219]
s_waitcnt lgkmcnt(6)
v_mfma_f32_16x16x32_bf16 v[220:223], a[44:47], v[60:63], v[220:223]
v_mfma_f32_16x16x32_bf16 v[224:227], a[32:35], v[40:43], v[224:227]
ds_read_b64_tr_b16 v[56:57], v12 offset:18432
v_mfma_f32_16x16x32_bf16 v[228:231], a[36:39], v[40:43], v[228:231]
ds_read_b64_tr_b16 v[58:59], v12 offset:18944
v_mfma_f32_16x16x32_bf16 v[232:235], a[40:43], v[40:43], v[232:235]
s_waitcnt lgkmcnt(4)
v_mfma_f32_16x16x32_bf16 v[236:239], a[44:47], v[40:43], v[236:239]
v_mfma_f32_16x16x32_bf16 v[240:243], a[32:35], v[44:47], v[240:243]
ds_read_b64_tr_b16 v[60:61], v13 offset:18432
v_mul_f32 v72, s63, v72
v_mfma_f32_16x16x32_bf16 v[244:247], a[36:39], v[44:47], v[244:247]
v_mul_f32 v73, s63, v73
ds_read_b64_tr_b16 v[62:63], v13 offset:18944
v_mfma_f32_16x16x32_bf16 v[248:251], a[40:43], v[44:47], v[248:251]
v_mul_f32 v74, s63, v74
v_mul_f32 v75, s63, v75
v_mfma_f32_16x16x32_bf16 v[252:255], a[44:47], v[44:47], v[252:255]
s_waitcnt vmcnt(33)
v_mul_f32 v88, s63, v88
v_mul_f32 v89, s63, v89
v_mfma_f32_16x16x32_bf16 v[192:195], a[48:51], v[48:51], v[192:195]
s_barrier
v_mul_f32 v90, s63, v90
v_mul_f32 v91, s63, v91
v_mfma_f32_16x16x32_bf16 v[196:199], a[52:55], v[48:51], v[196:199]
ds_read_b64_tr_b16 v[40:41], v10 offset:4096
v_cvt_pk_bf16_f32 v72, v72, v73
v_mfma_f32_16x16x32_bf16 v[200:203], a[56:59], v[48:51], v[200:203]
s_waitcnt lgkmcnt(3)
v_cvt_pk_bf16_f32 v73, v74, v75
ds_read_b64_tr_b16 v[42:43], v10 offset:4608
v_mfma_f32_16x16x32_bf16 v[204:207], a[60:63], v[48:51], v[204:207]
s_add_u32 s62, s58, 8192
v_cvt_pk_bf16_f32 v74, v88, v89
v_cvt_pk_bf16_f32 v75, v90, v91
v_mfma_f32_16x16x32_bf16 v[208:211], a[48:51], v[52:55], v[208:211]
buffer_store_dwordx4 v[72:75], v21, s[36:39], s62 offen sc1
v_mfma_f32_16x16x32_bf16 v[212:215], a[52:55], v[52:55], v[212:215]
ds_read_b64_tr_b16 v[44:45], v11 offset:4096
ds_read_b64_tr_b16 v[46:47], v11 offset:4608
v_mfma_f32_16x16x32_bf16 v[216:219], a[56:59], v[52:55], v[216:219]
v_mfma_f32_16x16x32_bf16 v[220:223], a[60:63], v[52:55], v[220:223]
v_mfma_f32_16x16x32_bf16 v[224:227], a[48:51], v[56:59], v[224:227]
ds_read_b64_tr_b16 v[48:49], v12 offset:4096
v_mfma_f32_16x16x32_bf16 v[228:231], a[52:55], v[56:59], v[228:231]
ds_read_b64_tr_b16 v[50:51], v12 offset:4608
v_mfma_f32_16x16x32_bf16 v[232:235], a[56:59], v[56:59], v[232:235]
s_waitcnt lgkmcnt(6)
v_mfma_f32_16x16x32_bf16 v[236:239], a[60:63], v[56:59], v[236:239]
v_mfma_f32_16x16x32_bf16 v[240:243], a[48:51], v[60:63], v[240:243]
ds_read_b64_tr_b16 v[52:53], v13 offset:4096
v_mfma_f32_16x16x32_bf16 v[244:247], a[52:55], v[60:63], v[244:247]
ds_read_b64_tr_b16 v[54:55], v13 offset:4608
v_mfma_f32_16x16x32_bf16 v[248:251], a[56:59], v[60:63], v[248:251]
s_waitcnt lgkmcnt(4)
v_mfma_f32_16x16x32_bf16 v[252:255], a[60:63], v[60:63], v[252:255]
v_mfma_f32_16x16x32_bf16 v[192:195], a[64:67], v[40:43], v[192:195]
ds_read_b64_tr_b16 v[56:57], v10 offset:20480
v_mul_f32 v76, s63, v76
v_mfma_f32_16x16x32_bf16 v[196:199], a[68:71], v[40:43], v[196:199]
v_mul_f32 v77, s63, v77
ds_read_b64_tr_b16 v[58:59], v10 offset:20992
v_mfma_f32_16x16x32_bf16 v[200:203], a[72:75], v[40:43], v[200:203]
v_mul_f32 v78, s63, v78
v_mul_f32 v79, s63, v79
v_mfma_f32_16x16x32_bf16 v[204:207], a[76:79], v[40:43], v[204:207]
v_mul_f32 v92, s63, v92
v_mul_f32 v93, s63, v93
v_mfma_f32_16x16x32_bf16 v[208:211], a[64:67], v[44:47], v[208:211]
v_mul_f32 v94, s63, v94
v_mul_f32 v95, s63, v95
v_mfma_f32_16x16x32_bf16 v[212:215], a[68:71], v[44:47], v[212:215]
ds_read_b64_tr_b16 v[60:61], v11 offset:20480
v_cvt_pk_bf16_f32 v76, v76, v77
v_mfma_f32_16x16x32_bf16 v[216:219], a[72:75], v[44:47], v[216:219]
s_waitcnt lgkmcnt(3)
v_cvt_pk_bf16_f32 v77, v78, v79
ds_read_b64_tr_b16 v[62:63], v11 offset:20992
v_mfma_f32_16x16x32_bf16 v[220:223], a[76:79], v[44:47], v[220:223]
s_add_u32 s62, s58, 12288
v_cvt_pk_bf16_f32 v78, v92, v93
v_cvt_pk_bf16_f32 v79, v94, v95
v_mfma_f32_16x16x32_bf16 v[224:227], a[64:67], v[48:51], v[224:227]
buffer_store_dwordx4 v[76:79], v21, s[36:39], s62 offen sc1
v_mfma_f32_16x16x32_bf16 v[228:231], a[68:71], v[48:51], v[228:231]
ds_read_b64_tr_b16 v[40:41], v12 offset:20480
ds_read_b64_tr_b16 v[42:43], v12 offset:20992
v_mfma_f32_16x16x32_bf16 v[232:235], a[72:75], v[48:51], v[232:235]
v_mfma_f32_16x16x32_bf16 v[236:239], a[76:79], v[48:51], v[236:239]
v_mfma_f32_16x16x32_bf16 v[240:243], a[64:67], v[52:55], v[240:243]
ds_read_b64_tr_b16 v[44:45], v13 offset:20480
s_lshl_b32 s48, s42, 11
v_mfma_f32_16x16x32_bf16 v[244:247], a[68:71], v[52:55], v[244:247]
ds_read_b64_tr_b16 v[46:47], v13 offset:20992
s_add_u32 s48, s48, 50331648
v_mfma_f32_16x16x32_bf16 v[248:251], a[72:75], v[52:55], v[248:251]
s_waitcnt lgkmcnt(6)
v_mfma_f32_16x16x32_bf16 v[252:255], a[76:79], v[52:55], v[252:255]
s_waitcnt vmcnt(29)
s_waitcnt vmcnt(12)
v_or_b32 v29, s14, v29
v_cmp_ne_u32 vcc, -1, v29
s_cbranch_vccnz L_rstub_KN
L_rback_KN:
v_mfma_f32_16x16x32_bf16 v[192:195], a[80:83], v[56:59], v[192:195]
s_barrier
ds_read_b64_tr_b16 v[48:49], v10 offset:6144
v_mfma_f32_16x16x32_bf16 v[196:199], a[84:87], v[56:59], v[196:199]
buffer_load_dwordx4 v[32:35], v21, s[36:39], s48 offen offset:0 sc0 sc1
v_mfma_f32_16x16x32_bf16 v[200:203], a[88:91], v[56:59], v[200:203]
buffer_load_dwordx4 v[36:39], v21, s[36:39], s48 offen offset:1024 sc0 sc1
v_mfma_f32_16x16x32_bf16 v[204:207], a[92:95], v[56:59], v[204:207]
s_waitcnt lgkmcnt(3)
ds_read_b64_tr_b16 v[50:51], v10 offset:6656
v_mfma_f32_16x16x32_bf16 v[208:211], a[80:83], v[60:63], v[208:211]
ds_read_b64_tr_b16 v[52:53], v11 offset:6144
v_mul_f32 v96, s63, v96
v_mfma_f32_16x16x32_bf16 v[212:215], a[84:87], v[60:63], v[212:215]
v_mul_f32 v97, s63, v97
ds_read_b64_tr_b16 v[54:55], v11 offset:6656
v_mfma_f32_16x16x32_bf16 v[216:219], a[88:91], v[60:63], v[216:219]
v_mul_f32 v98, s63, v98
v_mul_f32 v99, s63, v99
v_mfma_f32_16x16x32_bf16 v[220:223], a[92:95], v[60:63], v[220:223]
v_mul_f32 v112, s63, v112
v_mul_f32 v113, s63, v113
v_mfma_f32_16x16x32_bf16 v[224:227], a[80:83], v[40:43], v[224:227]
v_mul_f32 v114, s63, v114
v_mul_f32 v115, s63, v115
v_mfma_f32_16x16x32_bf16 v[228:231], a[84:87], v[40:43], v[228:231]
ds_read_b64_tr_b16 v[56:57], v12 offset:6144
v_cvt_pk_bf16_f32 v96, v96, v97
v_mfma_f32_16x16x32_bf16 v[232:235], a[88:91], v[40:43], v[232:235]
s_waitcnt lgkmcnt(5)
v_cvt_pk_bf16_f32 v97, v98, v99
ds_read_b64_tr_b16 v[58:59], v12 offset:6656
v_mfma_f32_16x16x32_bf16 v[236:239], a[92:95], v[40:43], v[236:239]
s_add_u32 s62, s58, 1024
v_cvt_pk_bf16_f32 v98, v112, v113
v_cvt_pk_bf16_f32 v99, v114, v115
v_mfma_f32_16x16x32_bf16 v[240:243], a[80:83], v[44:47], v[240:243]
buffer_store_dwordx4 v[96:99], v21, s[36:39], s62 offen sc1
v_mfma_f32_16x16x32_bf16 v[244:247], a[84:87], v[44:47], v[244:247]
ds_read_b64_tr_b16 v[60:61], v13 offset:6144
ds_read_b64_tr_b16 v[62:63], v13 offset:6656
v_mfma_f32_16x16x32_bf16 v[248:251], a[88:91], v[44:47], v[248:251]
s_waitcnt lgkmcnt(4)
v_mfma_f32_16x16x32_bf16 v[252:255], a[92:95], v[44:47], v[252:255]
v_mfma_f32_16x16x32_bf16 v[192:195], a[96:99], v[48:51], v[192:195]
ds_read_b64_tr_b16 v[40:41], v10 offset:22528
v_mfma_f32_16x16x32_bf16 v[196:199], a[100:103], v[48:51], v[196:199]
ds_read_b64_tr_b16 v[42:43], v10 offset:23040
v_mfma_f32_16x16x32_bf16 v[200:203], a[104:107], v[48:51], v[200:203]
v_mfma_f32_16x16x32_bf16 v[204:207], a[108:111], v[48:51], v[204:207]
v_mfma_f32_16x16x32_bf16 v[208:211], a[96:99], v[52:55], v[208:211]
ds_read_b64_tr_b16 v[44:45], v11 offset:22528
v_mfma_f32_16x16x32_bf16 v[212:215], a[100:103], v[52:55], v[212:215]
ds_read_b64_tr_b16 v[46:47], v11 offset:23040
v_mfma_f32_16x16x32_bf16 v[216:219], a[104:107], v[52:55], v[216:219]
s_waitcnt lgkmcnt(4)
v_mfma_f32_16x16x32_bf16 v[220:223], a[108:111], v[52:55], v[220:223]
v_mfma_f32_16x16x32_bf16 v[224:227], a[96:99], v[56:59], v[224:227]
ds_read_b64_tr_b16 v[48:49], v12 offset:22528
v_mul_f32 v100, s63, v100
v_mfma_f32_16x16x32_bf16 v[228:231], a[100:103], v[56:59], v[228:231]
v_mul_f32 v101, s63, v101
ds_read_b64_tr_b16 v[50:51], v12 offset:23040
v_mfma_f32_16x16x32_bf16 v[232:235], a[104:107], v[56:59], v[232:235]
v_mul_f32 v102, s63, v102
v_mul_f32 v103, s63, v103
v_mfma_f32_16x16x32_bf16 v[236:239], a[108:111], v[56:59], v[236:239]
v_mul_f32 v116, s63, v116
v_mul_f32 v117, s63, v117
v_mfma_f32_16x16x32_bf16 v[240:243], a[96:99], v[60:63], v[240:243]
v_mul_f32 v118, s63, v118
v_mul_f32 v119, s63, v119
v_mfma_f32_16x16x32_bf16 v[244:247], a[100:103], v[60:63], v[244:247]
ds_read_b64_tr_b16 v[52:53], v13 offset:22528
v_cvt_pk_bf16_f32 v100, v100, v101
v_mfma_f32_16x16x32_bf16 v[248:251], a[104:107], v[60:63], v[248:251]
s_waitcnt lgkmcnt(3)
v_cvt_pk_bf16_f32 v101, v102, v103
ds_read_b64_tr_b16 v[54:55], v13 offset:23040
v_mfma_f32_16x16x32_bf16 v[252:255], a[108:111], v[60:63], v[252:255]
s_add_u32 s62, s58, 5120
v_cvt_pk_bf16_f32 v102, v116, v117
v_cvt_pk_bf16_f32 v103, v118, v119
v_mfma_f32_16x16x32_bf16 v[192:195], a[112:115], v[40:43], v[192:195]
buffer_store_dwordx4 v[100:103], v21, s[36:39], s62 offen sc1
v_mfma_f32_16x16x32_bf16 v[196:199], a[116:119], v[40:43], v[196:199]
s_barrier
ds_read_b64_tr_b16 v[56:57], v10 offset:32768
ds_read_b64_tr_b16 v[58:59], v10 offset:33280
v_mfma_f32_16x16x32_bf16 v[200:203], a[120:123], v[40:43], v[200:203]
v_mfma_f32_16x16x32_bf16 v[204:207], a[124:127], v[40:43], v[204:207]
v_mfma_f32_16x16x32_bf16 v[208:211], a[112:115], v[44:47], v[208:211]
ds_read_b64_tr_b16 v[60:61], v11 offset:32768
v_mfma_f32_16x16x32_bf16 v[212:215], a[116:119], v[44:47], v[212:215]
ds_read_b64_tr_b16 v[62:63], v11 offset:33280
v_mfma_f32_16x16x32_bf16 v[216:219], a[120:123], v[44:47], v[216:219]
s_waitcnt lgkmcnt(6)
v_mfma_f32_16x16x32_bf16 v[220:223], a[124:127], v[44:47], v[220:223]
v_mfma_f32_16x16x32_bf16 v[224:227], a[112:115], v[48:51], v[224:227]
ds_read_b64_tr_b16 v[40:41], v12 offset:32768
v_mfma_f32_16x16x32_bf16 v[228:231], a[116:119], v[48:51], v[228:231]
ds_read_b64_tr_b16 v[42:43], v12 offset:33280
v_mfma_f32_16x16x32_bf16 v[232:235], a[120:123], v[48:51], v[232:235]
s_waitcnt lgkmcnt(4)
v_mfma_f32_16x16x32_bf16 v[236:239], a[124:127], v[48:51], v[236:239]
v_mfma_f32_16x16x32_bf16 v[240:243], a[112:115], v[52:55], v[240:243]
ds_read_b64_tr_b16 v[44:45], v13 offset:32768
v_mul_f32 v104, s63, v104
v_mfma_f32_16x16x32_bf16 v[244:247], a[116:119], v[52:55], v[244:247]
v_mul_f32 v105, s63, v105
ds_read_b64_tr_b16 v[46:47], v13 offset:33280
v_mfma_f32_16x16x32_bf16 v[248:251], a[120:123], v[52:55], v[248:251]
v_mul_f32 v106, s63, v106
v_mul_f32 v107, s63, v107
v_mfma_f32_16x16x32_bf16 v[252:255], a[124:127], v[52:55], v[252:255]
v_mul_f32 v120, s63, v120
v_mul_f32 v121, s63, v121
v_mfma_f32_16x16x32_bf16 v[192:195], a[128:131], v[56:59], v[192:195]
v_mul_f32 v122, s63, v122
v_mul_f32 v123, s63, v123
v_mfma_f32_16x16x32_bf16 v[196:199], a[132:135], v[56:59], v[196:199]
ds_read_b64_tr_b16 v[48:49], v10 offset:49152
v_cvt_pk_bf16_f32 v104, v104, v105
v_mfma_f32_16x16x32_bf16 v[200:203], a[136:139], v[56:59], v[200:203]
s_waitcnt lgkmcnt(3)
v_cvt_pk_bf16_f32 v105, v106, v107
ds_read_b64_tr_b16 v[50:51], v10 offset:49664
v_mfma_f32_16x16x32_bf16 v[204:207], a[140:143], v[56:59], v[204:207]
s_add_u32 s62, s58, 9216
v_cvt_pk_bf16_f32 v106, v120, v121
v_cvt_pk_bf16_f32 v107, v122, v123
v_mfma_f32_16x16x32_bf16 v[208:211], a[128:131], v[60:63], v[208:211]
buffer_store_dwordx4 v[104:107], v21, s[36:39], s62 offen sc1
v_mfma_f32_16x16x32_bf16 v[212:215], a[132:135], v[60:63], v[212:215]
ds_read_b64_tr_b16 v[52:53], v11 offset:49152
ds_read_b64_tr_b16 v[54:55], v11 offset:49664
v_mfma_f32_16x16x32_bf16 v[216:219], a[136:139], v[60:63], v[216:219]
v_mfma_f32_16x16x32_bf16 v[220:223], a[140:143], v[60:63], v[220:223]
v_mfma_f32_16x16x32_bf16 v[224:227], a[128:131], v[40:43], v[224:227]
ds_read_b64_tr_b16 v[56:57], v12 offset:49152
v_mfma_f32_16x16x32_bf16 v[228:231], a[132:135], v[40:43], v[228:231]
ds_read_b64_tr_b16 v[58:59], v12 offset:49664
v_mfma_f32_16x16x32_bf16 v[232:235], a[136:139], v[40:43], v[232:235]
s_waitcnt lgkmcnt(6)
v_mfma_f32_16x16x32_bf16 v[236:239], a[140:143], v[40:43], v[236:239]
v_mfma_f32_16x16x32_bf16 v[240:243], a[128:131], v[44:47], v[240:243]
ds_read_b64_tr_b16 v[60:61], v13 offset:49152
v_mfma_f32_16x16x32_bf16 v[244:247], a[132:135], v[44:47], v[244:247]
ds_read_b64_tr_b16 v[62:63], v13 offset:49664
v_mfma_f32_16x16x32_bf16 v[248:251], a[136:139], v[44:47], v[248:251]
s_waitcnt lgkmcnt(4)
v_mfma_f32_16x16x32_bf16 v[252:255], a[140:143], v[44:47], v[252:255]
s_barrier
v_mfma_f32_16x16x32_bf16 v[192:195], a[144:147], v[48:51], v[192:195]
ds_read_b64_tr_b16 v[40:41], v10 offset:34816
v_mul_f32 v108, s63, v108
v_mfma_f32_16x16x32_bf16 v[196:199], a[148:151], v[48:51], v[196:199]
v_mul_f32 v109, s63, v109
ds_read_b64_tr_b16 v[42:43], v10 offset:35328
v_mfma_f32_16x16x32_bf16 v[200:203], a[152:155], v[48:51], v[200:203]
v_mul_f32 v110, s63, v110
v_mul_f32 v111, s63, v111
v_mfma_f32_16x16x32_bf16 v[204:207], a[156:159], v[48:51], v[204:207]
v_mul_f32 v124, s63, v124
v_mul_f32 v125, s63, v125
v_mfma_f32_16x16x32_bf16 v[208:211], a[144:147], v[52:55], v[208:211]
v_mul_f32 v126, s63, v126
v_mul_f32 v127, s63, v127
v_mfma_f32_16x16x32_bf16 v[212:215], a[148:151], v[52:55], v[212:215]
ds_read_b64_tr_b16 v[44:45], v11 offset:34816
v_cvt_pk_bf16_f32 v108, v108, v109
v_mfma_f32_16x16x32_bf16 v[216:219], a[152:155], v[52:55], v[216:219]
s_waitcnt lgkmcnt(3)
v_cvt_pk_bf16_f32 v109, v110, v111
ds_read_b64_tr_b16 v[46:47], v11 offset:35328
v_mfma_f32_16x16x32_bf16 v[220:223], a[156:159], v[52:55], v[220:223]
s_add_u32 s62, s58, 13312
v_cvt_pk_bf16_f32 v110, v124, v125
v_cvt_pk_bf16_f32 v111, v126, v127
v_mfma_f32_16x16x32_bf16 v[224:227], a[144:147], v[56:59], v[224:227]
buffer_store_dwordx4 v[108:111], v21, s[36:39], s62 offen sc1
v_mfma_f32_16x16x32_bf16 v[228:231], a[148:151], v[56:59], v[228:231]
ds_read_b64_tr_b16 v[48:49], v12 offset:34816
ds_read_b64_tr_b16 v[50:51], v12 offset:35328
v_mfma_f32_16x16x32_bf16 v[232:235], a[152:155], v[56:59], v[232:235]
v_mfma_f32_16x16x32_bf16 v[236:239], a[156:159], v[56:59], v[236:239]
v_mfma_f32_16x16x32_bf16 v[240:243], a[144:147], v[60:63], v[240:243]
ds_read_b64_tr_b16 v[52:53], v13 offset:34816
v_mfma_f32_16x16x32_bf16 v[244:247], a[148:151], v[60:63], v[244:247]
ds_read_b64_tr_b16 v[54:55], v13 offset:35328
v_mfma_f32_16x16x32_bf16 v[248:251], a[152:155], v[60:63], v[248:251]
s_waitcnt lgkmcnt(6)
v_mfma_f32_16x16x32_bf16 v[252:255], a[156:159], v[60:63], v[252:255]
v_mfma_f32_16x16x32_bf16 v[192:195], a[160:163], v[40:43], v[192:195]
ds_read_b64_tr_b16 v[56:57], v10 offset:51200
v_mfma_f32_16x16x32_bf16 v[196:199], a[164:167], v[40:43], v[196:199]
ds_read_b64_tr_b16 v[58:59], v10 offset:51712
v_mfma_f32_16x16x32_bf16 v[200:203], a[168:171], v[40:43], v[200:203]
s_waitcnt lgkmcnt(4)
v_mfma_f32_16x16x32_bf16 v[204:207], a[172:175], v[40:43], v[204:207]
v_mfma_f32_16x16x32_bf16 v[208:211], a[160:163], v[44:47], v[208:211]
ds_read_b64_tr_b16 v[60:61], v11 offset:51200
v_mul_f32 v128, s63, v128
v_mfma_f32_16x16x32_bf16 v[212:215], a[164:167], v[44:47], v[212:215]
v_mul_f32 v129, s63, v129
ds_read_b64_tr_b16 v[62:63], v11 offset:51712
v_mfma_f32_16x16x32_bf16 v[216:219], a[168:171], v[44:47], v[216:219]
v_mul_f32 v130, s63, v130
v_mul_f32 v131, s63, v131
v_mfma_f32_16x16x32_bf16 v[220:223], a[172:175], v[44:47], v[220:223]
v_mul_f32 v144, s63, v144
v_mul_f32 v145, s63, v145
v_mfma_f32_16x16x32_bf16 v[224:227], a[160:163], v[48:51], v[224:227]
v_mul_f32 v146, s63, v146
v_mul_f32 v147, s63, v147
v_mfma_f32_16x16x32_bf16 v[228:231], a[164:167], v[48:51], v[228:231]
ds_read_b64_tr_b16 v[40:41], v12 offset:51200
v_cvt_pk_bf16_f32 v128, v128, v129
v_mfma_f32_16x16x32_bf16 v[232:235], a[168:171], v[48:51], v[232:235]
s_waitcnt lgkmcnt(3)
v_cvt_pk_bf16_f32 v129, v130, v131
ds_read_b64_tr_b16 v[42:43], v12 offset:51712
v_mfma_f32_16x16x32_bf16 v[236:239], a[172:175], v[48:51], v[236:239]
s_add_u32 s62, s58, 2048
v_cvt_pk_bf16_f32 v130, v144, v145
v_cvt_pk_bf16_f32 v131, v146, v147
v_mfma_f32_16x16x32_bf16 v[240:243], a[160:163], v[52:55], v[240:243]
buffer_store_dwordx4 v[128:131], v21, s[36:39], s62 offen sc1
v_mfma_f32_16x16x32_bf16 v[244:247], a[164:167], v[52:55], v[244:247]
ds_read_b64_tr_b16 v[44:45], v13 offset:51200
ds_read_b64_tr_b16 v[46:47], v13 offset:51712
v_mfma_f32_16x16x32_bf16 v[248:251], a[168:171], v[52:55], v[248:251]
v_mfma_f32_16x16x32_bf16 v[252:255], a[172:175], v[52:55], v[252:255]
v_add_u32 v10, 0x10000, v10
v_add_u32 v11, 0x10000, v11
v_mfma_f32_16x16x32_bf16 v[192:195], a[176:179], v[56:59], v[192:195]
v_add_u32 v12, 0x10000, v12
v_add_u32 v13, 0x10000, v13
v_mfma_f32_16x16x32_bf16 v[196:199], a[180:183], v[56:59], v[196:199]
s_barrier
ds_read_b64_tr_b16 v[48:49], v10 offset:0
ds_read_b64_tr_b16 v[50:51], v10 offset:512
v_mfma_f32_16x16x32_bf16 v[200:203], a[184:187], v[56:59], v[200:203]
s_waitcnt lgkmcnt(6)
v_mfma_f32_16x16x32_bf16 v[204:207], a[188:191], v[56:59], v[204:207]
v_mfma_f32_16x16x32_bf16 v[208:211], a[176:179], v[60:63], v[208:211]
ds_read_b64_tr_b16 v[52:53], v11 offset:0
v_mfma_f32_16x16x32_bf16 v[212:215], a[180:183], v[60:63], v[212:215]
ds_read_b64_tr_b16 v[54:55], v11 offset:512
v_mfma_f32_16x16x32_bf16 v[216:219], a[184:187], v[60:63], v[216:219]
s_waitcnt lgkmcnt(4)
v_mfma_f32_16x16x32_bf16 v[220:223], a[188:191], v[60:63], v[220:223]
v_mfma_f32_16x16x32_bf16 v[224:227], a[176:179], v[40:43], v[224:227]
ds_read_b64_tr_b16 v[56:57], v12 offset:0
v_mul_f32 v132, s63, v132
v_mfma_f32_16x16x32_bf16 v[228:231], a[180:183], v[40:43], v[228:231]
v_mul_f32 v133, s63, v133
ds_read_b64_tr_b16 v[58:59], v12 offset:512
v_mfma_f32_16x16x32_bf16 v[232:235], a[184:187], v[40:43], v[232:235]
v_mul_f32 v134, s63, v134
v_mul_f32 v135, s63, v135
v_mfma_f32_16x16x32_bf16 v[236:239], a[188:191], v[40:43], v[236:239]
v_mul_f32 v148, s63, v148
v_mul_f32 v149, s63, v149
v_mfma_f32_16x16x32_bf16 v[240:243], a[176:179], v[44:47], v[240:243]
v_mul_f32 v150, s63, v150
v_mul_f32 v151, s63, v151
v_mfma_f32_16x16x32_bf16 v[244:247], a[180:183], v[44:47], v[244:247]
ds_read_b64_tr_b16 v[60:61], v13 offset:0
v_cvt_pk_bf16_f32 v132, v132, v133
v_mfma_f32_16x16x32_bf16 v[248:251], a[184:187], v[44:47], v[248:251]
s_waitcnt lgkmcnt(3)
v_cvt_pk_bf16_f32 v133, v134, v135
ds_read_b64_tr_b16 v[62:63], v13 offset:512
v_mfma_f32_16x16x32_bf16 v[252:255], a[188:191], v[44:47], v[252:255]
s_add_u32 s62, s58, 6144
v_cvt_pk_bf16_f32 v134, v148, v149
v_cvt_pk_bf16_f32 v135, v150, v151
v_mfma_f32_16x16x32_bf16 v[192:195], a[192:195], v[48:51], v[192:195]
buffer_store_dwordx4 v[132:135], v21, s[36:39], s62 offen sc1
v_mfma_f32_16x16x32_bf16 v[196:199], a[196:199], v[48:51], v[196:199]
ds_read_b64_tr_b16 v[40:41], v10 offset:16384
ds_read_b64_tr_b16 v[42:43], v10 offset:16896
v_mfma_f32_16x16x32_bf16 v[200:203], a[200:203], v[48:51], v[200:203]
v_mfma_f32_16x16x32_bf16 v[204:207], a[204:207], v[48:51], v[204:207]
v_mfma_f32_16x16x32_bf16 v[208:211], a[192:195], v[52:55], v[208:211]
ds_read_b64_tr_b16 v[44:45], v11 offset:16384
v_mfma_f32_16x16x32_bf16 v[212:215], a[196:199], v[52:55], v[212:215]
ds_read_b64_tr_b16 v[46:47], v11 offset:16896
v_mfma_f32_16x16x32_bf16 v[216:219], a[200:203], v[52:55], v[216:219]
s_waitcnt lgkmcnt(6)
v_mfma_f32_16x16x32_bf16 v[220:223], a[204:207], v[52:55], v[220:223]
v_mfma_f32_16x16x32_bf16 v[224:227], a[192:195], v[56:59], v[224:227]
ds_read_b64_tr_b16 v[48:49], v12 offset:16384
v_mfma_f32_16x16x32_bf16 v[228:231], a[196:199], v[56:59], v[228:231]
ds_read_b64_tr_b16 v[50:51], v12 offset:16896
v_mfma_f32_16x16x32_bf16 v[232:235], a[200:203], v[56:59], v[232:235]
s_waitcnt lgkmcnt(4)
v_mfma_f32_16x16x32_bf16 v[236:239], a[204:207], v[56:59], v[236:239]
v_mfma_f32_16x16x32_bf16 v[240:243], a[192:195], v[60:63], v[240:243]
ds_read_b64_tr_b16 v[52:53], v13 offset:16384
v_mfma_f32_16x16x32_bf16 v[244:247], a[196:199], v[60:63], v[244:247]
ds_read_b64_tr_b16 v[54:55], v13 offset:16896
v_mfma_f32_16x16x32_bf16 v[248:251], a[200:203], v[60:63], v[248:251]
v_mfma_f32_16x16x32_bf16 v[252:255], a[204:207], v[60:63], v[252:255]
s_barrier
v_mfma_f32_16x16x32_bf16 v[192:195], a[208:211], v[40:43], v[192:195]
ds_read_b64_tr_b16 v[56:57], v10 offset:2048
v_mfma_f32_16x16x32_bf16 v[196:199], a[212:215], v[40:43], v[196:199]
s_add_u32 s100, s101, 0
ds_read_b64_tr_b16 v[58:59], v10 offset:2560
s_and_b32 s100, s100, 1023
v_mfma_f32_16x16x32_bf16 v[200:203], a[216:219], v[40:43], v[200:203]
s_waitcnt lgkmcnt(4)
s_add_u32 m0, s43, 32768
s_add_u32 s100, s100, s8
v_mfma_f32_16x16x32_bf16 v[204:207], a[220:223], v[40:43], v[204:207]
buffer_load_dwordx4 v19, s[20:23], s100 offen lds
v_mfma_f32_16x16x32_bf16 v[208:211], a[208:211], v[44:47], v[208:211]
s_add_u32 m0, s43, 33792
ds_read_b64_tr_b16 v[60:61], v11 offset:2048
s_add_u32 s100, s100, 8192
v_mfma_f32_16x16x32_bf16 v[212:215], a[212:215], v[44:47], v[212:215]
buffer_load_dwordx4 v20, s[20:23], s100 offen lds
v_mfma_f32_16x16x32_bf16 v[216:219], a[216:219], v[44:47], v[216:219]
ds_read_b64_tr_b16 v[62:63], v11 offset:2560
v_mfma_f32_16x16x32_bf16 v[220:223], a[220:223], v[44:47], v[220:223]
s_add_u32 m0, s43, 34816
s_add_u32 s100, s100, 8192
v_mfma_f32_16x16x32_bf16 v[224:227], a[208:211], v[48:51], v[224:227]
buffer_load_dwordx4 v19, s[20:23], s100 offen lds
v_mfma_f32_16x16x32_bf16 v[228:231], a[212:215], v[48:51], v[228:231]
ds_read_b64_tr_b16 v[40:41], v12 offset:2048
ds_read_b64_tr_b16 v[42:43], v12 offset:2560
v_mfma_f32_16x16x32_bf16 v[232:235], a[216:219], v[48:51], v[232:235]
s_waitcnt lgkmcnt(4)
s_add_u32 m0, s43, 35840
s_add_u32 s100, s100, 8192
v_mfma_f32_16x16x32_bf16 v[236:239], a[220:223], v[48:51], v[236:239]
buffer_load_dwordx4 v20, s[20:23], s100 offen lds
v_mfma_f32_16x16x32_bf16 v[240:243], a[208:211], v[52:55], v[240:243]
ds_read_b64_tr_b16 v[44:45], v13 offset:2048
v_mfma_f32_16x16x32_bf16 v[244:247], a[212:215], v[52:55], v[244:247]
s_add_u32 m0, s43, 36864
ds_read_b64_tr_b16 v[46:47], v13 offset:2560
s_add_u32 s100, s100, s9
v_mfma_f32_16x16x32_bf16 v[248:251], a[216:219], v[52:55], v[248:251]
buffer_load_dwordx4 v19, s[20:23], s100 offen lds
v_mfma_f32_16x16x32_bf16 v[252:255], a[220:223], v[52:55], v[252:255]
v_mfma_f32_16x16x32_bf16 v[192:195], a[224:227], v[56:59], v[192:195]
s_add_u32 m0, s43, 37888
ds_read_b64_tr_b16 v[48:49], v10 offset:18432
s_add_u32 s100, s100, 8192
v_mfma_f32_16x16x32_bf16 v[196:199], a[228:231], v[56:59], v[196:199]
buffer_load_dwordx4 v20, s[20:23], s100 offen lds
v_mfma_f32_16x16x32_bf16 v[200:203], a[232:235], v[56:59], v[200:203]
s_waitcnt lgkmcnt(3)
ds_read_b64_tr_b16 v[50:51], v10 offset:18944
v_mfma_f32_16x16x32_bf16 v[204:207], a[236:239], v[56:59], v[204:207]
s_add_u32 m0, s43, 38912
s_add_u32 s100, s100, 8192
v_mfma_f32_16x16x32_bf16 v[208:211], a[224:227], v[60:63], v[208:211]
buffer_load_dwordx4 v19, s[20:23], s100 offen lds
v_mfma_f32_16x16x32_bf16 v[212:215], a[228:231], v[60:63], v[212:215]
ds_read_b64_tr_b16 v[52:53], v11 offset:18432
ds_read_b64_tr_b16 v[54:55], v11 offset:18944
v_mfma_f32_16x16x32_bf16 v[216:219], a[232:235], v[60:63], v[216:219]
s_add_u32 m0, s43, 39936
s_add_u32 s100, s100, 8192
v_mfma_f32_16x16x32_bf16 v[220:223], a[236:239], v[60:63], v[220:223]
buffer_load_dwordx4 v20, s[20:23], s100 offen lds
v_mfma_f32_16x16x32_bf16 v[224:227], a[224:227], v[40:43], v[224:227]
ds_read_b64_tr_b16 v[56:57], v12 offset:18432
v_mfma_f32_16x16x32_bf16 v[228:231], a[228:231], v[40:43], v[228:231]
ds_read_b64_tr_b16 v[58:59], v12 offset:18944
v_mfma_f32_16x16x32_bf16 v[232:235], a[232:235], v[40:43], v[232:235]
s_waitcnt lgkmcnt(6)
v_mfma_f32_16x16x32_bf16 v[236:239], a[236:239], v[40:43], v[236:239]
v_mfma_f32_16x16x32_bf16 v[240:243], a[224:227], v[44:47], v[240:243]
ds_read_b64_tr_b16 v[60:61], v13 offset:18432
v_mfma_f32_16x16x32_bf16 v[244:247], a[228:231], v[44:47], v[244:247]
ds_read_b64_tr_b16 v[62:63], v13 offset:18944
v_mfma_f32_16x16x32_bf16 v[248:251], a[232:235], v[44:47], v[248:251]
s_waitcnt lgkmcnt(4)
s_waitcnt vmcnt(14)
v_max_u32 v24, v32, v33
v_mfma_f32_16x16x32_bf16 v[252:255], a[236:239], v[44:47], v[252:255]
s_barrier
v_min_u32 v25, v32, v33
v_mfma_f32_16x16x32_bf16 v[192:195], a[240:243], v[48:51], v[192:195]
ds_read_b64_tr_b16 v[40:41], v10 offset:32768
v_med3_u32 v25, v24, v25, v34
v_mfma_f32_16x16x32_bf16 v[196:199], a[244:247], v[48:51], v[196:199]
ds_read_b64_tr_b16 v[42:43], v10 offset:33280
v_max_u32 v24, v24, v34
v_mfma_f32_16x16x32_bf16 v[200:203], a[248:251], v[48:51], v[200:203]
v_med3_u32 v25, v24, v25, v35
v_mfma_f32_16x16x32_bf16 v[204:207], a[252:255], v[48:51], v[204:207]
v_max_u32 v24, v24, v35
v_mfma_f32_16x16x32_bf16 v[208:211], a[240:243], v[52:55], v[208:211]
ds_read_b64_tr_b16 v[44:45], v11 offset:32768
v_med3_u32 v25, v24, v25, v36
v_mfma_f32_16x16x32_bf16 v[212:215], a[244:247], v[52:55], v[212:215]
ds_read_b64_tr_b16 v[46:47], v11 offset:33280
v_max_u32 v24, v24, v36
v_mfma_f32_16x16x32_bf16 v[216:219], a[248:251], v[52:55], v[216:219]
s_waitcnt lgkmcnt(4)
v_med3_u32 v25, v24, v25, v37
v_mfma_f32_16x16x32_bf16 v[220:223], a[252:255], v[52:55], v[220:223]
v_max_u32 v24, v24, v37
v_mfma_f32_16x16x32_bf16 v[224:227], a[240:243], v[56:59], v[224:227]
ds_read_b64_tr_b16 v[48:49], v12 offset:32768
v_med3_u32 v25, v24, v25, v38
v_mfma_f32_16x16x32_bf16 v[228:231], a[244:247], v[56:59], v[228:231]
ds_read_b64_tr_b16 v[50:51], v12 offset:33280
v_max_u32 v24, v24, v38
v_mfma_f32_16x16x32_bf16 v[232:235], a[248:251], v[56:59], v[232:235]
v_med3_u32 v25, v24, v25, v39
v_mfma_f32_16x16x32_bf16 v[236:239], a[252:255], v[56:59], v[236:239]
v_max_u32 v24, v24, v39
v_mfma_f32_16x16x32_bf16 v[240:243], a[240:243], v[60:63], v[240:243]
ds_read_b64_tr_b16 v[52:53], v13 offset:32768
v_min_u32_dpp v23, v24, v24 quad_perm:[1,0,3,2] row_mask:0xf bank_mask:0xf
v_mfma_f32_16x16x32_bf16 v[244:247], a[244:247], v[60:63], v[244:247]
ds_read_b64_tr_b16 v[54:55], v13 offset:33280
v_max_u32_dpp v25, v25, v25 quad_perm:[1,0,3,2] row_mask:0xf bank_mask:0xf
v_mfma_f32_16x16x32_bf16 v[248:251], a[248:251], v[60:63], v[248:251]
s_waitcnt lgkmcnt(4)
v_max_u32_dpp v24, v24, v24 quad_perm:[1,0,3,2] row_mask:0xf bank_mask:0xf
v_mfma_f32_16x16x32_bf16 v[252:255], a[252:255], v[60:63], v[252:255]
v_max_u32 v25, v25, v23
v_mfma_f32_16x16x32_bf16 v[64:67], a[0:3], v[40:43], 0
ds_read_b64_tr_b16 v[56:57], v10 offset:49152
v_min_u32_dpp v23, v24, v24 quad_perm:[2,3,0,1] row_mask:0xf bank_mask:0xf
v_mfma_f32_16x16x32_bf16 v[68:71], a[4:7], v[40:43], 0
ds_read_b64_tr_b16 v[58:59], v10 offset:49664
v_max_u32_dpp v25, v25, v25 quad_perm:[2,3,0,1] row_mask:0xf bank_mask:0xf
v_mfma_f32_16x16x32_bf16 v[72:75], a[8:11], v[40:43], 0
v_max_u32_dpp v24, v24, v24 quad_perm:[2,3,0,1] row_mask:0xf bank_mask:0xf
v_mfma_f32_16x16x32_bf16 v[76:79], a[12:15], v[40:43], 0
v_max_u32 v25, v25, v23
v_mfma_f32_16x16x32_bf16 v[80:83], a[0:3], v[44:47], 0
ds_read_b64_tr_b16 v[60:61], v11 offset:49152
v_min_u32_dpp v23, v24, v24 row_half_mirror row_mask:0xf bank_mask:0xf
v_mfma_f32_16x16x32_bf16 v[84:87], a[4:7], v[44:47], 0
ds_read_b64_tr_b16 v[62:63], v11 offset:49664
v_max_u32_dpp v25, v25, v25 row_half_mirror row_mask:0xf bank_mask:0xf
v_mfma_f32_16x16x32_bf16 v[88:91], a[8:11], v[44:47], 0
s_waitcnt lgkmcnt(4)
v_mul_f32 v136, s63, v136
v_mul_f32 v137, s63, v137
v_mfma_f32_16x16x32_bf16 v[92:95], a[12:15], v[44:47], 0
v_mul_f32 v138, s63, v138
v_mul_f32 v139, s63, v139
v_mfma_f32_16x16x32_bf16 v[96:99], a[0:3], v[48:51], 0
ds_read_b64_tr_b16 v[40:41], v12 offset:49152
v_mul_f32 v152, s63, v152
v_mfma_f32_16x16x32_bf16 v[100:103], a[4:7], v[48:51], 0
v_mul_f32 v153, s63, v153
ds_read_b64_tr_b16 v[42:43], v12 offset:49664
v_mfma_f32_16x16x32_bf16 v[104:107], a[8:11], v[48:51], 0
v_mul_f32 v154, s63, v154
v_mul_f32 v155, s63, v155
v_mfma_f32_16x16x32_bf16 v[108:111], a[12:15], v[48:51], 0
v_cvt_pk_bf16_f32 v136, v136, v137
v_cvt_pk_bf16_f32 v137, v138, v139
v_mfma_f32_16x16x32_bf16 v[112:115], a[0:3], v[52:55], 0
s_add_u32 s62, s58, 10240
v_cvt_pk_bf16_f32 v138, v152, v153
v_cvt_pk_bf16_f32 v139, v154, v155
v_mfma_f32_16x16x32_bf16 v[116:119], a[4:7], v[52:55], 0
buffer_store_dwordx4 v[136:139], v21, s[36:39], s62 offen sc1
v_mfma_f32_16x16x32_bf16 v[120:123], a[8:11], v[52:55], 0
s_waitcnt lgkmcnt(2)
ds_read_b64_tr_b16 v[44:45], v13 offset:49152
ds_read_b64_tr_b16 v[46:47], v13 offset:49664
v_mfma_f32_16x16x32_bf16 v[124:127], a[12:15], v[52:55], 0
s_barrier
v_max_u32_dpp v24, v24, v24 row_half_mirror row_mask:0xf bank_mask:0xf
v_max_u32 v25, v25, v23
v_mfma_f32_16x16x32_bf16 v[64:67], a[16:19], v[56:59], v[64:67]
ds_read_b64_tr_b16 v[48:49], v10 offset:34816
v_min_u32_dpp v23, v24, v24 row_mirror row_mask:0xf bank_mask:0xf
v_mfma_f32_16x16x32_bf16 v[68:71], a[20:23], v[56:59], v[68:71]
ds_read_b64_tr_b16 v[50:51], v10 offset:35328
v_max_u32_dpp v25, v25, v25 row_mirror row_mask:0xf bank_mask:0xf
v_mfma_f32_16x16x32_bf16 v[72:75], a[24:27], v[56:59], v[72:75]
s_lshl_b32 s48, s42, 9
v_max_u32_dpp v24, v24, v24 row_mirror row_mask:0xf bank_mask:0xf
v_max_u32 v25, v25, v23
v_mfma_f32_16x16x32_bf16 v[76:79], a[28:31], v[56:59], v[76:79]
v_lshl_add_u32 v23, v0, 3, s48
v_mfma_f32_16x16x32_bf16 v[80:83], a[16:19], v[60:63], v[80:83]
ds_read_b64_tr_b16 v[52:53], v11 offset:34816
v_mfma_f32_16x16x32_bf16 v[84:87], a[20:23], v[60:63], v[84:87]
ds_read_b64_tr_b16 v[54:55], v11 offset:35328
v_mfma_f32_16x16x32_bf16 v[88:91], a[24:27], v[60:63], v[88:91]
s_waitcnt lgkmcnt(6)
v_mfma_f32_16x16x32_bf16 v[92:95], a[28:31], v[60:63], v[92:95]
v_mul_f32 v140, s63, v140
v_mul_f32 v141, s63, v141
v_mfma_f32_16x16x32_bf16 v[96:99], a[16:19], v[40:43], v[96:99]
ds_read_b64_tr_b16 v[56:57], v12 offset:34816
v_mul_f32 v142, s63, v142
v_mfma_f32_16x16x32_bf16 v[100:103], a[20:23], v[40:43], v[100:103]
v_mul_f32 v143, s63, v143
ds_read_b64_tr_b16 v[58:59], v12 offset:35328
v_mfma_f32_16x16x32_bf16 v[104:107], a[24:27], v[40:43], v[104:107]
s_waitcnt lgkmcnt(4)
v_mul_f32 v156, s63, v156
v_mul_f32 v157, s63, v157
v_mfma_f32_16x16x32_bf16 v[108:111], a[28:31], v[40:43], v[108:111]
v_mul_f32 v158, s63, v158
v_mul_f32 v159, s63, v159
v_mfma_f32_16x16x32_bf16 v[112:115], a[16:19], v[44:47], v[112:115]
v_cvt_pk_bf16_f32 v140, v140, v141
v_cvt_pk_bf16_f32 v141, v142, v143
v_mfma_f32_16x16x32_bf16 v[116:119], a[20:23], v[44:47], v[116:119]
ds_read_b64_tr_b16 v[60:61], v13 offset:34816
v_cvt_pk_bf16_f32 v142, v156, v157
v_mfma_f32_16x16x32_bf16 v[120:123], a[24:27], v[44:47], v[120:123]
v_cvt_pk_bf16_f32 v143, v158, v159
ds_write_b64 v23, v[24:25]
v_mfma_f32_16x16x32_bf16 v[124:127], a[28:31], v[44:47], v[124:127]
s_add_u32 s62, s58, 14336
ds_read_b64_tr_b16 v[62:63], v13 offset:35328
v_and_b32 v23, 15, v0
v_mfma_f32_16x16x32_bf16 v[64:67], a[32:35], v[48:51], v[64:67]
buffer_store_dwordx4 v[140:143], v21, s[36:39], s62 offen sc1
v_mfma_f32_16x16x32_bf16 v[68:71], a[36:39], v[48:51], v[68:71]
ds_read_b64_tr_b16 v[40:41], v10 offset:51200
ds_read_b64_tr_b16 v[42:43], v10 offset:51712
v_mfma_f32_16x16x32_bf16 v[72:75], a[40:43], v[48:51], v[72:75]
s_waitcnt lgkmcnt(5)
v_lshlrev_b32 v23, 7, v23
v_mfma_f32_16x16x32_bf16 v[76:79], a[44:47], v[48:51], v[76:79]
v_mfma_f32_16x16x32_bf16 v[80:83], a[32:35], v[52:55], v[80:83]
ds_read_b64_tr_b16 v[44:45], v11 offset:51200
v_mfma_f32_16x16x32_bf16 v[84:87], a[36:39], v[52:55], v[84:87]
ds_read_b64_tr_b16 v[46:47], v11 offset:51712
v_mfma_f32_16x16x32_bf16 v[88:91], a[40:43], v[52:55], v[88:91]
v_mfma_f32_16x16x32_bf16 v[92:95], a[44:47], v[52:55], v[92:95]
v_mfma_f32_16x16x32_bf16 v[96:99], a[32:35], v[56:59], v[96:99]
ds_read_b64_tr_b16 v[48:49], v12 offset:51200
v_mul_f32 v160, s63, v160
v_mfma_f32_16x16x32_bf16 v[100:103], a[36:39], v[56:59], v[100:103]
v_mul_f32 v161, s63, v161
ds_read_b64_tr_b16 v[50:51], v12 offset:51712
v_mfma_f32_16x16x32_bf16 v[104:107], a[40:43], v[56:59], v[104:107]
s_waitcnt lgkmcnt(4)
v_mul_f32 v162, s63, v162
v_mul_f32 v163, s63, v163
v_mfma_f32_16x16x32_bf16 v[108:111], a[44:47], v[56:59], v[108:111]
v_mul_f32 v176, s63, v176
v_mul_f32 v177, s63, v177
v_mfma_f32_16x16x32_bf16 v[112:115], a[32:35], v[60:63], v[112:115]
v_mul_f32 v178, s63, v178
v_mul_f32 v179, s63, v179
v_mfma_f32_16x16x32_bf16 v[116:119], a[36:39], v[60:63], v[116:119]
ds_read_b64_tr_b16 v[52:53], v13 offset:51200
v_cvt_pk_bf16_f32 v160, v160, v161
v_mfma_f32_16x16x32_bf16 v[120:123], a[40:43], v[60:63], v[120:123]
s_add_u32 s62, s58, 3072
v_cvt_pk_bf16_f32 v161, v162, v163
ds_read_b64_tr_b16 v[54:55], v13 offset:51712
v_mfma_f32_16x16x32_bf16 v[124:127], a[44:47], v[60:63], v[124:127]
v_cvt_pk_bf16_f32 v162, v176, v177
v_cvt_pk_bf16_f32 v163, v178, v179
v_mfma_f32_16x16x32_bf16 v[64:67], a[48:51], v[40:43], v[64:67]
buffer_store_dwordx4 v[160:163], v21, s[36:39], s62 offen sc1
v_mfma_f32_16x16x32_bf16 v[68:71], a[52:55], v[40:43], v[68:71]
s_barrier
ds_read_b64_tr_b16 v[56:57], v10 offset:36864
ds_read_b64 v[34:35], v23
v_mfma_f32_16x16x32_bf16 v[72:75], a[56:59], v[40:43], v[72:75]
s_waitcnt lgkmcnt(4)
ds_read_b64_tr_b16 v[58:59], v10 offset:37376
s_add_u32 s18, s101, 0
v_mfma_f32_16x16x32_bf16 v[76:79], a[60:63], v[40:43], v[76:79]
s_and_b32 s18, s18, 1023
s_lshl_b32 s18, s18, 12
s_add_u32 s18, s18, s10
v_mfma_f32_16x16x32_bf16 v[80:83], a[48:51], v[44:47], v[80:83]
s_add_u32 m0, s43, 98304
ds_read_b64_tr_b16 v[60:61], v11 offset:36864
v_mfma_f32_16x16x32_bf16 v[84:87], a[52:55], v[44:47], v[84:87]
buffer_load_dwordx4 v16, s[24:27], s18 offen lds
v_mfma_f32_16x16x32_bf16 v[88:91], a[56:59], v[44:47], v[88:91]
s_add_u32 m0, s43, 99328
ds_read_b64_tr_b16 v[62:63], v11 offset:37376
s_add_u32 s18, s18, 32768
v_mfma_f32_16x16x32_bf16 v[92:95], a[60:63], v[44:47], v[92:95]
buffer_load_dwordx4 v16, s[24:27], s18 offen lds
v_mfma_f32_16x16x32_bf16 v[96:99], a[48:51], v[48:51], v[96:99]
ds_read_b64_tr_b16 v[40:41], v12 offset:36864
v_mfma_f32_16x16x32_bf16 v[100:103], a[52:55], v[48:51], v[100:103]
ds_read_b64_tr_b16 v[42:43], v12 offset:37376
v_mul_f32 v164, s63, v164
v_mfma_f32_16x16x32_bf16 v[104:107], a[56:59], v[48:51], v[104:107]
s_waitcnt lgkmcnt(7)
v_mul_f32 v165, s63, v165
v_mul_f32 v166, s63, v166
v_mfma_f32_16x16x32_bf16 v[108:111], a[60:63], v[48:51], v[108:111]
v_mul_f32 v167, s63, v167
v_mul_f32 v180, s63, v180
v_mfma_f32_16x16x32_bf16 v[112:115], a[48:51], v[52:55], v[112:115]
v_mul_f32 v181, s63, v181
ds_read_b64_tr_b16 v[44:45], v13 offset:36864
v_mfma_f32_16x16x32_bf16 v[116:119], a[52:55], v[52:55], v[116:119]
v_mul_f32 v182, s63, v182
v_mul_f32 v183, s63, v183
v_mfma_f32_16x16x32_bf16 v[120:123], a[56:59], v[52:55], v[120:123]
s_waitcnt lgkmcnt(5)
ds_read_b64_tr_b16 v[46:47], v13 offset:37376
v_cvt_pk_bf16_f32 v164, v164, v165
v_mfma_f32_16x16x32_bf16 v[124:127], a[60:63], v[52:55], v[124:127]
s_add_u32 s62, s58, 7168
v_cvt_pk_bf16_f32 v165, v166, v167
v_cvt_pk_bf16_f32 v166, v180, v181
v_mfma_f32_16x16x32_bf16 v[64:67], a[64:67], v[56:59], v[64:67]
v_cvt_pk_bf16_f32 v167, v182, v183
ds_read_b64_tr_b16 v[48:49], v10 offset:53248
v_mfma_f32_16x16x32_bf16 v[68:71], a[68:71], v[56:59], v[68:71]
buffer_store_dwordx4 v[164:167], v21, s[36:39], s62 offen sc1
v_mfma_f32_16x16x32_bf16 v[72:75], a[72:75], v[56:59], v[72:75]
s_waitcnt lgkmcnt(3)
ds_read_b64_tr_b16 v[50:51], v10 offset:53760
v_mfma_f32_16x16x32_bf16 v[76:79], a[76:79], v[56:59], v[76:79]
v_mfma_f32_16x16x32_bf16 v[80:83], a[64:67], v[60:63], v[80:83]
ds_read_b64_tr_b16 v[52:53], v11 offset:53248
s_add_u32 s62, s43, 65536
v_mfma_f32_16x16x32_bf16 v[84:87], a[68:71], v[60:63], v[84:87]
ds_read_b64_tr_b16 v[54:55], v11 offset:53760
v_add_u32 v38, s62, v21
v_mfma_f32_16x16x32_bf16 v[88:91], a[72:75], v[60:63], v[88:91]
v_mfma_f32_16x16x32_bf16 v[92:95], a[76:79], v[60:63], v[92:95]
v_mfma_f32_16x16x32_bf16 v[96:99], a[64:67], v[40:43], v[96:99]
ds_read_b64_tr_b16 v[56:57], v12 offset:53248
v_mfma_f32_16x16x32_bf16 v[100:103], a[68:71], v[40:43], v[100:103]
ds_read_b64_tr_b16 v[58:59], v12 offset:53760
v_mfma_f32_16x16x32_bf16 v[104:107], a[72:75], v[40:43], v[104:107]
s_waitcnt lgkmcnt(6)
v_mul_f32 v168, s63, v168
v_mul_f32 v169, s63, v169
v_mfma_f32_16x16x32_bf16 v[108:111], a[76:79], v[40:43], v[108:111]
v_mul_f32 v170, s63, v170
v_mul_f32 v171, s63, v171
v_mfma_f32_16x16x32_bf16 v[112:115], a[64:67], v[44:47], v[112:115]
ds_read_b64_tr_b16 v[60:61], v13 offset:53248
v_mul_f32 v184, s63, v184
v_mfma_f32_16x16x32_bf16 v[116:119], a[68:71], v[44:47], v[116:119]
v_mul_f32 v185, s63, v185
ds_read_b64_tr_b16 v[62:63], v13 offset:53760
v_mfma_f32_16x16x32_bf16 v[120:123], a[72:75], v[44:47], v[120:123]
s_waitcnt lgkmcnt(4)
v_mul_f32 v186, s63, v186
v_mul_f32 v187, s63, v187
v_mfma_f32_16x16x32_bf16 v[124:127], a[76:79], v[44:47], v[124:127]
v_cvt_pk_bf16_f32 v168, v168, v169
v_cvt_pk_bf16_f32 v169, v170, v171
v_mfma_f32_16x16x32_bf16 v[64:67], a[80:83], v[48:51], v[64:67]
s_barrier
v_cvt_pk_bf16_f32 v170, v184, v185
v_cvt_pk_bf16_f32 v171, v186, v187
v_mfma_f32_16x16x32_bf16 v[68:71], a[84:87], v[48:51], v[68:71]
s_add_u32 s62, s58, 11264
ds_read_b64_tr_b16 v[40:41], v10 offset:38912
ds_read_b64_tr_b16 v[42:43], v10 offset:39424
v_mfma_f32_16x16x32_bf16 v[72:75], a[88:91], v[48:51], v[72:75]
buffer_store_dwordx4 v[168:171], v21, s[36:39], s62 offen sc1
v_mfma_f32_16x16x32_bf16 v[76:79], a[92:95], v[48:51], v[76:79]
s_add_u32 s18, s101, 64
s_and_b32 s18, s18, 1023
s_lshl_b32 s18, s18, 12
v_mfma_f32_16x16x32_bf16 v[80:83], a[80:83], v[52:55], v[80:83]
s_add_u32 s18, s18, s10
s_add_u32 m0, s43, 100352
v_min_u32_dpp v23, v34, v34 quad_perm:[1,0,3,2] row_mask:0xf bank_mask:0xf
v_mfma_f32_16x16x32_bf16 v[84:87], a[84:87], v[52:55], v[84:87]
buffer_load_dwordx4 v16, s[24:27], s18 offen lds
v_mfma_f32_16x16x32_bf16 v[88:91], a[88:91], v[52:55], v[88:91]
s_waitcnt lgkmcnt(2)
ds_read_b128 a[64:67], v38 offset:4096
ds_read_b128 a[68:71], v38 offset:5120
v_mfma_f32_16x16x32_bf16 v[92:95], a[92:95], v[52:55], v[92:95]
s_add_u32 m0, s43, 101376
ds_read_b64_tr_b16 v[44:45], v11 offset:38912
ds_read_b128 a[72:75], v38 offset:6144
v_mfma_f32_16x16x32_bf16 v[96:99], a[80:83], v[56:59], v[96:99]
s_add_u32 s18, s18, 32768
ds_read_b64_tr_b16 v[46:47], v11 offset:39424
ds_read_b128 a[76:79], v38 offset:7168
v_mfma_f32_16x16x32_bf16 v[100:103], a[84:87], v[56:59], v[100:103]
buffer_load_dwordx4 v16, s[24:27], s18 offen lds
v_mfma_f32_16x16x32_bf16 v[104:107], a[88:91], v[56:59], v[104:107]
ds_read_b64_tr_b16 v[48:49], v12 offset:38912
ds_read_b64_tr_b16 v[50:51], v12 offset:39424
v_mfma_f32_16x16x32_bf16 v[108:111], a[92:95], v[56:59], v[108:111]
v_mul_f32 v172, s63, v172
v_mul_f32 v173, s63, v173
v_mfma_f32_16x16x32_bf16 v[112:115], a[80:83], v[60:63], v[112:115]
ds_read_b64_tr_b16 v[52:53], v13 offset:38912
v_mul_f32 v174, s63, v174
v_mfma_f32_16x16x32_bf16 v[116:119], a[84:87], v[60:63], v[116:119]
s_waitcnt lgkmcnt(3)
v_mul_f32 v175, s63, v175
ds_read_b64_tr_b16 v[54:55], v13 offset:39424
v_mfma_f32_16x16x32_bf16 v[120:123], a[88:91], v[60:63], v[120:123]
s_add_u32 s100, s101, 128
v_mul_f32 v188, s63, v188
v_mul_f32 v189, s63, v189
v_mfma_f32_16x16x32_bf16 v[124:127], a[92:95], v[60:63], v[124:127]
s_and_b32 s100, s100, 1023
v_mul_f32 v190, s63, v190
v_mul_f32 v191, s63, v191
v_mfma_f32_16x16x32_bf16 v[64:67], a[96:99], v[40:43], v[64:67]
s_add_u32 m0, s43, 65536
v_cvt_pk_bf16_f32 v172, v172, v173
v_cvt_pk_bf16_f32 v173, v174, v175
v_mfma_f32_16x16x32_bf16 v[68:71], a[100:103], v[40:43], v[68:71]
s_add_u32 s100, s100, s8
ds_read_b64_tr_b16 v[56:57], v10 offset:55296
v_cvt_pk_bf16_f32 v174, v188, v189
v_mfma_f32_16x16x32_bf16 v[72:75], a[104:107], v[40:43], v[72:75]
buffer_load_dwordx4 v19, s[20:23], s100 offen lds
v_mfma_f32_16x16x32_bf16 v[76:79], a[108:111], v[40:43], v[76:79]
s_add_u32 m0, s43, 66560
v_cvt_pk_bf16_f32 v175, v190, v191
ds_read_b64_tr_b16 v[58:59], v10 offset:55808
v_mfma_f32_16x16x32_bf16 v[80:83], a[96:99], v[44:47], v[80:83]
s_add_u32 s100, s100, 8192
ds_read_b64_tr_b16 v[60:61], v11 offset:55296
s_add_u32 s62, s58, 15360
v_mfma_f32_16x16x32_bf16 v[84:87], a[100:103], v[44:47], v[84:87]
buffer_load_dwordx4 v20, s[20:23], s100 offen lds
v_mfma_f32_16x16x32_bf16 v[88:91], a[104:107], v[44:47], v[88:91]
buffer_store_dwordx4 v[172:175], v21, s[36:39], s62 offen sc1
v_mfma_f32_16x16x32_bf16 v[92:95], a[108:111], v[44:47], v[92:95]
s_waitcnt lgkmcnt(3)
ds_read_b64_tr_b16 v[62:63], v11 offset:55808
s_add_u32 m0, s43, 67584
v_mfma_f32_16x16x32_bf16 v[96:99], a[96:99], v[48:51], v[96:99]
s_add_u32 s100, s100, 8192
ds_read_b64_tr_b16 v[40:41], v12 offset:55296
v_max_u32_dpp v35, v35, v35 quad_perm:[1,0,3,2] row_mask:0xf bank_mask:0xf
v_mfma_f32_16x16x32_bf16 v[100:103], a[100:103], v[48:51], v[100:103]
buffer_load_dwordx4 v19, s[20:23], s100 offen lds
v_mfma_f32_16x16x32_bf16 v[104:107], a[104:107], v[48:51], v[104:107]
s_add_u32 m0, s43, 68608
ds_read_b64_tr_b16 v[42:43], v12 offset:55808
s_add_u32 s100, s100, 8192
v_mfma_f32_16x16x32_bf16 v[108:111], a[108:111], v[48:51], v[108:111]
buffer_load_dwordx4 v20, s[20:23], s100 offen lds
v_mfma_f32_16x16x32_bf16 v[112:115], a[96:99], v[52:55], v[112:115]
s_add_u32 m0, s43, 69632
ds_read_b64_tr_b16 v[44:45], v13 offset:55296
s_add_u32 s100, s100, s9
v_mfma_f32_16x16x32_bf16 v[116:119], a[100:103], v[52:55], v[116:119]
buffer_load_dwordx4 v19, s[20:23], s100 offen lds
v_mfma_f32_16x16x32_bf16 v[120:123], a[104:107], v[52:55], v[120:123]
s_waitcnt lgkmcnt(5)
ds_read_b64_tr_b16 v[46:47], v13 offset:55808
s_add_u32 m0, s43, 70656
v_mfma_f32_16x16x32_bf16 v[124:127], a[108:111], v[52:55], v[124:127]
s_add_u32 s100, s100, 8192
v_add_u32 v10, 0x10000, v10
v_add_u32 v11, 0x10000, v11
v_mfma_f32_16x16x32_bf16 v[64:67], a[112:115], v[56:59], v[64:67]
buffer_load_dwordx4 v20, s[20:23], s100 offen lds
v_mfma_f32_16x16x32_bf16 v[68:71], a[116:119], v[56:59], v[68:71]
s_add_u32 m0, s43, 71680
v_add_u32 v12, 0x10000, v12
v_add_u32 v13, 0x10000, v13
v_mfma_f32_16x16x32_bf16 v[72:75], a[120:123], v[56:59], v[72:75]
s_waitcnt lgkmcnt(4)
s_add_u32 s100, s100, 8192
v_max_u32_dpp v34, v34, v34 quad_perm:[1,0,3,2] row_mask:0xf bank_mask:0xf
v_mfma_f32_16x16x32_bf16 v[76:79], a[124:127], v[56:59], v[76:79]
buffer_load_dwordx4 v19, s[20:23], s100 offen lds
v_mfma_f32_16x16x32_bf16 v[80:83], a[112:115], v[60:63], v[80:83]
s_add_u32 m0, s43, 72704
s_add_u32 s100, s100, 8192
v_max_u32 v35, v35, v23
v_mfma_f32_16x16x32_bf16 v[84:87], a[116:119], v[60:63], v[84:87]
buffer_load_dwordx4 v20, s[20:23], s100 offen lds
v_mfma_f32_16x16x32_bf16 v[88:91], a[120:123], v[60:63], v[88:91]
s_waitcnt lgkmcnt(2)
s_barrier
ds_read_b64_tr_b16 v[48:49], v10 offset:0
v_mfma_f32_16x16x32_bf16 v[92:95], a[124:127], v[60:63], v[92:95]
s_add_u32 s100, s101, 256
v_cvt_pk_bf16_f32 v192, v192, v193
v_cvt_pk_bf16_f32 v193, v194, v195
v_mfma_f32_16x16x32_bf16 v[96:99], a[112:115], v[40:43], v[96:99]
s_and_b32 s100, s100, 1023
ds_read_b64_tr_b16 v[50:51], v10 offset:512
v_cvt_pk_bf16_f32 v194, v196, v197
v_mfma_f32_16x16x32_bf16 v[100:103], a[116:119], v[40:43], v[100:103]
s_add_u32 m0, s43, 0
v_cvt_pk_bf16_f32 v195, v198, v199
ds_read_b64_tr_b16 v[52:53], v11 offset:0
v_mfma_f32_16x16x32_bf16 v[104:107], a[120:123], v[40:43], v[104:107]
s_waitcnt lgkmcnt(3)
ds_read_b64_tr_b16 v[54:55], v11 offset:512
ds_read_b64_tr_b16 v[56:57], v12 offset:0
v_mfma_f32_16x16x32_bf16 v[108:111], a[124:127], v[40:43], v[108:111]
s_add_u32 s100, s100, s8
ds_read_b64_tr_b16 v[58:59], v12 offset:512
s_add_u32 s18, s101, 128
buffer_load_dwordx4 v19, s[20:23], s100 offen lds
v_mfma_f32_16x16x32_bf16 v[112:115], a[112:115], v[44:47], v[112:115]
s_and_b32 s18, s18, 1023
ds_read_b64_tr_b16 v[60:61], v13 offset:0
s_lshl_b32 s18, s18, 12
v_mfma_f32_16x16x32_bf16 v[116:119], a[116:119], v[44:47], v[116:119]
s_add_u32 s18, s18, s10
ds_read_b64_tr_b16 v[62:63], v13 offset:512
s_add_u32 m0, s43, 102400
v_min_u32_dpp v23, v34, v34 quad_perm:[2,3,0,1] row_mask:0xf bank_mask:0xf
buffer_load_dwordx4 v16, s[24:27], s18 offen lds
s_add_u32 s62, s58, 16777216
buffer_store_dwordx4 v[192:195], v21, s[36:39], s62 offen sc1
v_mfma_f32_16x16x32_bf16 v[120:123], a[120:123], v[44:47], v[120:123]
s_waitcnt lgkmcnt(6)
s_add_u32 m0, s43, 1024
s_add_u32 s100, s100, 8192
v_max_u32_dpp v35, v35, v35 quad_perm:[2,3,0,1] row_mask:0xf bank_mask:0xf
buffer_load_dwordx4 v20, s[20:23], s100 offen lds
v_mfma_f32_16x16x32_bf16 v[124:127], a[124:127], v[44:47], v[124:127]
s_add_u32 m0, s43, 103424
s_add_u32 s18, s18, 32768
s_add_u32 s100, s100, 8192
v_max_u32_dpp v34, v34, v34 quad_perm:[2,3,0,1] row_mask:0xf bank_mask:0xf
v_mfma_f32_16x16x32_bf16 v[64:67], a[128:131], v[48:51], v[64:67]
buffer_load_dwordx4 v16, s[24:27], s18 offen lds
v_max_u32 v35, v35, v23
v_mfma_f32_16x16x32_bf16 v[68:71], a[132:135], v[48:51], v[68:71]
s_add_u32 m0, s43, 2048
ds_read_b64_tr_b16 v[40:41], v10 offset:16384
ds_read_b64_tr_b16 v[42:43], v10 offset:16896
v_min_u32_dpp v23, v34, v34 row_half_mirror row_mask:0xf bank_mask:0xf
buffer_load_dwordx4 v19, s[20:23], s100 offen lds
v_mfma_f32_16x16x32_bf16 v[72:75], a[136:139], v[48:51], v[72:75]
s_waitcnt lgkmcnt(6)
v_cvt_pk_bf16_f32 v200, v200, v201
v_cvt_pk_bf16_f32 v201, v202, v203
v_max_u32_dpp v35, v35, v35 row_half_mirror row_mask:0xf bank_mask:0xf
v_mfma_f32_16x16x32_bf16 v[76:79], a[140:143], v[48:51], v[76:79]
s_add_u32 m0, s43, 3072
v_cvt_pk_bf16_f32 v202, v204, v205
v_cvt_pk_bf16_f32 v203, v206, v207
v_max_u32_dpp v34, v34, v34 row_half_mirror row_mask:0xf bank_mask:0xf
v_mfma_f32_16x16x32_bf16 v[80:83], a[128:131], v[52:55], v[80:83]
s_add_u32 s100, s100, 8192
ds_read_b64_tr_b16 v[44:45], v11 offset:16384
v_max_u32 v35, v35, v23
buffer_load_dwordx4 v20, s[20:23], s100 offen lds
v_lshrrev_b32 v36, 3, v0
v_lshlrev_b32 v36, 2, v36
v_min_u32_dpp v23, v34, v34 row_mirror row_mask:0xf bank_mask:0xf
v_max_u32_dpp v34, v34, v34 row_mirror row_mask:0xf bank_mask:0xf
s_nop 0
v_readfirstlane_b32 s48, v34
s_andn2_b32 s48, 0x7ff, s48
s_lshl_b32 s48, s48, 10
s_lshl_b32 s50, s45, 5
s_add_u32 s48, s48, s50
s_nop 0
buffer_load_dword v32, v36, s[20:23], s48 offen
v_mfma_f32_16x16x32_bf16 v[84:87], a[132:135], v[52:55], v[84:87]
ds_read_b64_tr_b16 v[46:47], v11 offset:16896
v_max_u32_dpp v35, v35, v35 row_mirror row_mask:0xf bank_mask:0xf
v_max_u32 v35, v35, v23
s_nop 0
v_readfirstlane_b32 s49, v35
s_andn2_b32 s49, 0x7ff, s49
s_lshl_b32 s49, s49, 10
s_add_u32 s49, s49, s50
s_nop 1
buffer_load_dword v33, v36, s[20:23], s49 offen
v_mfma_f32_16x16x32_bf16 v[88:91], a[136:139], v[52:55], v[88:91]
s_waitcnt lgkmcnt(4)
v_mov_b32 v23, 0
s_cmp_eq_u32 s60, 0
v_mfma_f32_16x16x32_bf16 v[92:95], a[140:143], v[52:55], v[92:95]
s_cselect_b32 s48, 51265536, 1073741824
s_add_u32 m0, s43, 4096
s_add_u32 s100, s100, s9
buffer_load_dwordx4 v19, s[20:23], s100 offen lds
v_mfma_f32_16x16x32_bf16 v[96:99], a[128:131], v[56:59], v[96:99]
buffer_store_dwordx2 v[34:35], v23, s[36:39], s48 offen sc1
v_mfma_f32_16x16x32_bf16 v[100:103], a[132:135], v[56:59], v[100:103]
s_add_u32 m0, s43, 5120
ds_read_b64_tr_b16 v[48:49], v12 offset:16384
ds_read_b64_tr_b16 v[50:51], v12 offset:16896
v_mfma_f32_16x16x32_bf16 v[104:107], a[136:139], v[56:59], v[104:107]
s_add_u32 s100, s100, 8192
s_add_u32 s62, s58, 16785408
buffer_load_dwordx4 v20, s[20:23], s100 offen lds
v_mfma_f32_16x16x32_bf16 v[108:111], a[140:143], v[56:59], v[108:111]
s_add_u32 m0, s43, 6144
s_add_u32 s100, s100, 8192
v_mfma_f32_16x16x32_bf16 v[112:115], a[128:131], v[60:63], v[112:115]
buffer_load_dwordx4 v19, s[20:23], s100 offen lds
v_mfma_f32_16x16x32_bf16 v[116:119], a[132:135], v[60:63], v[116:119]
buffer_store_dwordx4 v[200:203], v21, s[36:39], s62 offen sc1
v_mfma_f32_16x16x32_bf16 v[120:123], a[136:139], v[60:63], v[120:123]
s_waitcnt lgkmcnt(2)
ds_read_b64_tr_b16 v[52:53], v13 offset:16384
ds_read_b64_tr_b16 v[54:55], v13 offset:16896
v_mfma_f32_16x16x32_bf16 v[124:127], a[140:143], v[60:63], v[124:127]
s_add_u32 m0, s43, 7168
s_add_u32 s100, s100, 8192
v_mfma_f32_16x16x32_bf16 v[64:67], a[144:147], v[40:43], v[64:67]
buffer_load_dwordx4 v20, s[20:23], s100 offen lds
v_mfma_f32_16x16x32_bf16 v[68:71], a[148:151], v[40:43], v[68:71]
s_barrier
ds_read_b64_tr_b16 v[56:57], v10 offset:2048
ds_read_b64_tr_b16 v[58:59], v10 offset:2560
v_mfma_f32_16x16x32_bf16 v[72:75], a[152:155], v[40:43], v[72:75]
s_add_u32 s18, s101, 192
v_cvt_pk_bf16_f32 v208, v208, v209
v_cvt_pk_bf16_f32 v209, v210, v211
v_mfma_f32_16x16x32_bf16 v[76:79], a[156:159], v[40:43], v[76:79]
s_and_b32 s18, s18, 1023
v_cvt_pk_bf16_f32 v210, v212, v213
v_cvt_pk_bf16_f32 v211, v214, v215
v_mfma_f32_16x16x32_bf16 v[80:83], a[144:147], v[44:47], v[80:83]
s_lshl_b32 s18, s18, 12
ds_read_b64_tr_b16 v[60:61], v11 offset:2048
s_add_u32 s18, s18, s10
v_mfma_f32_16x16x32_bf16 v[84:87], a[148:151], v[44:47], v[84:87]
s_add_u32 m0, s43, 104448
ds_read_b64_tr_b16 v[62:63], v11 offset:2560
s_add_u32 s62, s58, 16778240
v_mfma_f32_16x16x32_bf16 v[88:91], a[152:155], v[44:47], v[88:91]
buffer_load_dwordx4 v16, s[24:27], s18 offen lds
v_mfma_f32_16x16x32_bf16 v[92:95], a[156:159], v[44:47], v[92:95]
s_waitcnt lgkmcnt(4)
s_add_u32 m0, s43, 105472
s_add_u32 s18, s18, 32768
v_mfma_f32_16x16x32_bf16 v[96:99], a[144:147], v[48:51], v[96:99]
buffer_store_dwordx4 v[208:211], v21, s[36:39], s62 offen sc1
v_mfma_f32_16x16x32_bf16 v[100:103], a[148:151], v[48:51], v[100:103]
buffer_load_dwordx4 v16, s[24:27], s18 offen lds
v_mfma_f32_16x16x32_bf16 v[104:107], a[152:155], v[48:51], v[104:107]
ds_read_b64_tr_b16 v[40:41], v12 offset:2048
ds_read_b64_tr_b16 v[42:43], v12 offset:2560
v_mfma_f32_16x16x32_bf16 v[108:111], a[156:159], v[48:51], v[108:111]
v_mfma_f32_16x16x32_bf16 v[112:115], a[144:147], v[52:55], v[112:115]
ds_read_b64_tr_b16 v[44:45], v13 offset:2048
v_mfma_f32_16x16x32_bf16 v[116:119], a[148:151], v[52:55], v[116:119]
ds_read_b64_tr_b16 v[46:47], v13 offset:2560
v_mfma_f32_16x16x32_bf16 v[120:123], a[152:155], v[52:55], v[120:123]
s_waitcnt lgkmcnt(4)
v_mfma_f32_16x16x32_bf16 v[124:127], a[156:159], v[52:55], v[124:127]
v_mfma_f32_16x16x32_bf16 v[64:67], a[160:163], v[56:59], v[64:67]
ds_read_b64_tr_b16 v[48:49], v10 offset:18432
v_mfma_f32_16x16x32_bf16 v[68:71], a[164:167], v[56:59], v[68:71]
ds_read_b64_tr_b16 v[50:51], v10 offset:18944
v_mfma_f32_16x16x32_bf16 v[72:75], a[168:171], v[56:59], v[72:75]
v_mfma_f32_16x16x32_bf16 v[76:79], a[172:175], v[56:59], v[76:79]
v_cvt_pk_bf16_f32 v216, v216, v217
v_cvt_pk_bf16_f32 v217, v218, v219
v_mfma_f32_16x16x32_bf16 v[80:83], a[160:163], v[60:63], v[80:83]
ds_read_b64_tr_b16 v[52:53], v11 offset:18432
v_cvt_pk_bf16_f32 v218, v220, v221
v_mfma_f32_16x16x32_bf16 v[84:87], a[164:167], v[60:63], v[84:87]
s_add_u32 s62, s58, 16786432
v_cvt_pk_bf16_f32 v219, v222, v223
ds_read_b64_tr_b16 v[54:55], v11 offset:18944
v_mfma_f32_16x16x32_bf16 v[88:91], a[168:171], v[60:63], v[88:91]
buffer_store_dwordx4 v[216:219], v21, s[36:39], s62 offen sc1
v_mfma_f32_16x16x32_bf16 v[92:95], a[172:175], v[60:63], v[92:95]
s_waitcnt lgkmcnt(4)
v_mfma_f32_16x16x32_bf16 v[96:99], a[160:163], v[40:43], v[96:99]
ds_read_b64_tr_b16 v[56:57], v12 offset:18432
v_mfma_f32_16x16x32_bf16 v[100:103], a[164:167], v[40:43], v[100:103]
ds_read_b64_tr_b16 v[58:59], v12 offset:18944
v_mfma_f32_16x16x32_bf16 v[104:107], a[168:171], v[40:43], v[104:107]
v_mfma_f32_16x16x32_bf16 v[108:111], a[172:175], v[40:43], v[108:111]
v_mfma_f32_16x16x32_bf16 v[112:115], a[160:163], v[44:47], v[112:115]
ds_read_b64_tr_b16 v[60:61], v13 offset:18432
v_mfma_f32_16x16x32_bf16 v[116:119], a[164:167], v[44:47], v[116:119]
ds_read_b64_tr_b16 v[62:63], v13 offset:18944
v_mfma_f32_16x16x32_bf16 v[120:123], a[168:171], v[44:47], v[120:123]
s_waitcnt lgkmcnt(4)
v_mfma_f32_16x16x32_bf16 v[124:127], a[172:175], v[44:47], v[124:127]
s_barrier
v_mfma_f32_16x16x32_bf16 v[64:67], a[176:179], v[48:51], v[64:67]
ds_read_b64_tr_b16 v[40:41], v10 offset:4096
v_mfma_f32_16x16x32_bf16 v[68:71], a[180:183], v[48:51], v[68:71]
ds_read_b64_tr_b16 v[42:43], v10 offset:4608
v_mfma_f32_16x16x32_bf16 v[72:75], a[184:187], v[48:51], v[72:75]
s_add_u32 s18, s101, 256
s_and_b32 s18, s18, 1023
s_lshl_b32 s18, s18, 12
v_mfma_f32_16x16x32_bf16 v[76:79], a[188:191], v[48:51], v[76:79]
s_add_u32 s18, s18, s10
s_add_u32 m0, s43, 131072
v_mfma_f32_16x16x32_bf16 v[80:83], a[176:179], v[52:55], v[80:83]
buffer_load_dwordx4 v16, s[24:27], s18 offen lds
v_mfma_f32_16x16x32_bf16 v[84:87], a[180:183], v[52:55], v[84:87]
ds_read_b64_tr_b16 v[44:45], v11 offset:4096
v_cvt_pk_bf16_f32 v224, v224, v225
v_mfma_f32_16x16x32_bf16 v[88:91], a[184:187], v[52:55], v[88:91]
s_waitcnt lgkmcnt(3)
v_cvt_pk_bf16_f32 v225, v226, v227
ds_read_b64_tr_b16 v[46:47], v11 offset:4608
v_mfma_f32_16x16x32_bf16 v[92:95], a[188:191], v[52:55], v[92:95]
s_add_u32 m0, s43, 132096
v_cvt_pk_bf16_f32 v226, v228, v229
v_cvt_pk_bf16_f32 v227, v230, v231
v_mfma_f32_16x16x32_bf16 v[96:99], a[176:179], v[56:59], v[96:99]
s_add_u32 s18, s18, 32768
ds_read_b64_tr_b16 v[48:49], v12 offset:4096
s_add_u32 s62, s58, 16779264
v_mfma_f32_16x16x32_bf16 v[100:103], a[180:183], v[56:59], v[100:103]
buffer_load_dwordx4 v16, s[24:27], s18 offen lds
v_mfma_f32_16x16x32_bf16 v[104:107], a[184:187], v[56:59], v[104:107]
buffer_store_dwordx4 v[224:227], v21, s[36:39], s62 offen sc1
v_mfma_f32_16x16x32_bf16 v[108:111], a[188:191], v[56:59], v[108:111]
ds_read_b64_tr_b16 v[50:51], v12 offset:4608
v_mfma_f32_16x16x32_bf16 v[112:115], a[176:179], v[60:63], v[112:115]
ds_read_b64_tr_b16 v[52:53], v13 offset:4096
v_mfma_f32_16x16x32_bf16 v[116:119], a[180:183], v[60:63], v[116:119]
ds_read_b64_tr_b16 v[54:55], v13 offset:4608
v_mfma_f32_16x16x32_bf16 v[120:123], a[184:187], v[60:63], v[120:123]
s_waitcnt lgkmcnt(6)
v_mfma_f32_16x16x32_bf16 v[124:127], a[188:191], v[60:63], v[124:127]
v_mfma_f32_16x16x32_bf16 v[64:67], a[192:195], v[40:43], v[64:67]
ds_read_b64_tr_b16 v[56:57], v10 offset:20480
v_mfma_f32_16x16x32_bf16 v[68:71], a[196:199], v[40:43], v[68:71]
ds_read_b64_tr_b16 v[58:59], v10 offset:20992
v_mfma_f32_16x16x32_bf16 v[72:75], a[200:203], v[40:43], v[72:75]
s_waitcnt lgkmcnt(6)
v_mfma_f32_16x16x32_bf16 v[76:79], a[204:207], v[40:43], v[76:79]
v_mfma_f32_16x16x32_bf16 v[80:83], a[192:195], v[44:47], v[80:83]
ds_read_b64_tr_b16 v[60:61], v11 offset:20480
v_mfma_f32_16x16x32_bf16 v[84:87], a[196:199], v[44:47], v[84:87]
ds_read_b64_tr_b16 v[62:63], v11 offset:20992
v_cvt_pk_bf16_f32 v232, v232, v233
v_mfma_f32_16x16x32_bf16 v[88:91], a[200:203], v[44:47], v[88:91]
s_waitcnt lgkmcnt(4)
v_cvt_pk_bf16_f32 v233, v234, v235
v_cvt_pk_bf16_f32 v234, v236, v237
v_mfma_f32_16x16x32_bf16 v[92:95], a[204:207], v[44:47], v[92:95]
s_waitcnt vmcnt(40)
v_cvt_pk_bf16_f32 v235, v238, v239
ds_read_b128 a[0:3], v14 offset:32768
v_mfma_f32_16x16x32_bf16 v[96:99], a[192:195], v[48:51], v[96:99]
s_add_u32 s62, s58, 16787456
ds_read_b64_tr_b16 v[40:41], v12 offset:20480
v_mfma_f32_16x16x32_bf16 v[100:103], a[196:199], v[48:51], v[100:103]
buffer_store_dwordx4 v[232:235], v21, s[36:39], s62 offen sc1
v_mfma_f32_16x16x32_bf16 v[104:107], a[200:203], v[48:51], v[104:107]
ds_read_b64_tr_b16 v[42:43], v12 offset:20992
ds_read_b128 a[4:7], v14 offset:34816
v_mfma_f32_16x16x32_bf16 v[108:111], a[204:207], v[48:51], v[108:111]
v_mfma_f32_16x16x32_bf16 v[112:115], a[192:195], v[52:55], v[112:115]
ds_read_b64_tr_b16 v[44:45], v13 offset:20480
v_mfma_f32_16x16x32_bf16 v[116:119], a[196:199], v[52:55], v[116:119]
ds_read_b64_tr_b16 v[46:47], v13 offset:20992
v_mfma_f32_16x16x32_bf16 v[120:123], a[200:203], v[52:55], v[120:123]
s_waitcnt lgkmcnt(6)
ds_read_b128 a[8:11], v14 offset:36864
v_mfma_f32_16x16x32_bf16 v[124:127], a[204:207], v[52:55], v[124:127]
s_barrier
v_mfma_f32_16x16x32_bf16 v[64:67], a[208:211], v[56:59], v[64:67]
ds_read_b64_tr_b16 v[48:49], v10 offset:6144
v_mfma_f32_16x16x32_bf16 v[68:71], a[212:215], v[56:59], v[68:71]
ds_read_b64_tr_b16 v[50:51], v10 offset:6656
v_mfma_f32_16x16x32_bf16 v[72:75], a[216:219], v[56:59], v[72:75]
s_add_u32 s18, s101, 320
ds_read_b128 a[12:15], v14 offset:38912
s_and_b32 s18, s18, 1023
v_mfma_f32_16x16x32_bf16 v[76:79], a[220:223], v[56:59], v[76:79]
s_lshl_b32 s18, s18, 12
s_add_u32 s18, s18, s10
s_add_u32 m0, s43, 133120
v_mfma_f32_16x16x32_bf16 v[80:83], a[208:211], v[60:63], v[80:83]
buffer_load_dwordx4 v16, s[24:27], s18 offen lds
v_mfma_f32_16x16x32_bf16 v[84:87], a[212:215], v[60:63], v[84:87]
ds_read_b64_tr_b16 v[52:53], v11 offset:6144
ds_read_b64_tr_b16 v[54:55], v11 offset:6656
v_mfma_f32_16x16x32_bf16 v[88:91], a[216:219], v[60:63], v[88:91]
s_waitcnt lgkmcnt(6)
v_cvt_pk_bf16_f32 v240, v240, v241
v_cvt_pk_bf16_f32 v241, v242, v243
v_mfma_f32_16x16x32_bf16 v[92:95], a[220:223], v[60:63], v[92:95]
s_add_u32 m0, s43, 134144
ds_read_b128 a[16:19], v15 offset:32768
v_cvt_pk_bf16_f32 v242, v244, v245
v_mfma_f32_16x16x32_bf16 v[96:99], a[208:211], v[40:43], v[96:99]
s_add_u32 s18, s18, 32768
v_cvt_pk_bf16_f32 v243, v246, v247
ds_read_b64_tr_b16 v[56:57], v12 offset:6144
v_mfma_f32_16x16x32_bf16 v[100:103], a[212:215], v[40:43], v[100:103]
buffer_load_dwordx4 v16, s[24:27], s18 offen lds
v_mfma_f32_16x16x32_bf16 v[104:107], a[216:219], v[40:43], v[104:107]
s_add_u32 s62, s58, 16780288
ds_read_b64_tr_b16 v[58:59], v12 offset:6656
ds_read_b128 a[20:23], v15 offset:34816
v_mfma_f32_16x16x32_bf16 v[108:111], a[220:223], v[40:43], v[108:111]
buffer_store_dwordx4 v[240:243], v21, s[36:39], s62 offen sc1
v_mfma_f32_16x16x32_bf16 v[112:115], a[208:211], v[44:47], v[112:115]
ds_read_b64_tr_b16 v[60:61], v13 offset:6144
v_mfma_f32_16x16x32_bf16 v[116:119], a[212:215], v[44:47], v[116:119]
ds_read_b64_tr_b16 v[62:63], v13 offset:6656
v_mfma_f32_16x16x32_bf16 v[120:123], a[216:219], v[44:47], v[120:123]
s_waitcnt lgkmcnt(6)
ds_read_b128 a[24:27], v15 offset:36864
v_mfma_f32_16x16x32_bf16 v[124:127], a[220:223], v[44:47], v[124:127]
v_mfma_f32_16x16x32_bf16 v[64:67], a[224:227], v[48:51], v[64:67]
ds_read_b64_tr_b16 v[40:41], v10 offset:22528
v_mfma_f32_16x16x32_bf16 v[68:71], a[228:231], v[48:51], v[68:71]
ds_read_b64_tr_b16 v[42:43], v10 offset:23040
v_mfma_f32_16x16x32_bf16 v[72:75], a[232:235], v[48:51], v[72:75]
ds_read_b128 a[28:31], v15 offset:38912
v_mfma_f32_16x16x32_bf16 v[76:79], a[236:239], v[48:51], v[76:79]
v_mfma_f32_16x16x32_bf16 v[80:83], a[224:227], v[52:55], v[80:83]
ds_read_b64_tr_b16 v[44:45], v11 offset:22528
v_mfma_f32_16x16x32_bf16 v[84:87], a[228:231], v[52:55], v[84:87]
ds_read_b64_tr_b16 v[46:47], v11 offset:23040
v_mfma_f32_16x16x32_bf16 v[88:91], a[232:235], v[52:55], v[88:91]
s_waitcnt lgkmcnt(6)
v_mfma_f32_16x16x32_bf16 v[92:95], a[236:239], v[52:55], v[92:95]
v_cvt_pk_bf16_f32 v248, v248, v249
v_cvt_pk_bf16_f32 v249, v250, v251
v_mfma_f32_16x16x32_bf16 v[96:99], a[224:227], v[56:59], v[96:99]
ds_read_b64_tr_b16 v[48:49], v12 offset:22528
v_cvt_pk_bf16_f32 v250, v252, v253
v_mfma_f32_16x16x32_bf16 v[100:103], a[228:231], v[56:59], v[100:103]
s_add_u32 s62, s58, 16788480
v_cvt_pk_bf16_f32 v251, v254, v255
ds_read_b64_tr_b16 v[50:51], v12 offset:23040
v_mfma_f32_16x16x32_bf16 v[104:107], a[232:235], v[56:59], v[104:107]
buffer_store_dwordx4 v[248:251], v21, s[36:39], s62 offen sc1
v_mfma_f32_16x16x32_bf16 v[108:111], a[236:239], v[56:59], v[108:111]
v_mfma_f32_16x16x32_bf16 v[112:115], a[224:227], v[60:63], v[112:115]
ds_read_b64_tr_b16 v[52:53], v13 offset:22528
v_mfma_f32_16x16x32_bf16 v[116:119], a[228:231], v[60:63], v[116:119]
ds_read_b64_tr_b16 v[54:55], v13 offset:23040
v_mfma_f32_16x16x32_bf16 v[120:123], a[232:235], v[60:63], v[120:123]
s_waitcnt lgkmcnt(4)
s_add_u32 s100, s101, 384
s_and_b32 s100, s100, 1023
v_mfma_f32_16x16x32_bf16 v[124:127], a[236:239], v[60:63], v[124:127]
s_add_u32 m0, s43, 32768
s_add_u32 s100, s100, s8
v_mfma_f32_16x16x32_bf16 v[64:67], a[240:243], v[40:43], v[64:67]
buffer_load_dwordx4 v19, s[20:23], s100 offen lds
v_mfma_f32_16x16x32_bf16 v[68:71], a[244:247], v[40:43], v[68:71]
s_waitcnt vmcnt(41)
s_barrier
ds_read_b64_tr_b16 v[56:57], v2 offset:0
v_mfma_f32_16x16x32_bf16 v[72:75], a[248:251], v[40:43], v[72:75]
s_add_u32 m0, s43, 33792
ds_read_b64_tr_b16 v[58:59], v2 offset:1024
s_add_u32 s100, s100, 8192
v_mfma_f32_16x16x32_bf16 v[76:79], a[252:255], v[40:43], v[76:79]
buffer_load_dwordx4 v20, s[20:23], s100 offen lds
v_mfma_f32_16x16x32_bf16 v[80:83], a[240:243], v[44:47], v[80:83]
s_add_u32 s18, s101, 384
ds_read_b64_tr_b16 v[60:61], v3 offset:0
s_and_b32 s18, s18, 1023
v_mfma_f32_16x16x32_bf16 v[84:87], a[244:247], v[44:47], v[84:87]
s_lshl_b32 s18, s18, 12
ds_read_b64_tr_b16 v[62:63], v3 offset:1024
s_add_u32 s18, s18, s10
v_mfma_f32_16x16x32_bf16 v[88:91], a[248:251], v[44:47], v[88:91]
s_waitcnt lgkmcnt(4)
s_add_u32 m0, s43, 135168
s_add_u32 s100, s100, 8192
v_mfma_f32_16x16x32_bf16 v[92:95], a[252:255], v[44:47], v[92:95]
buffer_load_dwordx4 v16, s[24:27], s18 offen lds
v_mfma_f32_16x16x32_bf16 v[96:99], a[240:243], v[48:51], v[96:99]
s_add_u32 m0, s43, 34816
ds_read_b64_tr_b16 v[40:41], v4 offset:0
s_add_u32 s18, s18, 32768
v_mfma_f32_16x16x32_bf16 v[100:103], a[244:247], v[48:51], v[100:103]
buffer_load_dwordx4 v19, s[20:23], s100 offen lds
v_mfma_f32_16x16x32_bf16 v[104:107], a[248:251], v[48:51], v[104:107]
s_add_u32 m0, s43, 35840
ds_read_b64_tr_b16 v[42:43], v4 offset:1024
s_add_u32 s100, s100, 8192
v_mfma_f32_16x16x32_bf16 v[108:111], a[252:255], v[48:51], v[108:111]
buffer_load_dwordx4 v20, s[20:23], s100 offen lds
v_mfma_f32_16x16x32_bf16 v[112:115], a[240:243], v[52:55], v[112:115]
s_add_u32 m0, s43, 136192
ds_read_b64_tr_b16 v[44:45], v5 offset:0
s_add_u32 s100, s100, s9
v_mfma_f32_16x16x32_bf16 v[116:119], a[244:247], v[52:55], v[116:119]
buffer_load_dwordx4 v16, s[24:27], s18 offen lds
v_mfma_f32_16x16x32_bf16 v[120:123], a[248:251], v[52:55], v[120:123]
s_waitcnt lgkmcnt(3)
ds_read_b64_tr_b16 v[46:47], v5 offset:1024
s_add_u32 m0, s43, 36864
v_mfma_f32_16x16x32_bf16 v[124:127], a[252:255], v[52:55], v[124:127]
buffer_load_dwordx4 v19, s[20:23], s100 offen lds
v_mfma_f32_16x16x32_bf16 v[128:131], v[56:59], a[0:3], 0
s_add_u32 m0, s43, 37888
ds_read_b64_tr_b16 v[48:49], v6 offset:0
s_add_u32 s100, s100, 8192
v_mfma_f32_16x16x32_bf16 v[132:135], v[56:59], a[4:7], 0
buffer_load_dwordx4 v20, s[20:23], s100 offen lds
v_mfma_f32_16x16x32_bf16 v[136:139], v[56:59], a[8:11], 0
s_add_u32 m0, s43, 38912
ds_read_b64_tr_b16 v[50:51], v6 offset:1024
v_cvt_pk_bf16_f32 v64, v64, v65
v_mfma_f32_16x16x32_bf16 v[140:143], v[56:59], a[12:15], 0
s_add_u32 s100, s100, 8192
v_cvt_pk_bf16_f32 v65, v66, v67
v_cvt_pk_bf16_f32 v66, v68, v69
v_mfma_f32_16x16x32_bf16 v[144:147], v[60:63], a[0:3], 0
buffer_load_dwordx4 v19, s[20:23], s100 offen lds
v_mfma_f32_16x16x32_bf16 v[148:151], v[60:63], a[4:7], 0
s_add_u32 m0, s43, 39936
v_cvt_pk_bf16_f32 v67, v70, v71
ds_read_b64_tr_b16 v[52:53], v7 offset:0
v_mfma_f32_16x16x32_bf16 v[152:155], v[60:63], a[8:11], 0
s_waitcnt lgkmcnt(5)
ds_read_b64_tr_b16 v[54:55], v7 offset:1024
s_add_u32 s100, s100, 8192
v_mfma_f32_16x16x32_bf16 v[156:159], v[60:63], a[12:15], 0
buffer_load_dwordx4 v20, s[20:23], s100 offen lds
v_mfma_f32_16x16x32_bf16 v[160:163], v[40:43], a[0:3], 0
s_add_u32 s62, s58, 16781312
v_mfma_f32_16x16x32_bf16 v[164:167], v[40:43], a[4:7], 0
buffer_store_dwordx4 v[64:67], v21, s[36:39], s62 offen sc1
v_mfma_f32_16x16x32_bf16 v[168:171], v[40:43], a[8:11], 0
s_waitcnt lgkmcnt(4)
s_waitcnt vmcnt(38)
ds_read_b128 a[32:35], v26 offset:0
v_mfma_f32_16x16x32_bf16 v[172:175], v[40:43], a[12:15], 0
s_add_u32 s62, s58, 16789504
v_cvt_pk_bf16_f32 v72, v72, v73
v_cvt_pk_bf16_f32 v73, v74, v75
v_mfma_f32_16x16x32_bf16 v[176:179], v[44:47], a[0:3], 0
ds_read_b64_tr_b16 v[56:57], v8 offset:0
v_cvt_pk_bf16_f32 v74, v76, v77
v_mfma_f32_16x16x32_bf16 v[180:183], v[44:47], a[4:7], 0
v_cvt_pk_bf16_f32 v75, v78, v79
ds_read_b64_tr_b16 v[58:59], v8 offset:1024
v_mfma_f32_16x16x32_bf16 v[184:187], v[44:47], a[8:11], 0
buffer_store_dwordx4 v[72:75], v21, s[36:39], s62 offen sc1
v_mfma_f32_16x16x32_bf16 v[188:191], v[44:47], a[12:15], 0
s_waitcnt lgkmcnt(3)
ds_read_b128 a[36:39], v26 offset:2048
ds_read_b64_tr_b16 v[60:61], v9 offset:0
v_mfma_f32_16x16x32_bf16 v[192:195], v[48:51], a[0:3], 0
s_add_u32 s62, s58, 16782336
v_cvt_pk_bf16_f32 v80, v80, v81
v_cvt_pk_bf16_f32 v81, v82, v83
v_mfma_f32_16x16x32_bf16 v[196:199], v[48:51], a[4:7], 0
ds_read_b64_tr_b16 v[62:63], v9 offset:1024
v_cvt_pk_bf16_f32 v82, v84, v85
v_mfma_f32_16x16x32_bf16 v[200:203], v[48:51], a[8:11], 0
v_cvt_pk_bf16_f32 v83, v86, v87
ds_read_b128 a[40:43], v26 offset:4096
v_mfma_f32_16x16x32_bf16 v[204:207], v[48:51], a[12:15], 0
buffer_store_dwordx4 v[80:83], v21, s[36:39], s62 offen sc1
v_mfma_f32_16x16x32_bf16 v[208:211], v[52:55], a[0:3], 0
s_barrier
ds_read_b64_tr_b16 v[40:41], v2 offset:2048
ds_read_b64_tr_b16 v[42:43], v2 offset:3072
v_mfma_f32_16x16x32_bf16 v[212:215], v[52:55], a[4:7], 0
s_add_u32 s18, s101, 448
v_cvt_pk_bf16_f32 v88, v88, v89
v_cvt_pk_bf16_f32 v89, v90, v91
v_mfma_f32_16x16x32_bf16 v[216:219], v[52:55], a[8:11], 0
s_waitcnt lgkmcnt(6)
v_cvt_pk_bf16_f32 v90, v92, v93
v_cvt_pk_bf16_f32 v91, v94, v95
v_mfma_f32_16x16x32_bf16 v[220:223], v[52:55], a[12:15], 0
s_and_b32 s18, s18, 1023
ds_read_b128 a[44:47], v26 offset:6144
ds_read_b64_tr_b16 v[44:45], v3 offset:2048
v_mfma_f32_16x16x32_bf16 v[224:227], v[56:59], a[0:3], 0
s_lshl_b32 s18, s18, 12
ds_read_b64_tr_b16 v[46:47], v3 offset:3072
v_cvt_pk_bf16_f32 v96, v96, v97
v_mfma_f32_16x16x32_bf16 v[228:231], v[56:59], a[4:7], 0
s_add_u32 s18, s18, s10
v_cvt_pk_bf16_f32 v97, v98, v99
ds_read_b128 a[48:51], v27 offset:0
v_mfma_f32_16x16x32_bf16 v[232:235], v[56:59], a[8:11], 0
s_waitcnt lgkmcnt(7)
v_cvt_pk_bf16_f32 v98, v100, v101
v_cvt_pk_bf16_f32 v99, v102, v103
v_mfma_f32_16x16x32_bf16 v[236:239], v[56:59], a[12:15], 0
s_add_u32 m0, s43, 137216
ds_read_b64_tr_b16 v[48:49], v4 offset:2048
ds_read_b64_tr_b16 v[50:51], v4 offset:3072
v_mfma_f32_16x16x32_bf16 v[240:243], v[60:63], a[0:3], 0
buffer_load_dwordx4 v16, s[24:27], s18 offen lds
v_mfma_f32_16x16x32_bf16 v[244:247], v[60:63], a[4:7], 0
s_add_u32 s62, s58, 16790528
ds_read_b128 a[52:55], v27 offset:2048
v_cvt_pk_bf16_f32 v104, v104, v105
v_mfma_f32_16x16x32_bf16 v[248:251], v[60:63], a[8:11], 0
buffer_store_dwordx4 v[88:91], v21, s[36:39], s62 offen sc1
v_mfma_f32_16x16x32_bf16 v[252:255], v[60:63], a[12:15], 0
s_waitcnt lgkmcnt(7)
v_cvt_pk_bf16_f32 v105, v106, v107
ds_read_b64_tr_b16 v[52:53], v5 offset:2048
v_mfma_f32_16x16x32_bf16 v[128:131], v[40:43], a[16:19], v[128:131]
s_add_u32 m0, s43, 138240
v_cvt_pk_bf16_f32 v106, v108, v109
v_cvt_pk_bf16_f32 v107, v110, v111
v_mfma_f32_16x16x32_bf16 v[132:135], v[40:43], a[20:23], v[132:135]
s_add_u32 s18, s18, 32768
ds_read_b64_tr_b16 v[54:55], v5 offset:3072
ds_read_b128 a[56:59], v27 offset:4096
buffer_load_dwordx4 v16, s[24:27], s18 offen lds
v_mfma_f32_16x16x32_bf16 v[136:139], v[40:43], a[24:27], v[136:139]
s_waitcnt lgkmcnt(7)
ds_read_b64_tr_b16 v[56:57], v6 offset:2048
v_cvt_pk_bf16_f32 v112, v112, v113
v_mfma_f32_16x16x32_bf16 v[140:143], v[40:43], a[28:31], v[140:143]
s_add_u32 s62, s58, 16783360
v_cvt_pk_bf16_f32 v113, v114, v115
ds_read_b64_tr_b16 v[58:59], v6 offset:3072
buffer_store_dwordx4 v[96:99], v21, s[36:39], s62 offen sc1
v_mfma_f32_16x16x32_bf16 v[144:147], v[44:47], a[16:19], v[144:147]
s_add_u32 s62, s58, 16791552
v_cvt_pk_bf16_f32 v114, v116, v117
v_cvt_pk_bf16_f32 v115, v118, v119
v_mfma_f32_16x16x32_bf16 v[148:151], v[44:47], a[20:23], v[148:151]
buffer_store_dwordx4 v[104:107], v21, s[36:39], s62 offen sc1
v_mfma_f32_16x16x32_bf16 v[152:155], v[44:47], a[24:27], v[152:155]
s_waitcnt lgkmcnt(6)
ds_read_b128 a[60:63], v27 offset:6144
ds_read_b64_tr_b16 v[60:61], v7 offset:2048
v_mfma_f32_16x16x32_bf16 v[156:159], v[44:47], a[28:31], v[156:159]
s_add_u32 s62, s58, 16784384
ds_read_b64_tr_b16 v[62:63], v7 offset:3072
v_cvt_pk_bf16_f32 v120, v120, v121
v_mfma_f32_16x16x32_bf16 v[160:163], v[48:51], a[16:19], v[160:163]
buffer_store_dwordx4 v[112:115], v21, s[36:39], s62 offen sc1
v_mfma_f32_16x16x32_bf16 v[164:167], v[48:51], a[20:23], v[164:167]
s_add_u32 s62, s58, 16792576
v_cvt_pk_bf16_f32 v121, v122, v123
v_cvt_pk_bf16_f32 v122, v124, v125
v_mfma_f32_16x16x32_bf16 v[168:171], v[48:51], a[24:27], v[168:171]
s_waitcnt lgkmcnt(6)
v_cvt_pk_bf16_f32 v123, v126, v127
ds_read_b64_tr_b16 v[40:41], v8 offset:2048
v_mfma_f32_16x16x32_bf16 v[172:175], v[48:51], a[28:31], v[172:175]
buffer_store_dwordx4 v[120:123], v21, s[36:39], s62 offen sc1
v_mfma_f32_16x16x32_bf16 v[176:179], v[52:55], a[16:19], v[176:179]
ds_read_b64_tr_b16 v[42:43], v8 offset:3072
ds_read_b64_tr_b16 v[44:45], v9 offset:2048
v_mfma_f32_16x16x32_bf16 v[180:183], v[52:55], a[20:23], v[180:183]
ds_read_b64_tr_b16 v[46:47], v9 offset:3072
v_and_b32 v23, 15, v0
v_mfma_f32_16x16x32_bf16 v[184:187], v[52:55], a[24:27], v[184:187]
s_waitcnt lgkmcnt(7)
s_waitcnt lgkmcnt(6)
v_lshlrev_b32 v24, 2, v22
v_mfma_f32_16x16x32_bf16 v[188:191], v[52:55], a[28:31], v[188:191]
s_add_u32 s100, s101, 512
s_and_b32 s100, s100, 1023
s_add_u32 m0, s43, 65536
v_mfma_f32_16x16x32_bf16 v[192:195], v[56:59], a[16:19], v[192:195]
s_add_u32 s100, s100, s8
v_accvgpr_read_b32 v64, a64
v_accvgpr_read_b32 v65, a65
v_mfma_f32_16x16x32_bf16 v[196:199], v[56:59], a[20:23], v[196:199]
buffer_load_dwordx4 v19, s[20:23], s100 offen lds
v_mfma_f32_16x16x32_bf16 v[200:203], v[56:59], a[24:27], v[200:203]
s_waitcnt lgkmcnt(4)
s_waitcnt vmcnt(43)
s_barrier
v_mfma_f32_16x16x32_bf16 v[204:207], v[56:59], a[28:31], v[204:207]
s_add_u32 m0, s43, 66560
v_sub_u32 v24, v23, v24
ds_read_b64_tr_b16 v[48:49], v2 offset:4096
v_mfma_f32_16x16x32_bf16 v[208:211], v[60:63], a[16:19], v[208:211]
s_add_u32 s100, s100, 8192
v_cmp_le_i32 s[56:57], 0, v24
ds_read_b64_tr_b16 v[50:51], v2 offset:5120
v_mfma_f32_16x16x32_bf16 v[212:215], v[60:63], a[20:23], v[212:215]
buffer_load_dwordx4 v20, s[20:23], s100 offen lds
v_mfma_f32_16x16x32_bf16 v[216:219], v[60:63], a[24:27], v[216:219]
s_waitcnt lgkmcnt(2)
v_cmp_le_i32 s[58:59], 1, v24
v_cmp_le_i32 s[60:61], 2, v24
v_mfma_f32_16x16x32_bf16 v[220:223], v[60:63], a[28:31], v[220:223]
s_add_u32 s18, s101, 512
v_cmp_le_i32 s[62:63], 3, v24
ds_read_b64_tr_b16 v[52:53], v3 offset:4096
v_mfma_f32_16x16x32_bf16 v[224:227], v[40:43], a[16:19], v[224:227]
s_and_b32 s18, s18, 1023
ds_read_b64_tr_b16 v[54:55], v3 offset:5120
ds_read_b64_tr_b16 v[56:57], v4 offset:4096
v_mfma_f32_16x16x32_bf16 v[228:231], v[40:43], a[20:23], v[228:231]
s_lshl_b32 s18, s18, 12
ds_read_b64_tr_b16 v[58:59], v4 offset:5120
s_add_u32 s18, s18, s10
v_mfma_f32_16x16x32_bf16 v[232:235], v[40:43], a[24:27], v[232:235]
s_add_u32 m0, s43, 98304
s_add_u32 s100, s100, 8192
s_lshr_b32 s48, s42, 1
v_mfma_f32_16x16x32_bf16 v[236:239], v[40:43], a[28:31], v[236:239]
buffer_load_dwordx4 v16, s[24:27], s18 offen lds
v_accvgpr_read_b32 v66, a66
v_mfma_f32_16x16x32_bf16 v[240:243], v[44:47], a[16:19], v[240:243]
s_add_u32 m0, s43, 67584
ds_read_b64_tr_b16 v[60:61], v5 offset:4096
s_lshl_b32 s48, s48, 24
v_accvgpr_read_b32 v67, a67
v_mfma_f32_16x16x32_bf16 v[244:247], v[44:47], a[20:23], v[244:247]
buffer_load_dwordx4 v19, s[20:23], s100 offen lds
v_accvgpr_read_b32 v68, a68
v_mfma_f32_16x16x32_bf16 v[248:251], v[44:47], a[24:27], v[248:251]
s_waitcnt lgkmcnt(5)
ds_read_b64_tr_b16 v[62:63], v5 offset:5120
s_add_u32 m0, s43, 68608
v_accvgpr_read_b32 v69, a69
v_mfma_f32_16x16x32_bf16 v[252:255], v[44:47], a[28:31], v[252:255]
s_add_u32 s100, s100, 8192
s_add_u32 s18, s18, 32768
s_lshl_b32 s49, s40, 19
v_accvgpr_read_b32 v70, a70
buffer_load_dwordx4 v20, s[20:23], s100 offen lds
v_mfma_f32_16x16x32_bf16 v[128:131], v[48:51], a[32:35], v[128:131]
s_add_u32 m0, s43, 99328
ds_read_b64_tr_b16 v[40:41], v6 offset:4096
s_add_u32 s100, s100, s9
v_accvgpr_read_b32 v71, a71
v_mfma_f32_16x16x32_bf16 v[132:135], v[48:51], a[36:39], v[132:135]
buffer_load_dwordx4 v16, s[24:27], s18 offen lds
v_accvgpr_read_b32 v72, a72
s_add_u32 m0, s43, 69632
s_nop 0
buffer_load_dwordx4 v19, s[20:23], s100 offen lds
v_mfma_f32_16x16x32_bf16 v[136:139], v[48:51], a[40:43], v[136:139]
s_waitcnt lgkmcnt(3)
ds_read_b64_tr_b16 v[42:43], v6 offset:5120
s_add_u32 s49, s49, s48
v_accvgpr_read_b32 v73, a73
v_mfma_f32_16x16x32_bf16 v[140:143], v[48:51], a[44:47], v[140:143]
s_add_u32 m0, s43, 70656
s_add_u32 s100, s100, 8192
s_lshl_b32 s48, s41, 15
v_accvgpr_read_b32 v74, a74
buffer_load_dwordx4 v20, s[20:23], s100 offen lds
v_mfma_f32_16x16x32_bf16 v[144:147], v[52:55], a[32:35], v[144:147]
s_sub_u32 s48, 524288, s48
ds_read_b64_tr_b16 v[44:45], v7 offset:4096
s_add_u32 m0, s43, 71680
v_accvgpr_read_b32 v75, a75
v_mfma_f32_16x16x32_bf16 v[148:151], v[52:55], a[36:39], v[148:151]
s_add_u32 s100, s100, 8192
ds_read_b64_tr_b16 v[46:47], v7 offset:5120
s_mov_b32 s28, s36
v_accvgpr_read_b32 v76, a76
buffer_load_dwordx4 v19, s[20:23], s100 offen lds
v_mfma_f32_16x16x32_bf16 v[152:155], v[52:55], a[40:43], v[152:155]
s_mov_b32 s29, s37
s_add_u32 m0, s43, 72704
s_add_u32 s100, s100, 8192
v_accvgpr_read_b32 v77, a77
v_mfma_f32_16x16x32_bf16 v[156:159], v[52:55], a[44:47], v[156:159]
buffer_load_dwordx4 v20, s[20:23], s100 offen lds
v_accvgpr_read_b32 v78, a78
s_add_u32 s30, s49, s48
v_mfma_f32_16x16x32_bf16 v[160:163], v[56:59], a[32:35], v[160:163]
s_mov_b32 s31, 0x20000
s_and_b32 s48, s42, 1
s_lshl_b32 s48, s48, 12
v_accvgpr_read_b32 v79, a79
v_mfma_f32_16x16x32_bf16 v[164:167], v[56:59], a[36:39], v[164:167]
s_add_u32 s49, s49, s48
s_lshl_b32 s52, s41, 2
s_add_u32 s53, s52, s42
v_mfma_f32_16x16x32_bf16 v[168:171], v[56:59], a[40:43], v[168:171]
s_waitcnt lgkmcnt(4)
s_sub_u32 s54, 60, s52
s_xor_b32 s55, s42, 1
v_mfma_f32_16x16x32_bf16 v[172:175], v[56:59], a[44:47], v[172:175]
s_add_u32 s55, s55, s54
s_waitcnt vmcnt(42)
ds_read_b128 a[64:67], v14 offset:0
v_mfma_f32_16x16x32_bf16 v[176:179], v[60:63], a[32:35], v[176:179]
s_add_u32 s54, s54, s42
ds_read_b64_tr_b16 v[48:49], v8 offset:4096
ds_read_b64_tr_b16 v[50:51], v8 offset:5120
v_mfma_f32_16x16x32_bf16 v[180:183], v[60:63], a[36:39], v[180:183]
s_add_u32 s52, s52, 4
ds_read_b128 a[68:71], v14 offset:2048
ds_read_b64_tr_b16 v[52:53], v9 offset:4096
v_mfma_f32_16x16x32_bf16 v[184:187], v[60:63], a[40:43], v[184:187]
s_waitcnt lgkmcnt(5)
ds_read_b64_tr_b16 v[54:55], v9 offset:5120
ds_read_b128 a[72:75], v14 offset:4096
v_mfma_f32_16x16x32_bf16 v[188:191], v[60:63], a[44:47], v[188:191]
s_mov_b32 s19, s53
s_and_b32 s48, s42, 2
s_add_u32 s45, s52, s48
v_mfma_f32_16x16x32_bf16 v[192:195], v[40:43], a[32:35], v[192:195]
s_sub_u32 s45, s45, 2
s_mov_b32 s50, 63
s_mov_b32 s51, 0
v_mfma_f32_16x16x32_bf16 v[196:199], v[40:43], a[36:39], v[196:199]
s_lshl_b64 s[50:51], s[50:51], s52
s_waitcnt vmcnt(39)
s_barrier
v_mfma_f32_16x16x32_bf16 v[200:203], v[40:43], a[40:43], v[200:203]
s_lshr_b64 s[50:51], s[50:51], 5
ds_read_b64_tr_b16 v[56:57], v2 offset:6144
ds_read_b64_tr_b16 v[58:59], v2 offset:7168
v_mfma_f32_16x16x32_bf16 v[204:207], v[40:43], a[44:47], v[204:207]
s_or_b32 s50, s50, 2818605568
ds_read_b128 a[76:79], v14 offset:6144
s_or_b32 s51, s51, 1
v_mfma_f32_16x16x32_bf16 v[208:211], v[44:47], a[32:35], v[208:211]
s_add_u32 s18, s101, 576
ds_read_b64_tr_b16 v[60:61], v3 offset:6144
s_and_b32 s18, s18, 1023
v_mfma_f32_16x16x32_bf16 v[212:215], v[44:47], a[36:39], v[212:215]
s_lshl_b32 s18, s18, 12
ds_read_b64_tr_b16 v[62:63], v3 offset:7168
s_add_u32 s18, s18, s10
v_mfma_f32_16x16x32_bf16 v[216:219], v[44:47], a[40:43], v[216:219]
s_waitcnt lgkmcnt(9)
ds_read_b128 a[80:83], v15 offset:0
s_add_u32 m0, s43, 100352
v_mfma_f32_16x16x32_bf16 v[220:223], v[44:47], a[44:47], v[220:223]
buffer_load_dwordx4 v16, s[24:27], s18 offen lds
v_mfma_f32_16x16x32_bf16 v[224:227], v[48:51], a[32:35], v[224:227]
s_mov_b32 s44, 0
ds_read_b64_tr_b16 v[40:41], v4 offset:6144
s_mov_b32 s46, 16384
v_mfma_f32_16x16x32_bf16 v[228:231], v[48:51], a[36:39], v[228:231]
s_and_b32 s48, s42, 1
ds_read_b64_tr_b16 v[42:43], v4 offset:7168
s_add_u32 s48, s48, 2
v_mfma_f32_16x16x32_bf16 v[232:235], v[48:51], a[40:43], v[232:235]
s_waitcnt lgkmcnt(9)
ds_read_b128 a[84:87], v15 offset:2048
s_add_u32 m0, s43, 101376
v_mfma_f32_16x16x32_bf16 v[236:239], v[48:51], a[44:47], v[236:239]
s_add_u32 s18, s18, 32768
s_sub_u32 s48, s48, s52
s_lshl_b32 s47, s48, 14
v_mfma_f32_16x16x32_bf16 v[240:243], v[52:55], a[32:35], v[240:243]
buffer_load_dwordx4 v16, s[24:27], s18 offen lds
v_mfma_f32_16x16x32_bf16 v[244:247], v[52:55], a[36:39], v[244:247]
s_lshl_b32 s48, s40, 12
ds_read_b64_tr_b16 v[44:45], v5 offset:6144
ds_read_b64_tr_b16 v[46:47], v5 offset:7168
v_mfma_f32_16x16x32_bf16 v[248:251], v[52:55], a[40:43], v[248:251]
s_waitcnt lgkmcnt(6)
ds_read_b128 a[88:91], v15 offset:4096
s_add_u32 s48, s48, 33554432
v_mfma_f32_16x16x32_bf16 v[252:255], v[52:55], a[44:47], v[252:255]
s_lshl_b32 s66, s53, 18
s_add_u32 s66, s66, s48
s_lshl_b32 s67, s54, 18
v_mfma_f32_16x16x32_bf16 v[128:131], v[56:59], a[48:51], v[128:131]
s_add_u32 s67, s67, s48
ds_read_b64_tr_b16 v[48:49], v6 offset:6144
s_mov_b64 s[32:33], 0
v_mfma_f32_16x16x32_bf16 v[132:135], v[56:59], a[52:55], v[132:135]
s_mov_b64 s[34:35], 0
ds_read_b64_tr_b16 v[50:51], v6 offset:7168
s_mov_b32 s12, 0x05040100
v_mfma_f32_16x16x32_bf16 v[136:139], v[56:59], a[56:59], v[136:139]
ds_read_b128 a[92:95], v15 offset:6144
v_perm_b32 v88, v68, v64, s12
v_mfma_f32_16x16x32_bf16 v[140:143], v[56:59], a[60:63], v[140:143]
s_mov_b32 s13, 0x07060302
v_perm_b32 v89, v68, v64, s13
v_dot2_f32_bf16 v96, v88, v32, 0
v_mfma_f32_16x16x32_bf16 v[144:147], v[60:63], a[48:51], v[144:147]
ds_read_b64_tr_b16 v[52:53], v7 offset:6144
v_dot2_f32_bf16 v97, v88, v33, 0
v_mfma_f32_16x16x32_bf16 v[148:151], v[60:63], a[52:55], v[148:151]
ds_read_b64_tr_b16 v[54:55], v7 offset:7168
v_perm_b32 v90, v69, v65, s12
v_mfma_f32_16x16x32_bf16 v[152:155], v[60:63], a[56:59], v[152:155]
s_waitcnt lgkmcnt(6)
v_dot2_f32_bf16 v98, v89, v32, 0
v_dot2_f32_bf16 v99, v89, v33, 0
v_mfma_f32_16x16x32_bf16 v[156:159], v[60:63], a[60:63], v[156:159]
v_perm_b32 v91, v69, v65, s13
v_dot2_f32_bf16 v100, v90, v32, 0
v_mfma_f32_16x16x32_bf16 v[160:163], v[40:43], a[48:51], v[160:163]
ds_read_b64_tr_b16 v[56:57], v8 offset:6144
v_dot2_f32_bf16 v101, v90, v33, 0
v_mfma_f32_16x16x32_bf16 v[164:167], v[40:43], a[52:55], v[164:167]
ds_read_b64_tr_b16 v[58:59], v8 offset:7168
v_perm_b32 v88, v70, v66, s12
v_mfma_f32_16x16x32_bf16 v[168:171], v[40:43], a[56:59], v[168:171]
v_dot2_f32_bf16 v102, v91, v32, 0
v_dot2_f32_bf16 v103, v91, v33, 0
v_mfma_f32_16x16x32_bf16 v[172:175], v[40:43], a[60:63], v[172:175]
v_perm_b32 v89, v70, v66, s13
v_dot2_f32_bf16 v104, v88, v32, 0
v_mfma_f32_16x16x32_bf16 v[176:179], v[44:47], a[48:51], v[176:179]
ds_read_b64_tr_b16 v[60:61], v9 offset:6144
v_dot2_f32_bf16 v105, v88, v33, 0
v_mfma_f32_16x16x32_bf16 v[180:183], v[44:47], a[52:55], v[180:183]
ds_read_b64_tr_b16 v[62:63], v9 offset:7168
v_perm_b32 v90, v71, v67, s12
v_mfma_f32_16x16x32_bf16 v[184:187], v[44:47], a[56:59], v[184:187]
s_waitcnt lgkmcnt(4)
s_add_u32 s100, s101, 640
s_and_b32 s100, s100, 1023
v_mfma_f32_16x16x32_bf16 v[188:191], v[44:47], a[60:63], v[188:191]
s_add_u32 m0, s43, 0
s_add_u32 s100, s100, s8
v_dot2_f32_bf16 v106, v89, v32, 0
v_mfma_f32_16x16x32_bf16 v[192:195], v[48:51], a[48:51], v[192:195]
buffer_load_dwordx4 v19, s[20:23], s100 offen lds
v_mfma_f32_16x16x32_bf16 v[196:199], v[48:51], a[52:55], v[196:199]
s_waitcnt vmcnt(39)
s_barrier
ds_read_b64_tr_b16 v[40:41], v2 offset:32768
v_mfma_f32_16x16x32_bf16 v[200:203], v[48:51], a[56:59], v[200:203]
s_add_u32 m0, s43, 1024
ds_read_b64_tr_b16 v[42:43], v2 offset:33792
s_add_u32 s100, s100, 8192
v_mfma_f32_16x16x32_bf16 v[204:207], v[48:51], a[60:63], v[204:207]
buffer_load_dwordx4 v20, s[20:23], s100 offen lds
v_mfma_f32_16x16x32_bf16 v[208:211], v[52:55], a[48:51], v[208:211]
s_add_u32 s18, s101, 640
ds_read_b64_tr_b16 v[44:45], v3 offset:32768
s_and_b32 s18, s18, 1023
v_mfma_f32_16x16x32_bf16 v[212:215], v[52:55], a[52:55], v[212:215]
s_lshl_b32 s18, s18, 12
ds_read_b64_tr_b16 v[46:47], v3 offset:33792
s_add_u32 s18, s18, s10
v_mfma_f32_16x16x32_bf16 v[216:219], v[52:55], a[56:59], v[216:219]
s_waitcnt lgkmcnt(4)
s_add_u32 m0, s43, 102400
s_add_u32 s100, s100, 8192
v_mfma_f32_16x16x32_bf16 v[220:223], v[52:55], a[60:63], v[220:223]
buffer_load_dwordx4 v16, s[24:27], s18 offen lds
v_mfma_f32_16x16x32_bf16 v[224:227], v[56:59], a[48:51], v[224:227]
s_add_u32 m0, s43, 2048
ds_read_b64_tr_b16 v[48:49], v4 offset:32768
s_add_u32 s18, s18, 32768
v_mfma_f32_16x16x32_bf16 v[228:231], v[56:59], a[52:55], v[228:231]
buffer_load_dwordx4 v19, s[20:23], s100 offen lds
v_mfma_f32_16x16x32_bf16 v[232:235], v[56:59], a[56:59], v[232:235]
s_add_u32 m0, s43, 3072
ds_read_b64_tr_b16 v[50:51], v4 offset:33792
s_add_u32 s100, s100, 8192
v_mfma_f32_16x16x32_bf16 v[236:239], v[56:59], a[60:63], v[236:239]
buffer_load_dwordx4 v20, s[20:23], s100 offen lds
v_mfma_f32_16x16x32_bf16 v[240:243], v[60:63], a[48:51], v[240:243]
s_add_u32 m0, s43, 103424
ds_read_b64_tr_b16 v[52:53], v5 offset:32768
s_add_u32 s100, s100, s9
v_mfma_f32_16x16x32_bf16 v[244:247], v[60:63], a[52:55], v[244:247]
buffer_load_dwordx4 v16, s[24:27], s18 offen lds
v_mfma_f32_16x16x32_bf16 v[248:251], v[60:63], a[56:59], v[248:251]
s_waitcnt lgkmcnt(3)
ds_read_b64_tr_b16 v[54:55], v5 offset:33792
s_add_u32 m0, s43, 4096
v_mfma_f32_16x16x32_bf16 v[252:255], v[60:63], a[60:63], v[252:255]
buffer_load_dwordx4 v19, s[20:23], s100 offen lds
v_mfma_f32_16x16x32_bf16 v[128:131], v[40:43], a[64:67], v[128:131]
s_add_u32 m0, s43, 5120
ds_read_b64_tr_b16 v[56:57], v6 offset:32768
s_add_u32 s100, s100, 8192
v_mfma_f32_16x16x32_bf16 v[132:135], v[40:43], a[68:71], v[132:135]
buffer_load_dwordx4 v20, s[20:23], s100 offen lds
v_mfma_f32_16x16x32_bf16 v[136:139], v[40:43], a[72:75], v[136:139]
s_add_u32 m0, s43, 6144
ds_read_b64_tr_b16 v[58:59], v6 offset:33792
s_add_u32 s100, s100, 8192
v_mfma_f32_16x16x32_bf16 v[140:143], v[40:43], a[76:79], v[140:143]
buffer_load_dwordx4 v19, s[20:23], s100 offen lds
v_mfma_f32_16x16x32_bf16 v[144:147], v[44:47], a[64:67], v[144:147]
s_add_u32 m0, s43, 7168
ds_read_b64_tr_b16 v[60:61], v7 offset:32768
s_add_u32 s100, s100, 8192
v_mfma_f32_16x16x32_bf16 v[148:151], v[44:47], a[68:71], v[148:151]
buffer_load_dwordx4 v20, s[20:23], s100 offen lds
v_mfma_f32_16x16x32_bf16 v[152:155], v[44:47], a[72:75], v[152:155]
s_waitcnt lgkmcnt(5)
ds_read_b64_tr_b16 v[62:63], v7 offset:33792
s_waitcnt vmcnt(32)
v_mfma_f32_16x16x32_bf16 v[156:159], v[44:47], a[76:79], v[156:159]
ds_read_b128 a[96:99], v14 offset:32768
v_dot2_f32_bf16 v107, v89, v33, 0
v_mfma_f32_16x16x32_bf16 v[160:163], v[48:51], a[64:67], v[160:163]
ds_read_b64_tr_b16 v[40:41], v8 offset:32768
v_perm_b32 v91, v71, v67, s13
v_mfma_f32_16x16x32_bf16 v[164:167], v[48:51], a[68:71], v[164:167]
ds_read_b64_tr_b16 v[42:43], v8 offset:33792
v_dot2_f32_bf16 v108, v90, v32, 0
v_mfma_f32_16x16x32_bf16 v[168:171], v[48:51], a[72:75], v[168:171]
s_waitcnt lgkmcnt(7)
ds_read_b128 a[100:103], v14 offset:34816
v_dot2_f32_bf16 v109, v90, v33, 0
v_mfma_f32_16x16x32_bf16 v[172:175], v[48:51], a[76:79], v[172:175]
v_dot2_f32_bf16 v110, v91, v32, 0
v_dot2_f32_bf16 v111, v91, v33, 0
v_mfma_f32_16x16x32_bf16 v[176:179], v[52:55], a[64:67], v[176:179]
ds_read_b64_tr_b16 v[44:45], v9 offset:32768
v_perm_b32 v88, v76, v72, s12
v_mfma_f32_16x16x32_bf16 v[180:183], v[52:55], a[68:71], v[180:183]
ds_read_b64_tr_b16 v[46:47], v9 offset:33792
v_perm_b32 v89, v76, v72, s13
v_mfma_f32_16x16x32_bf16 v[184:187], v[52:55], a[72:75], v[184:187]
s_waitcnt lgkmcnt(8)
ds_read_b128 a[104:107], v14 offset:36864
v_dot2_f32_bf16 v112, v88, v32, 0
v_mfma_f32_16x16x32_bf16 v[188:191], v[52:55], a[76:79], v[188:191]
s_barrier
v_dot2_f32_bf16 v113, v88, v33, 0
v_perm_b32 v90, v77, v73, s12
v_mfma_f32_16x16x32_bf16 v[192:195], v[56:59], a[64:67], v[192:195]
ds_read_b64_tr_b16 v[48:49], v2 offset:34816
v_dot2_f32_bf16 v114, v89, v32, 0
v_mfma_f32_16x16x32_bf16 v[196:199], v[56:59], a[68:71], v[196:199]
ds_read_b64_tr_b16 v[50:51], v2 offset:35840
v_dot2_f32_bf16 v115, v89, v33, 0
v_mfma_f32_16x16x32_bf16 v[200:203], v[56:59], a[72:75], v[200:203]
s_waitcnt lgkmcnt(6)
ds_read_b128 a[108:111], v14 offset:38912
s_add_u32 s18, s101, 704
v_mfma_f32_16x16x32_bf16 v[204:207], v[56:59], a[76:79], v[204:207]
s_and_b32 s18, s18, 1023
s_lshl_b32 s18, s18, 12
s_add_u32 s18, s18, s10
v_mfma_f32_16x16x32_bf16 v[208:211], v[60:63], a[64:67], v[208:211]
s_add_u32 m0, s43, 104448
ds_read_b64_tr_b16 v[52:53], v3 offset:34816
v_perm_b32 v91, v77, v73, s13
v_mfma_f32_16x16x32_bf16 v[212:215], v[60:63], a[68:71], v[212:215]
buffer_load_dwordx4 v16, s[24:27], s18 offen lds
v_mfma_f32_16x16x32_bf16 v[216:219], v[60:63], a[72:75], v[216:219]
s_add_u32 m0, s43, 105472
ds_read_b64_tr_b16 v[54:55], v3 offset:35840
ds_read_b128 a[112:115], v15 offset:32768
v_mfma_f32_16x16x32_bf16 v[220:223], v[60:63], a[76:79], v[220:223]
s_add_u32 s18, s18, 32768
v_dot2_f32_bf16 v116, v90, v32, 0
v_dot2_f32_bf16 v117, v90, v33, 0
v_mfma_f32_16x16x32_bf16 v[224:227], v[40:43], a[64:67], v[224:227]
buffer_load_dwordx4 v16, s[24:27], s18 offen lds
v_mfma_f32_16x16x32_bf16 v[228:231], v[40:43], a[68:71], v[228:231]
ds_read_b64_tr_b16 v[56:57], v4 offset:34816
ds_read_b64_tr_b16 v[58:59], v4 offset:35840
v_mfma_f32_16x16x32_bf16 v[232:235], v[40:43], a[72:75], v[232:235]
s_waitcnt lgkmcnt(6)
ds_read_b128 a[116:119], v15 offset:34816
v_perm_b32 v88, v78, v74, s12
v_mfma_f32_16x16x32_bf16 v[236:239], v[40:43], a[76:79], v[236:239]
v_dot2_f32_bf16 v118, v91, v32, 0
v_dot2_f32_bf16 v119, v91, v33, 0
v_mfma_f32_16x16x32_bf16 v[240:243], v[44:47], a[64:67], v[240:243]
ds_read_b64_tr_b16 v[60:61], v5 offset:34816
v_perm_b32 v89, v78, v74, s13
v_mfma_f32_16x16x32_bf16 v[244:247], v[44:47], a[68:71], v[244:247]
ds_read_b64_tr_b16 v[62:63], v5 offset:35840
v_dot2_f32_bf16 v120, v88, v32, 0
v_mfma_f32_16x16x32_bf16 v[248:251], v[44:47], a[72:75], v[248:251]
ds_read_b128 a[120:123], v15 offset:36864
v_dot2_f32_bf16 v121, v88, v33, 0
v_mfma_f32_16x16x32_bf16 v[252:255], v[44:47], a[76:79], v[252:255]
v_perm_b32 v90, v79, v75, s12
v_dot2_f32_bf16 v122, v89, v32, 0
v_mfma_f32_16x16x32_bf16 v[128:131], v[48:51], a[80:83], v[128:131]
ds_read_b64_tr_b16 v[40:41], v6 offset:34816
v_dot2_f32_bf16 v123, v89, v33, 0
v_mfma_f32_16x16x32_bf16 v[132:135], v[48:51], a[84:87], v[132:135]
ds_read_b64_tr_b16 v[42:43], v6 offset:35840
v_perm_b32 v91, v79, v75, s13
v_mfma_f32_16x16x32_bf16 v[136:139], v[48:51], a[88:91], v[136:139]
s_waitcnt lgkmcnt(6)
ds_read_b128 a[124:127], v15 offset:38912
v_dot2_f32_bf16 v124, v90, v32, 0
v_mfma_f32_16x16x32_bf16 v[140:143], v[48:51], a[92:95], v[140:143]
v_dot2_f32_bf16 v125, v90, v33, 0
v_dot2_f32_bf16 v126, v91, v32, 0
v_mfma_f32_16x16x32_bf16 v[144:147], v[52:55], a[80:83], v[144:147]
ds_read_b64_tr_b16 v[44:45], v7 offset:34816
v_dot2_f32_bf16 v127, v91, v33, 0
v_mfma_f32_16x16x32_bf16 v[148:151], v[52:55], a[84:87], v[148:151]
ds_read_b64_tr_b16 v[46:47], v7 offset:35840
v_permlane32_swap_b32 v96, v104
v_mfma_f32_16x16x32_bf16 v[152:155], v[52:55], a[88:91], v[152:155]
v_permlane32_swap_b32 v97, v105
v_permlane32_swap_b32 v98, v106
v_mfma_f32_16x16x32_bf16 v[156:159], v[52:55], a[92:95], v[156:159]
v_permlane32_swap_b32 v99, v107
v_permlane32_swap_b32 v100, v108
v_mfma_f32_16x16x32_bf16 v[160:163], v[56:59], a[80:83], v[160:163]
ds_read_b64_tr_b16 v[48:49], v8 offset:34816
v_permlane32_swap_b32 v101, v109
v_mfma_f32_16x16x32_bf16 v[164:167], v[56:59], a[84:87], v[164:167]
ds_read_b64_tr_b16 v[50:51], v8 offset:35840
v_permlane32_swap_b32 v102, v110
v_mfma_f32_16x16x32_bf16 v[168:171], v[56:59], a[88:91], v[168:171]
s_waitcnt lgkmcnt(5)
v_permlane32_swap_b32 v103, v111
v_add_f32 v96, v96, v104
v_mfma_f32_16x16x32_bf16 v[172:175], v[56:59], a[92:95], v[172:175]
v_add_f32 v97, v97, v105
v_add_f32 v98, v98, v106
v_mfma_f32_16x16x32_bf16 v[176:179], v[60:63], a[80:83], v[176:179]
s_add_u32 s17, s15, s41
ds_read_b64_tr_b16 v[52:53], v9 offset:34816
v_mov_b32 v30, -1
v_mfma_f32_16x16x32_bf16 v[180:183], v[60:63], a[84:87], v[180:183]
ds_read_b64_tr_b16 v[54:55], v9 offset:35840
v_add_f32 v99, v99, v107
v_mfma_f32_16x16x32_bf16 v[184:187], v[60:63], a[88:91], v[184:187]
s_waitcnt lgkmcnt(6)
s_add_u32 s100, s101, 768
s_and_b32 s100, s100, 1023
v_mfma_f32_16x16x32_bf16 v[188:191], v[60:63], a[92:95], v[188:191]
s_add_u32 m0, s43, 32768
s_add_u32 s100, s100, s8
v_add_f32 v100, v100, v108
v_mfma_f32_16x16x32_bf16 v[192:195], v[40:43], a[80:83], v[192:195]
buffer_load_dwordx4 v19, s[20:23], s100 offen lds
v_mfma_f32_16x16x32_bf16 v[196:199], v[40:43], a[84:87], v[196:199]
s_waitcnt vmcnt(25)
s_barrier
ds_read_b64_tr_b16 v[56:57], v2 offset:36864
v_mfma_f32_16x16x32_bf16 v[200:203], v[40:43], a[88:91], v[200:203]
s_waitcnt lgkmcnt(3)
ds_read_b64_tr_b16 v[58:59], v2 offset:37888
s_add_u32 m0, s43, 33792
v_mfma_f32_16x16x32_bf16 v[204:207], v[40:43], a[92:95], v[204:207]
s_add_u32 s100, s100, 8192
s_add_u32 s18, s101, 768
s_and_b32 s18, s18, 1023
v_mfma_f32_16x16x32_bf16 v[208:211], v[44:47], a[80:83], v[208:211]
buffer_load_dwordx4 v20, s[20:23], s100 offen lds
v_mfma_f32_16x16x32_bf16 v[212:215], v[44:47], a[84:87], v[212:215]
buffer_store_byte v30, v28, s[36:39], s17 offen offset:4 sc1
v_mfma_f32_16x16x32_bf16 v[216:219], v[44:47], a[88:91], v[216:219]
s_lshl_b32 s18, s18, 12
ds_read_b64_tr_b16 v[60:61], v3 offset:36864
ds_read_b64_tr_b16 v[62:63], v3 offset:37888
v_mfma_f32_16x16x32_bf16 v[220:223], v[44:47], a[92:95], v[220:223]
s_add_u32 s18, s18, s10
s_add_u32 m0, s43, 131072
s_add_u32 s100, s100, 8192
v_mfma_f32_16x16x32_bf16 v[224:227], v[48:51], a[80:83], v[224:227]
buffer_load_dwordx4 v16, s[24:27], s18 offen lds
v_mfma_f32_16x16x32_bf16 v[228:231], v[48:51], a[84:87], v[228:231]
s_add_u32 m0, s43, 34816
ds_read_b64_tr_b16 v[40:41], v4 offset:36864
ds_read_b64_tr_b16 v[42:43], v4 offset:37888
v_mfma_f32_16x16x32_bf16 v[232:235], v[48:51], a[88:91], v[232:235]
buffer_load_dwordx4 v19, s[20:23], s100 offen lds
v_mfma_f32_16x16x32_bf16 v[236:239], v[48:51], a[92:95], v[236:239]
s_waitcnt lgkmcnt(4)
s_add_u32 m0, s43, 35840
s_add_u32 s100, s100, 8192
v_mfma_f32_16x16x32_bf16 v[240:243], v[52:55], a[80:83], v[240:243]
buffer_load_dwordx4 v20, s[20:23], s100 offen lds
v_mfma_f32_16x16x32_bf16 v[244:247], v[52:55], a[84:87], v[244:247]
s_add_u32 m0, s43, 132096
ds_read_b64_tr_b16 v[44:45], v5 offset:36864
ds_read_b64_tr_b16 v[46:47], v5 offset:37888
v_mfma_f32_16x16x32_bf16 v[248:251], v[52:55], a[88:91], v[248:251]
s_add_u32 s18, s18, 32768
s_add_u32 s100, s100, s9
v_add_f32 v101, v101, v109
v_mfma_f32_16x16x32_bf16 v[252:255], v[52:55], a[92:95], v[252:255]
buffer_load_dwordx4 v16, s[24:27], s18 offen lds
v_mfma_f32_16x16x32_bf16 v[128:131], v[56:59], a[96:99], v[128:131]
s_add_u32 m0, s43, 36864
ds_read_b64_tr_b16 v[48:49], v6 offset:36864
v_add_f32 v102, v102, v110
v_mfma_f32_16x16x32_bf16 v[132:135], v[56:59], a[100:103], v[132:135]
buffer_load_dwordx4 v19, s[20:23], s100 offen lds
v_mfma_f32_16x16x32_bf16 v[136:139], v[56:59], a[104:107], v[136:139]
s_waitcnt lgkmcnt(3)
ds_read_b64_tr_b16 v[50:51], v6 offset:37888
s_add_u32 m0, s43, 37888
v_mfma_f32_16x16x32_bf16 v[140:143], v[56:59], a[108:111], v[140:143]
s_add_u32 s100, s100, 8192
v_add_f32 v103, v103, v111
v_permlane32_swap_b32 v112, v120
buffer_load_dwordx4 v20, s[20:23], s100 offen lds
v_mfma_f32_16x16x32_bf16 v[144:147], v[60:63], a[96:99], v[144:147]
s_add_u32 m0, s43, 38912
ds_read_b64_tr_b16 v[52:53], v7 offset:36864
s_add_u32 s100, s100, 8192
v_mfma_f32_16x16x32_bf16 v[148:151], v[60:63], a[100:103], v[148:151]
buffer_load_dwordx4 v19, s[20:23], s100 offen lds
v_mfma_f32_16x16x32_bf16 v[152:155], v[60:63], a[104:107], v[152:155]
s_add_u32 m0, s43, 39936
ds_read_b64_tr_b16 v[54:55], v7 offset:37888
s_add_u32 s100, s100, 8192
v_mfma_f32_16x16x32_bf16 v[156:159], v[60:63], a[108:111], v[156:159]
buffer_load_dwordx4 v20, s[20:23], s100 offen lds
v_mfma_f32_16x16x32_bf16 v[160:163], v[40:43], a[96:99], v[160:163]
s_waitcnt vmcnt(25)
ds_read_b128 a[128:131], v26 offset:0
ds_read_b64_tr_b16 v[56:57], v8 offset:36864
v_mfma_f32_16x16x32_bf16 v[164:167], v[40:43], a[100:103], v[164:167]
ds_read_b64_tr_b16 v[58:59], v8 offset:37888
v_permlane32_swap_b32 v113, v121
v_mfma_f32_16x16x32_bf16 v[168:171], v[40:43], a[104:107], v[168:171]
s_waitcnt lgkmcnt(7)
ds_read_b128 a[132:135], v26 offset:2048
v_permlane32_swap_b32 v114, v122
v_mfma_f32_16x16x32_bf16 v[172:175], v[40:43], a[108:111], v[172:175]
v_permlane32_swap_b32 v115, v123
v_permlane32_swap_b32 v116, v124
v_mfma_f32_16x16x32_bf16 v[176:179], v[44:47], a[96:99], v[176:179]
ds_read_b64_tr_b16 v[60:61], v9 offset:36864
v_permlane32_swap_b32 v117, v125
v_mfma_f32_16x16x32_bf16 v[180:183], v[44:47], a[100:103], v[180:183]
ds_read_b64_tr_b16 v[62:63], v9 offset:37888
v_permlane32_swap_b32 v118, v126
v_mfma_f32_16x16x32_bf16 v[184:187], v[44:47], a[104:107], v[184:187]
s_waitcnt lgkmcnt(8)
ds_read_b128 a[136:139], v26 offset:4096
v_permlane32_swap_b32 v119, v127
v_mfma_f32_16x16x32_bf16 v[188:191], v[44:47], a[108:111], v[188:191]
s_barrier
v_add_f32 v112, v112, v120
v_add_f32 v113, v113, v121
v_mfma_f32_16x16x32_bf16 v[192:195], v[48:51], a[96:99], v[192:195]
ds_read_b64_tr_b16 v[40:41], v2 offset:38912
v_add_f32 v114, v114, v122
v_mfma_f32_16x16x32_bf16 v[196:199], v[48:51], a[100:103], v[196:199]
ds_read_b64_tr_b16 v[42:43], v2 offset:39936
v_add_f32 v115, v115, v123
v_mfma_f32_16x16x32_bf16 v[200:203], v[48:51], a[104:107], v[200:203]
s_waitcnt lgkmcnt(6)
ds_read_b128 a[140:143], v26 offset:6144
s_add_u32 s18, s101, 832
v_mfma_f32_16x16x32_bf16 v[204:207], v[48:51], a[108:111], v[204:207]
s_and_b32 s18, s18, 1023
s_lshl_b32 s18, s18, 12
s_add_u32 s18, s18, s10
v_mfma_f32_16x16x32_bf16 v[208:211], v[52:55], a[96:99], v[208:211]
s_add_u32 m0, s43, 133120
ds_read_b64_tr_b16 v[44:45], v3 offset:38912
v_add_f32 v116, v116, v124
v_mfma_f32_16x16x32_bf16 v[212:215], v[52:55], a[100:103], v[212:215]
buffer_load_dwordx4 v16, s[24:27], s18 offen lds
v_mfma_f32_16x16x32_bf16 v[216:219], v[52:55], a[104:107], v[216:219]
s_add_u32 m0, s43, 134144
ds_read_b64_tr_b16 v[46:47], v3 offset:39936
ds_read_b128 a[144:147], v27 offset:0
v_mfma_f32_16x16x32_bf16 v[220:223], v[52:55], a[108:111], v[220:223]
s_add_u32 s18, s18, 32768
v_add_f32 v117, v117, v125
v_add_f32 v118, v118, v126
v_mfma_f32_16x16x32_bf16 v[224:227], v[56:59], a[96:99], v[224:227]
buffer_load_dwordx4 v16, s[24:27], s18 offen lds
v_mfma_f32_16x16x32_bf16 v[228:231], v[56:59], a[100:103], v[228:231]
ds_read_b64_tr_b16 v[48:49], v4 offset:38912
ds_read_b64_tr_b16 v[50:51], v4 offset:39936
v_mfma_f32_16x16x32_bf16 v[232:235], v[56:59], a[104:107], v[232:235]
s_waitcnt lgkmcnt(6)
ds_read_b128 a[148:151], v27 offset:2048
v_add_f32 v119, v119, v127
v_mfma_f32_16x16x32_bf16 v[236:239], v[56:59], a[108:111], v[236:239]
v_permlane16_swap_b32 v96, v100
v_permlane16_swap_b32 v97, v101
v_mfma_f32_16x16x32_bf16 v[240:243], v[60:63], a[96:99], v[240:243]
ds_read_b64_tr_b16 v[52:53], v5 offset:38912
v_permlane16_swap_b32 v98, v102
v_mfma_f32_16x16x32_bf16 v[244:247], v[60:63], a[100:103], v[244:247]
ds_read_b64_tr_b16 v[54:55], v5 offset:39936
v_permlane16_swap_b32 v99, v103
v_mfma_f32_16x16x32_bf16 v[248:251], v[60:63], a[104:107], v[248:251]
ds_read_b128 a[152:155], v27 offset:4096
v_add_f32 v96, v96, v100
v_mfma_f32_16x16x32_bf16 v[252:255], v[60:63], a[108:111], v[252:255]
v_add_f32 v97, v97, v101
v_add_f32 v98, v98, v102
v_mfma_f32_16x16x32_bf16 v[128:131], v[40:43], a[112:115], v[128:131]
ds_read_b64_tr_b16 v[56:57], v6 offset:38912
v_add_f32 v99, v99, v103
v_mfma_f32_16x16x32_bf16 v[132:135], v[40:43], a[116:119], v[132:135]
ds_read_b64_tr_b16 v[58:59], v6 offset:39936
v_permlane16_swap_b32 v112, v116
v_mfma_f32_16x16x32_bf16 v[136:139], v[40:43], a[120:123], v[136:139]
s_waitcnt lgkmcnt(6)
ds_read_b128 a[156:159], v27 offset:6144
v_permlane16_swap_b32 v113, v117
v_mfma_f32_16x16x32_bf16 v[140:143], v[40:43], a[124:127], v[140:143]
v_permlane16_swap_b32 v114, v118
v_permlane16_swap_b32 v115, v119
v_mfma_f32_16x16x32_bf16 v[144:147], v[44:47], a[112:115], v[144:147]
ds_read_b64_tr_b16 v[60:61], v7 offset:38912
v_add_f32 v112, v112, v116
v_mfma_f32_16x16x32_bf16 v[148:151], v[44:47], a[116:119], v[148:151]
ds_read_b64_tr_b16 v[62:63], v7 offset:39936
v_add_f32 v113, v113, v117
v_mfma_f32_16x16x32_bf16 v[152:155], v[44:47], a[120:123], v[152:155]
v_add_f32 v114, v114, v118
v_add_f32 v115, v115, v119
v_mfma_f32_16x16x32_bf16 v[156:159], v[44:47], a[124:127], v[156:159]
v_add_f32_dpp v96, v96, v96 row_ror:8 row_mask:0xf bank_mask:0x3
v_add_f32_dpp v97, v97, v97 row_ror:8 row_mask:0xf bank_mask:0x3
v_mfma_f32_16x16x32_bf16 v[160:163], v[48:51], a[112:115], v[160:163]
ds_read_b64_tr_b16 v[40:41], v8 offset:38912
v_add_f32_dpp v112, v112, v112 row_ror:8 row_mask:0xf bank_mask:0x3
v_mfma_f32_16x16x32_bf16 v[164:167], v[48:51], a[116:119], v[164:167]
ds_read_b64_tr_b16 v[42:43], v8 offset:39936
v_add_f32_dpp v113, v113, v113 row_ror:8 row_mask:0xf bank_mask:0x3
v_mfma_f32_16x16x32_bf16 v[168:171], v[48:51], a[120:123], v[168:171]
s_waitcnt lgkmcnt(5)
v_add_f32_dpp v96, v98, v98 row_ror:8 row_mask:0xf bank_mask:0xc
v_mfma_f32_16x16x32_bf16 v[172:175], v[48:51], a[124:127], v[172:175]
v_add_f32_dpp v97, v99, v99 row_ror:8 row_mask:0xf bank_mask:0xc
v_mfma_f32_16x16x32_bf16 v[176:179], v[52:55], a[112:115], v[176:179]
ds_read_b64_tr_b16 v[44:45], v9 offset:38912
v_mfma_f32_16x16x32_bf16 v[180:183], v[52:55], a[116:119], v[180:183]
ds_read_b64_tr_b16 v[46:47], v9 offset:39936
v_add_f32_dpp v112, v114, v114 row_ror:8 row_mask:0xf bank_mask:0xc
v_mfma_f32_16x16x32_bf16 v[184:187], v[52:55], a[120:123], v[184:187]
s_waitcnt lgkmcnt(6)
s_add_u32 s100, s101, 896
s_and_b32 s100, s100, 1023
v_mfma_f32_16x16x32_bf16 v[188:191], v[52:55], a[124:127], v[188:191]
s_add_u32 m0, s43, 65536
s_add_u32 s100, s100, s8
v_add_f32_dpp v113, v115, v115 row_ror:8 row_mask:0xf bank_mask:0xc
v_mfma_f32_16x16x32_bf16 v[192:195], v[56:59], a[112:115], v[192:195]
buffer_load_dwordx4 v19, s[20:23], s100 offen lds
v_mfma_f32_16x16x32_bf16 v[196:199], v[56:59], a[116:119], v[196:199]
s_barrier
ds_read_b64_tr_b16 v[48:49], v2 offset:0
ds_read_b64_tr_b16 v[50:51], v2 offset:1024
v_mfma_f32_16x16x32_bf16 v[200:203], v[56:59], a[120:123], v[200:203]
s_waitcnt lgkmcnt(4)
s_add_u32 m0, s43, 66560
s_add_u32 s100, s100, 8192
v_mfma_f32_16x16x32_bf16 v[204:207], v[56:59], a[124:127], v[204:207]
buffer_load_dwordx4 v20, s[20:23], s100 offen lds
v_mfma_f32_16x16x32_bf16 v[208:211], v[60:63], a[112:115], v[208:211]
s_add_u32 s18, s101, 896
ds_read_b64_tr_b16 v[52:53], v3 offset:0
s_and_b32 s18, s18, 1023
v_mfma_f32_16x16x32_bf16 v[212:215], v[60:63], a[116:119], v[212:215]
s_lshl_b32 s18, s18, 12
ds_read_b64_tr_b16 v[54:55], v3 offset:1024
s_add_u32 s18, s18, s10
v_mfma_f32_16x16x32_bf16 v[216:219], v[60:63], a[120:123], v[216:219]
s_add_u32 m0, s43, 135168
s_add_u32 s100, s100, 8192
v_and_b32 v37, 7, v0
v_mfma_f32_16x16x32_bf16 v[220:223], v[60:63], a[124:127], v[220:223]
buffer_load_dwordx4 v16, s[24:27], s18 offen lds
v_mfma_f32_16x16x32_bf16 v[224:227], v[40:43], a[112:115], v[224:227]
s_add_u32 m0, s43, 67584
ds_read_b64_tr_b16 v[56:57], v4 offset:0
s_add_u32 s18, s18, 32768
v_mfma_f32_16x16x32_bf16 v[228:231], v[40:43], a[116:119], v[228:231]
buffer_load_dwordx4 v19, s[20:23], s100 offen lds
v_mfma_f32_16x16x32_bf16 v[232:235], v[40:43], a[120:123], v[232:235]
s_waitcnt lgkmcnt(3)
ds_read_b64_tr_b16 v[58:59], v4 offset:1024
s_add_u32 m0, s43, 68608
v_mfma_f32_16x16x32_bf16 v[236:239], v[40:43], a[124:127], v[236:239]
s_add_u32 s100, s100, 8192
v_lshrrev_b32 v36, 3, v0
v_lshl_or_b32 v37, v37, 3, v36
v_mfma_f32_16x16x32_bf16 v[240:243], v[44:47], a[112:115], v[240:243]
buffer_load_dwordx4 v20, s[20:23], s100 offen lds
v_mfma_f32_16x16x32_bf16 v[244:247], v[44:47], a[116:119], v[244:247]
s_add_u32 m0, s43, 136192
ds_read_b64_tr_b16 v[60:61], v5 offset:0
ds_read_b64_tr_b16 v[62:63], v5 offset:1024
v_mfma_f32_16x16x32_bf16 v[248:251], v[44:47], a[120:123], v[248:251]
buffer_load_dwordx4 v16, s[24:27], s18 offen lds
v_mfma_f32_16x16x32_bf16 v[252:255], v[44:47], a[124:127], v[252:255]
s_add_u32 m0, s43, 69632
s_add_u32 s100, s100, s9
s_lshl_b32 s12, s42, 10
v_mfma_f32_16x16x32_bf16 v[128:131], v[48:51], a[128:131], v[128:131]
buffer_load_dwordx4 v19, s[20:23], s100 offen lds
v_mfma_f32_16x16x32_bf16 v[132:135], v[48:51], a[132:135], v[132:135]
s_add_u32 m0, s43, 70656
ds_read_b64_tr_b16 v[40:41], v6 offset:0
ds_read_b64_tr_b16 v[42:43], v6 offset:1024
v_mfma_f32_16x16x32_bf16 v[136:139], v[48:51], a[136:139], v[136:139]
s_waitcnt lgkmcnt(6)
s_add_u32 s100, s100, 8192
s_add_u32 s12, s12, 114688
v_mfma_f32_16x16x32_bf16 v[140:143], v[48:51], a[140:143], v[140:143]
buffer_load_dwordx4 v20, s[20:23], s100 offen lds
v_mfma_f32_16x16x32_bf16 v[144:147], v[52:55], a[128:131], v[144:147]
s_add_u32 m0, s43, 71680
ds_read_b64_tr_b16 v[44:45], v7 offset:0
s_add_u32 s100, s100, 8192
v_mfma_f32_16x16x32_bf16 v[148:151], v[52:55], a[132:135], v[148:151]
buffer_load_dwordx4 v19, s[20:23], s100 offen lds
v_mfma_f32_16x16x32_bf16 v[152:155], v[52:55], a[136:139], v[152:155]
s_waitcnt lgkmcnt(3)
ds_read_b64_tr_b16 v[46:47], v7 offset:1024
s_add_u32 m0, s43, 72704
v_mfma_f32_16x16x32_bf16 v[156:159], v[52:55], a[140:143], v[156:159]
s_add_u32 s100, s100, 8192
v_lshl_add_u32 v37, v37, 4, s12
s_lshl_b32 s13, s42, 8
buffer_load_dwordx4 v20, s[20:23], s100 offen lds
v_mfma_f32_16x16x32_bf16 v[160:163], v[56:59], a[128:131], v[160:163]
s_waitcnt vmcnt(25)
ds_read_b128 a[160:163], v14 offset:0
ds_read_b64_tr_b16 v[48:49], v8 offset:0
v_mfma_f32_16x16x32_bf16 v[164:167], v[56:59], a[132:135], v[164:167]
ds_read_b64_tr_b16 v[50:51], v8 offset:1024
s_add_u32 s13, s13, 114688
v_mfma_f32_16x16x32_bf16 v[168:171], v[56:59], a[136:139], v[168:171]
ds_read_b128 a[164:167], v14 offset:2048
v_lshl_add_u32 v36, v0, 2, s13
v_mfma_f32_16x16x32_bf16 v[172:175], v[56:59], a[140:143], v[172:175]
v_mfma_f32_16x16x32_bf16 v[176:179], v[60:63], a[128:131], v[176:179]
ds_read_b64_tr_b16 v[52:53], v9 offset:0
v_mfma_f32_16x16x32_bf16 v[180:183], v[60:63], a[132:135], v[180:183]
ds_read_b64_tr_b16 v[54:55], v9 offset:1024
v_mfma_f32_16x16x32_bf16 v[184:187], v[60:63], a[136:139], v[184:187]
s_waitcnt lgkmcnt(8)
ds_read_b128 a[168:171], v14 offset:4096
v_mfma_f32_16x16x32_bf16 v[188:191], v[60:63], a[140:143], v[188:191]
s_barrier
v_mfma_f32_16x16x32_bf16 v[192:195], v[40:43], a[128:131], v[192:195]
ds_read_b64_tr_b16 v[56:57], v2 offset:2048
v_mfma_f32_16x16x32_bf16 v[196:199], v[40:43], a[132:135], v[196:199]
ds_read_b64_tr_b16 v[58:59], v2 offset:3072
v_mfma_f32_16x16x32_bf16 v[200:203], v[40:43], a[136:139], v[200:203]
s_waitcnt lgkmcnt(6)
ds_read_b128 a[172:175], v14 offset:6144
s_add_u32 s18, s101, 960
v_mfma_f32_16x16x32_bf16 v[204:207], v[40:43], a[140:143], v[204:207]
s_and_b32 s18, s18, 1023
s_lshl_b32 s18, s18, 12
s_add_u32 s18, s18, s10
v_mfma_f32_16x16x32_bf16 v[208:211], v[44:47], a[128:131], v[208:211]
s_add_u32 m0, s43, 137216
ds_read_b64_tr_b16 v[60:61], v3 offset:2048
v_mfma_f32_16x16x32_bf16 v[212:215], v[44:47], a[132:135], v[212:215]
buffer_load_dwordx4 v16, s[24:27], s18 offen lds
v_mfma_f32_16x16x32_bf16 v[216:219], v[44:47], a[136:139], v[216:219]
s_add_u32 m0, s43, 138240
ds_read_b64_tr_b16 v[62:63], v3 offset:3072
ds_read_b128 a[176:179], v15 offset:0
v_mfma_f32_16x16x32_bf16 v[220:223], v[44:47], a[140:143], v[220:223]
s_add_u32 s18, s18, 32768
v_mfma_f32_16x16x32_bf16 v[224:227], v[48:51], a[128:131], v[224:227]
buffer_load_dwordx4 v16, s[24:27], s18 offen lds
v_mfma_f32_16x16x32_bf16 v[228:231], v[48:51], a[132:135], v[228:231]
ds_read_b64_tr_b16 v[40:41], v4 offset:2048
ds_read_b64_tr_b16 v[42:43], v4 offset:3072
v_mfma_f32_16x16x32_bf16 v[232:235], v[48:51], a[136:139], v[232:235]
s_waitcnt lgkmcnt(6)
ds_read_b128 a[180:183], v15 offset:2048
v_mfma_f32_16x16x32_bf16 v[236:239], v[48:51], a[140:143], v[236:239]
v_mfma_f32_16x16x32_bf16 v[240:243], v[52:55], a[128:131], v[240:243]
ds_read_b64_tr_b16 v[44:45], v5 offset:2048
v_mfma_f32_16x16x32_bf16 v[244:247], v[52:55], a[132:135], v[244:247]
ds_read_b64_tr_b16 v[46:47], v5 offset:3072
v_mfma_f32_16x16x32_bf16 v[248:251], v[52:55], a[136:139], v[248:251]
ds_read_b128 a[184:187], v15 offset:4096
v_mfma_f32_16x16x32_bf16 v[252:255], v[52:55], a[140:143], v[252:255]
v_mfma_f32_16x16x32_bf16 v[128:131], v[56:59], a[144:147], v[128:131]
ds_read_b64_tr_b16 v[48:49], v6 offset:2048
v_mfma_f32_16x16x32_bf16 v[132:135], v[56:59], a[148:151], v[132:135]
ds_read_b64_tr_b16 v[50:51], v6 offset:3072
v_mfma_f32_16x16x32_bf16 v[136:139], v[56:59], a[152:155], v[136:139]
s_waitcnt lgkmcnt(6)
ds_read_b128 a[188:191], v15 offset:6144
v_mfma_f32_16x16x32_bf16 v[140:143], v[56:59], a[156:159], v[140:143]
v_mfma_f32_16x16x32_bf16 v[144:147], v[60:63], a[144:147], v[144:147]
ds_read_b64_tr_b16 v[52:53], v7 offset:2048
v_mfma_f32_16x16x32_bf16 v[148:151], v[60:63], a[148:151], v[148:151]
ds_read_b64_tr_b16 v[54:55], v7 offset:3072
v_mfma_f32_16x16x32_bf16 v[152:155], v[60:63], a[152:155], v[152:155]
v_mfma_f32_16x16x32_bf16 v[156:159], v[60:63], a[156:159], v[156:159]
v_mfma_f32_16x16x32_bf16 v[160:163], v[40:43], a[144:147], v[160:163]
ds_read_b64_tr_b16 v[56:57], v8 offset:2048
v_mfma_f32_16x16x32_bf16 v[164:167], v[40:43], a[148:151], v[164:167]
ds_read_b64_tr_b16 v[58:59], v8 offset:3072
v_mfma_f32_16x16x32_bf16 v[168:171], v[40:43], a[152:155], v[168:171]
s_waitcnt lgkmcnt(5)
v_mfma_f32_16x16x32_bf16 v[172:175], v[40:43], a[156:159], v[172:175]
v_mfma_f32_16x16x32_bf16 v[176:179], v[44:47], a[144:147], v[176:179]
ds_read_b64_tr_b16 v[60:61], v9 offset:2048
v_mfma_f32_16x16x32_bf16 v[180:183], v[44:47], a[148:151], v[180:183]
ds_read_b64_tr_b16 v[62:63], v9 offset:3072
v_mfma_f32_16x16x32_bf16 v[184:187], v[44:47], a[152:155], v[184:187]
s_waitcnt lgkmcnt(6)
v_mfma_f32_16x16x32_bf16 v[188:191], v[44:47], a[156:159], v[188:191]
s_barrier
v_mfma_f32_16x16x32_bf16 v[192:195], v[48:51], a[144:147], v[192:195]
ds_read_b64_tr_b16 v[40:41], v2 offset:4096
v_mfma_f32_16x16x32_bf16 v[196:199], v[48:51], a[148:151], v[196:199]
ds_read_b64_tr_b16 v[42:43], v2 offset:5120
ds_write_b64 v37, v[96:97] offset:0
v_mfma_f32_16x16x32_bf16 v[200:203], v[48:51], a[152:155], v[200:203]
s_waitcnt lgkmcnt(5)
ds_write_b64 v37, v[112:113] offset:8
v_mfma_f32_16x16x32_bf16 v[204:207], v[48:51], a[156:159], v[204:207]
v_mfma_f32_16x16x32_bf16 v[208:211], v[52:55], a[144:147], v[208:211]
ds_read_b64_tr_b16 v[44:45], v3 offset:4096
v_mfma_f32_16x16x32_bf16 v[212:215], v[52:55], a[148:151], v[212:215]
ds_read_b64_tr_b16 v[46:47], v3 offset:5120
v_mfma_f32_16x16x32_bf16 v[216:219], v[52:55], a[152:155], v[216:219]
v_mfma_f32_16x16x32_bf16 v[220:223], v[52:55], a[156:159], v[220:223]
v_mfma_f32_16x16x32_bf16 v[224:227], v[56:59], a[144:147], v[224:227]
ds_read_b64_tr_b16 v[48:49], v4 offset:4096
v_mfma_f32_16x16x32_bf16 v[228:231], v[56:59], a[148:151], v[228:231]
ds_read_b64_tr_b16 v[50:51], v4 offset:5120
v_mfma_f32_16x16x32_bf16 v[232:235], v[56:59], a[152:155], v[232:235]
s_waitcnt lgkmcnt(6)
v_mfma_f32_16x16x32_bf16 v[236:239], v[56:59], a[156:159], v[236:239]
v_mfma_f32_16x16x32_bf16 v[240:243], v[60:63], a[144:147], v[240:243]
ds_read_b64_tr_b16 v[52:53], v5 offset:4096
v_mfma_f32_16x16x32_bf16 v[244:247], v[60:63], a[148:151], v[244:247]
ds_read_b64_tr_b16 v[54:55], v5 offset:5120
v_mfma_f32_16x16x32_bf16 v[248:251], v[60:63], a[152:155], v[248:251]
v_mfma_f32_16x16x32_bf16 v[252:255], v[60:63], a[156:159], v[252:255]
v_mfma_f32_16x16x32_bf16 v[128:131], v[40:43], a[160:163], v[128:131]
ds_read_b64_tr_b16 v[56:57], v6 offset:4096
v_mfma_f32_16x16x32_bf16 v[132:135], v[40:43], a[164:167], v[132:135]
ds_read_b64_tr_b16 v[58:59], v6 offset:5120
v_mfma_f32_16x16x32_bf16 v[136:139], v[40:43], a[168:171], v[136:139]
s_waitcnt lgkmcnt(4)
v_mfma_f32_16x16x32_bf16 v[140:143], v[40:43], a[172:175], v[140:143]
v_mfma_f32_16x16x32_bf16 v[144:147], v[44:47], a[160:163], v[144:147]
ds_read_b64_tr_b16 v[60:61], v7 offset:4096
v_mfma_f32_16x16x32_bf16 v[148:151], v[44:47], a[164:167], v[148:151]
ds_read_b64_tr_b16 v[62:63], v7 offset:5120
v_mfma_f32_16x16x32_bf16 v[152:155], v[44:47], a[168:171], v[152:155]
s_waitcnt vmcnt(14)
ds_read_b128 a[192:195], v14 offset:32768
v_mfma_f32_16x16x32_bf16 v[156:159], v[44:47], a[172:175], v[156:159]
v_mfma_f32_16x16x32_bf16 v[160:163], v[48:51], a[160:163], v[160:163]
ds_read_b64_tr_b16 v[40:41], v8 offset:4096
v_mfma_f32_16x16x32_bf16 v[164:167], v[48:51], a[164:167], v[164:167]
ds_read_b64_tr_b16 v[42:43], v8 offset:5120
v_mfma_f32_16x16x32_bf16 v[168:171], v[48:51], a[168:171], v[168:171]
buffer_load_dword v29, v28, s[36:39], s15 offen offset:4 sc0 sc1
v_mfma_f32_16x16x32_bf16 v[172:175], v[48:51], a[172:175], v[172:175]
s_waitcnt lgkmcnt(5)
ds_read_b128 a[196:199], v14 offset:34816
v_mfma_f32_16x16x32_bf16 v[176:179], v[52:55], a[160:163], v[176:179]
ds_read_b64_tr_b16 v[44:45], v9 offset:4096
v_mfma_f32_16x16x32_bf16 v[180:183], v[52:55], a[164:167], v[180:183]
ds_read_b64_tr_b16 v[46:47], v9 offset:5120
v_mfma_f32_16x16x32_bf16 v[184:187], v[52:55], a[168:171], v[184:187]
ds_read_b128 a[200:203], v14 offset:36864
v_mfma_f32_16x16x32_bf16 v[188:191], v[52:55], a[172:175], v[188:191]
s_barrier
v_mfma_f32_16x16x32_bf16 v[192:195], v[56:59], a[160:163], v[192:195]
ds_read_b64_tr_b16 v[48:49], v2 offset:6144
ds_read_b32 v96, v36 offset:0
v_mfma_f32_16x16x32_bf16 v[196:199], v[56:59], a[164:167], v[196:199]
ds_read_b32 v97, v36 offset:1024
ds_read_b32 v98, v36 offset:2048
v_mfma_f32_16x16x32_bf16 v[200:203], v[56:59], a[168:171], v[200:203]
s_waitcnt lgkmcnt(8)
ds_read_b32 v99, v36 offset:3072
ds_read_b64_tr_b16 v[50:51], v2 offset:7168
v_mfma_f32_16x16x32_bf16 v[204:207], v[56:59], a[172:175], v[204:207]
ds_read_b128 a[204:207], v14 offset:38912
v_lshrrev_b32 v38, 5, v0
v_mfma_f32_16x16x32_bf16 v[208:211], v[60:63], a[160:163], v[208:211]
ds_read_b64_tr_b16 v[52:53], v3 offset:6144
v_and_b32 v37, 31, v0
v_mfma_f32_16x16x32_bf16 v[212:215], v[60:63], a[164:167], v[212:215]
ds_read_b64_tr_b16 v[54:55], v3 offset:7168
v_lshlrev_b32 v38, 10, v38
v_mfma_f32_16x16x32_bf16 v[216:219], v[60:63], a[168:171], v[216:219]
ds_read_b128 a[208:211], v15 offset:32768
v_lshl_add_u32 v37, v37, 2, v38
v_mfma_f32_16x16x32_bf16 v[220:223], v[60:63], a[172:175], v[220:223]
s_lshl_b32 s10, s40, 13
s_lshl_b32 s12, s42, 11
s_add_u32 s10, s10, s12
v_mfma_f32_16x16x32_bf16 v[224:227], v[40:43], a[160:163], v[224:227]
ds_read_b64_tr_b16 v[56:57], v4 offset:6144
s_lshl_b32 s12, s41, 7
v_mfma_f32_16x16x32_bf16 v[228:231], v[40:43], a[164:167], v[228:231]
s_add_u32 s10, s10, s12
s_add_u32 s10, s10, 56623104
s_waitcnt lgkmcnt(6)
v_mfma_f32_16x16x32_bf16 v[232:235], v[40:43], a[168:171], v[232:235]
ds_read_b64_tr_b16 v[58:59], v4 offset:7168
ds_read_b128 a[212:215], v15 offset:34816
v_mfma_f32_16x16x32_bf16 v[236:239], v[40:43], a[172:175], v[236:239]
v_add_f32 v96, v96, v97
v_add_f32 v98, v98, v99
v_mfma_f32_16x16x32_bf16 v[240:243], v[44:47], a[160:163], v[240:243]
ds_read_b64_tr_b16 v[60:61], v5 offset:6144
v_add_f32 v96, v96, v98
v_mfma_f32_16x16x32_bf16 v[244:247], v[44:47], a[164:167], v[244:247]
ds_read_b64_tr_b16 v[62:63], v5 offset:7168
v_mfma_f32_16x16x32_bf16 v[248:251], v[44:47], a[168:171], v[248:251]
s_waitcnt lgkmcnt(6)
ds_read_b128 a[216:219], v15 offset:36864
v_mfma_f32_16x16x32_bf16 v[252:255], v[44:47], a[172:175], v[252:255]
v_mfma_f32_16x16x32_bf16 v[128:131], v[48:51], a[176:179], v[128:131]
ds_read_b64_tr_b16 v[40:41], v6 offset:6144
v_mfma_f32_16x16x32_bf16 v[132:135], v[48:51], a[180:183], v[132:135]
ds_read_b64_tr_b16 v[42:43], v6 offset:7168
v_mfma_f32_16x16x32_bf16 v[136:139], v[48:51], a[184:187], v[136:139]
ds_read_b128 a[220:223], v15 offset:38912
v_mfma_f32_16x16x32_bf16 v[140:143], v[48:51], a[188:191], v[140:143]
v_mfma_f32_16x16x32_bf16 v[144:147], v[52:55], a[176:179], v[144:147]
ds_read_b64_tr_b16 v[44:45], v7 offset:6144
v_mfma_f32_16x16x32_bf16 v[148:151], v[52:55], a[180:183], v[148:151]
ds_read_b64_tr_b16 v[46:47], v7 offset:7168
v_mfma_f32_16x16x32_bf16 v[152:155], v[52:55], a[184:187], v[152:155]
s_waitcnt lgkmcnt(6)
v_mfma_f32_16x16x32_bf16 v[156:159], v[52:55], a[188:191], v[156:159]
buffer_store_dword v96, v37, s[36:39], s10 offen sc1
v_mfma_f32_16x16x32_bf16 v[160:163], v[56:59], a[176:179], v[160:163]
ds_read_b64_tr_b16 v[48:49], v8 offset:6144
v_mfma_f32_16x16x32_bf16 v[164:167], v[56:59], a[180:183], v[164:167]
ds_read_b64_tr_b16 v[50:51], v8 offset:7168
v_mfma_f32_16x16x32_bf16 v[168:171], v[56:59], a[184:187], v[168:171]
v_mfma_f32_16x16x32_bf16 v[172:175], v[56:59], a[188:191], v[172:175]
v_mfma_f32_16x16x32_bf16 v[176:179], v[60:63], a[176:179], v[176:179]
ds_read_b64_tr_b16 v[52:53], v9 offset:6144
v_mfma_f32_16x16x32_bf16 v[180:183], v[60:63], a[180:183], v[180:183]
ds_read_b64_tr_b16 v[54:55], v9 offset:7168
v_mfma_f32_16x16x32_bf16 v[184:187], v[60:63], a[184:187], v[184:187]
s_waitcnt lgkmcnt(4)
v_mfma_f32_16x16x32_bf16 v[188:191], v[60:63], a[188:191], v[188:191]
s_barrier
v_mfma_f32_16x16x32_bf16 v[192:195], v[40:43], a[176:179], v[192:195]
ds_read_b64_tr_b16 v[56:57], v2 offset:32768
v_mfma_f32_16x16x32_bf16 v[196:199], v[40:43], a[180:183], v[196:199]
ds_read_b64_tr_b16 v[58:59], v2 offset:33792
v_mfma_f32_16x16x32_bf16 v[200:203], v[40:43], a[184:187], v[200:203]
v_mfma_f32_16x16x32_bf16 v[204:207], v[40:43], a[188:191], v[204:207]
v_mfma_f32_16x16x32_bf16 v[208:211], v[44:47], a[176:179], v[208:211]
ds_read_b64_tr_b16 v[60:61], v3 offset:32768
v_mfma_f32_16x16x32_bf16 v[212:215], v[44:47], a[180:183], v[212:215]
ds_read_b64_tr_b16 v[62:63], v3 offset:33792
v_mfma_f32_16x16x32_bf16 v[216:219], v[44:47], a[184:187], v[216:219]
s_waitcnt lgkmcnt(4)
v_mfma_f32_16x16x32_bf16 v[220:223], v[44:47], a[188:191], v[220:223]
v_mfma_f32_16x16x32_bf16 v[224:227], v[48:51], a[176:179], v[224:227]
ds_read_b64_tr_b16 v[40:41], v4 offset:32768
v_mfma_f32_16x16x32_bf16 v[228:231], v[48:51], a[180:183], v[228:231]
ds_read_b64_tr_b16 v[42:43], v4 offset:33792
v_mfma_f32_16x16x32_bf16 v[232:235], v[48:51], a[184:187], v[232:235]
v_mfma_f32_16x16x32_bf16 v[236:239], v[48:51], a[188:191], v[236:239]
v_mfma_f32_16x16x32_bf16 v[240:243], v[52:55], a[176:179], v[240:243]
ds_read_b64_tr_b16 v[44:45], v5 offset:32768
v_mfma_f32_16x16x32_bf16 v[244:247], v[52:55], a[180:183], v[244:247]
ds_read_b64_tr_b16 v[46:47], v5 offset:33792
v_mfma_f32_16x16x32_bf16 v[248:251], v[52:55], a[184:187], v[248:251]
s_waitcnt lgkmcnt(4)
v_mfma_f32_16x16x32_bf16 v[252:255], v[52:55], a[188:191], v[252:255]
v_mfma_f32_16x16x32_bf16 v[128:131], v[56:59], a[192:195], v[128:131]
ds_read_b64_tr_b16 v[48:49], v6 offset:32768
v_mfma_f32_16x16x32_bf16 v[132:135], v[56:59], a[196:199], v[132:135]
ds_read_b64_tr_b16 v[50:51], v6 offset:33792
v_mfma_f32_16x16x32_bf16 v[136:139], v[56:59], a[200:203], v[136:139]
v_mfma_f32_16x16x32_bf16 v[140:143], v[56:59], a[204:207], v[140:143]
v_mfma_f32_16x16x32_bf16 v[144:147], v[60:63], a[192:195], v[144:147]
ds_read_b64_tr_b16 v[52:53], v7 offset:32768
v_mfma_f32_16x16x32_bf16 v[148:151], v[60:63], a[196:199], v[148:151]
ds_read_b64_tr_b16 v[54:55], v7 offset:33792
v_mfma_f32_16x16x32_bf16 v[152:155], v[60:63], a[200:203], v[152:155]
s_waitcnt lgkmcnt(4)
s_waitcnt vmcnt(4)
ds_read_b128 a[224:227], v26 offset:0
v_mfma_f32_16x16x32_bf16 v[156:159], v[60:63], a[204:207], v[156:159]
v_mfma_f32_16x16x32_bf16 v[160:163], v[40:43], a[192:195], v[160:163]
ds_read_b64_tr_b16 v[56:57], v8 offset:32768
v_mfma_f32_16x16x32_bf16 v[164:167], v[40:43], a[196:199], v[164:167]
ds_read_b64_tr_b16 v[58:59], v8 offset:33792
v_mfma_f32_16x16x32_bf16 v[168:171], v[40:43], a[200:203], v[168:171]
ds_read_b128 a[228:231], v26 offset:2048
v_mfma_f32_16x16x32_bf16 v[172:175], v[40:43], a[204:207], v[172:175]
v_mfma_f32_16x16x32_bf16 v[176:179], v[44:47], a[192:195], v[176:179]
ds_read_b64_tr_b16 v[60:61], v9 offset:32768
v_mfma_f32_16x16x32_bf16 v[180:183], v[44:47], a[196:199], v[180:183]
ds_read_b64_tr_b16 v[62:63], v9 offset:33792
v_mfma_f32_16x16x32_bf16 v[184:187], v[44:47], a[200:203], v[184:187]
s_waitcnt lgkmcnt(6)
ds_read_b128 a[232:235], v26 offset:4096
v_mfma_f32_16x16x32_bf16 v[188:191], v[44:47], a[204:207], v[188:191]
s_waitcnt vmcnt(1)
v_readfirstlane_b32 s48, v29
s_or_b32 s48, s48, s14
s_bitcmp0_b32 s48, 0
s_cbranch_scc1 L_pstub0_KN
L_pback0_KN:
v_mfma_f32_16x16x32_bf16 v[192:195], v[48:51], a[192:195], v[192:195]
s_barrier
ds_read_b64_tr_b16 v[40:41], v2 offset:34816
v_mfma_f32_16x16x32_bf16 v[196:199], v[48:51], a[196:199], v[196:199]
s_add_u32 m0, s11, 0
ds_read_b64_tr_b16 v[42:43], v2 offset:35840
s_add_u32 s18, s49, 0
v_mfma_f32_16x16x32_bf16 v[200:203], v[48:51], a[200:203], v[200:203]
buffer_load_dwordx4 v21, s[28:31], s18 offen offset:0 lds
v_mfma_f32_16x16x32_bf16 v[204:207], v[48:51], a[204:207], v[204:207]
ds_read_b128 a[236:239], v26 offset:6144
v_mfma_f32_16x16x32_bf16 v[208:211], v[52:55], a[192:195], v[208:211]
buffer_load_dwordx4 v21, s[28:31], s18 offen offset:1024 lds
v_mfma_f32_16x16x32_bf16 v[212:215], v[52:55], a[196:199], v[212:215]
ds_read_b64_tr_b16 v[44:45], v3 offset:34816
ds_read_b64_tr_b16 v[46:47], v3 offset:35840
v_mfma_f32_16x16x32_bf16 v[216:219], v[52:55], a[200:203], v[216:219]
buffer_load_dwordx4 v21, s[28:31], s18 offen offset:2048 lds
v_mfma_f32_16x16x32_bf16 v[220:223], v[52:55], a[204:207], v[220:223]
s_waitcnt lgkmcnt(6)
ds_read_b128 a[240:243], v27 offset:0
v_mfma_f32_16x16x32_bf16 v[224:227], v[56:59], a[192:195], v[224:227]
buffer_load_dwordx4 v21, s[28:31], s18 offen offset:3072 lds
v_mfma_f32_16x16x32_bf16 v[228:231], v[56:59], a[196:199], v[228:231]
ds_read_b64_tr_b16 v[48:49], v4 offset:34816
ds_read_b64_tr_b16 v[50:51], v4 offset:35840
v_mfma_f32_16x16x32_bf16 v[232:235], v[56:59], a[200:203], v[232:235]
ds_read_b128 a[244:247], v27 offset:2048
v_mfma_f32_16x16x32_bf16 v[236:239], v[56:59], a[204:207], v[236:239]
s_add_u32 m0, s11, 16384
s_add_u32 s18, s49, 8192
v_mfma_f32_16x16x32_bf16 v[240:243], v[60:63], a[192:195], v[240:243]
buffer_load_dwordx4 v21, s[28:31], s18 offen offset:0 lds
v_mfma_f32_16x16x32_bf16 v[244:247], v[60:63], a[196:199], v[244:247]
ds_read_b64_tr_b16 v[52:53], v5 offset:34816
ds_read_b64_tr_b16 v[54:55], v5 offset:35840
v_mfma_f32_16x16x32_bf16 v[248:251], v[60:63], a[200:203], v[248:251]
buffer_load_dwordx4 v21, s[28:31], s18 offen offset:1024 lds
v_mfma_f32_16x16x32_bf16 v[252:255], v[60:63], a[204:207], v[252:255]
s_waitcnt lgkmcnt(6)
ds_read_b128 a[248:251], v27 offset:4096
v_mfma_f32_16x16x32_bf16 v[128:131], v[40:43], a[208:211], v[128:131]
buffer_load_dwordx4 v21, s[28:31], s18 offen offset:2048 lds
v_mfma_f32_16x16x32_bf16 v[132:135], v[40:43], a[212:215], v[132:135]
ds_read_b64_tr_b16 v[56:57], v6 offset:34816
ds_read_b64_tr_b16 v[58:59], v6 offset:35840
v_mfma_f32_16x16x32_bf16 v[136:139], v[40:43], a[216:219], v[136:139]
buffer_load_dwordx4 v21, s[28:31], s18 offen offset:3072 lds
v_mfma_f32_16x16x32_bf16 v[140:143], v[40:43], a[220:223], v[140:143]
ds_read_b128 a[252:255], v27 offset:6144
v_mfma_f32_16x16x32_bf16 v[144:147], v[44:47], a[208:211], v[144:147]
ds_read_b64_tr_b16 v[60:61], v7 offset:34816
v_mfma_f32_16x16x32_bf16 v[148:151], v[44:47], a[212:215], v[148:151]
s_add_u32 m0, s11, 32768
ds_read_b64_tr_b16 v[62:63], v7 offset:35840
s_add_u32 s18, s49, 16384
v_mfma_f32_16x16x32_bf16 v[152:155], v[44:47], a[216:219], v[152:155]
buffer_load_dwordx4 v21, s[28:31], s18 offen offset:0 lds
v_mfma_f32_16x16x32_bf16 v[156:159], v[44:47], a[220:223], v[156:159]
s_waitcnt lgkmcnt(6)
v_mfma_f32_16x16x32_bf16 v[160:163], v[48:51], a[208:211], v[160:163]
buffer_load_dwordx4 v21, s[28:31], s18 offen offset:1024 lds
v_mfma_f32_16x16x32_bf16 v[164:167], v[48:51], a[212:215], v[164:167]
ds_read_b64_tr_b16 v[40:41], v8 offset:34816
ds_read_b64_tr_b16 v[42:43], v8 offset:35840
v_mfma_f32_16x16x32_bf16 v[168:171], v[48:51], a[216:219], v[168:171]
buffer_load_dwordx4 v21, s[28:31], s18 offen offset:2048 lds
v_mfma_f32_16x16x32_bf16 v[172:175], v[48:51], a[220:223], v[172:175]
v_mfma_f32_16x16x32_bf16 v[176:179], v[52:55], a[208:211], v[176:179]
buffer_load_dwordx4 v21, s[28:31], s18 offen offset:3072 lds
v_mfma_f32_16x16x32_bf16 v[180:183], v[52:55], a[212:215], v[180:183]
ds_read_b64_tr_b16 v[44:45], v9 offset:34816
ds_read_b64_tr_b16 v[46:47], v9 offset:35840
v_mfma_f32_16x16x32_bf16 v[184:187], v[52:55], a[216:219], v[184:187]
s_waitcnt lgkmcnt(4)
v_mfma_f32_16x16x32_bf16 v[188:191], v[52:55], a[220:223], v[188:191]
s_barrier
s_add_u32 m0, s11, 49152
s_add_u32 s18, s49, 24576
v_mfma_f32_16x16x32_bf16 v[192:195], v[56:59], a[208:211], v[192:195]
buffer_load_dwordx4 v21, s[28:31], s18 offen offset:0 lds
v_mfma_f32_16x16x32_bf16 v[196:199], v[56:59], a[212:215], v[196:199]
ds_read_b64_tr_b16 v[48:49], v2 offset:36864
ds_read_b64_tr_b16 v[50:51], v2 offset:37888
v_mfma_f32_16x16x32_bf16 v[200:203], v[56:59], a[216:219], v[200:203]
buffer_load_dwordx4 v21, s[28:31], s18 offen offset:1024 lds
v_mfma_f32_16x16x32_bf16 v[204:207], v[56:59], a[220:223], v[204:207]
v_mfma_f32_16x16x32_bf16 v[208:211], v[60:63], a[208:211], v[208:211]
buffer_load_dwordx4 v21, s[28:31], s18 offen offset:2048 lds
v_mfma_f32_16x16x32_bf16 v[212:215], v[60:63], a[212:215], v[212:215]
ds_read_b64_tr_b16 v[52:53], v3 offset:36864
ds_read_b64_tr_b16 v[54:55], v3 offset:37888
v_mfma_f32_16x16x32_bf16 v[216:219], v[60:63], a[216:219], v[216:219]
buffer_load_dwordx4 v21, s[28:31], s18 offen offset:3072 lds
v_mfma_f32_16x16x32_bf16 v[220:223], v[60:63], a[220:223], v[220:223]
s_waitcnt lgkmcnt(4)
v_mfma_f32_16x16x32_bf16 v[224:227], v[40:43], a[208:211], v[224:227]
ds_read_b64_tr_b16 v[56:57], v4 offset:36864
v_mfma_f32_16x16x32_bf16 v[228:231], v[40:43], a[212:215], v[228:231]
s_add_u32 m0, s11, 65536
ds_read_b64_tr_b16 v[58:59], v4 offset:37888
s_add_u32 s18, s49, 32768
v_mfma_f32_16x16x32_bf16 v[232:235], v[40:43], a[216:219], v[232:235]
buffer_load_dwordx4 v21, s[28:31], s18 offen offset:0 lds
v_mfma_f32_16x16x32_bf16 v[236:239], v[40:43], a[220:223], v[236:239]
v_mfma_f32_16x16x32_bf16 v[240:243], v[44:47], a[208:211], v[240:243]
buffer_load_dwordx4 v21, s[28:31], s18 offen offset:1024 lds
v_mfma_f32_16x16x32_bf16 v[244:247], v[44:47], a[212:215], v[244:247]
ds_read_b64_tr_b16 v[60:61], v5 offset:36864
ds_read_b64_tr_b16 v[62:63], v5 offset:37888
v_mfma_f32_16x16x32_bf16 v[248:251], v[44:47], a[216:219], v[248:251]
buffer_load_dwordx4 v21, s[28:31], s18 offen offset:2048 lds
v_mfma_f32_16x16x32_bf16 v[252:255], v[44:47], a[220:223], v[252:255]
s_waitcnt lgkmcnt(4)
v_mfma_f32_16x16x32_bf16 v[128:131], v[48:51], a[224:227], v[128:131]
buffer_load_dwordx4 v21, s[28:31], s18 offen offset:3072 lds
v_mfma_f32_16x16x32_bf16 v[132:135], v[48:51], a[228:231], v[132:135]
ds_read_b64_tr_b16 v[40:41], v6 offset:36864
ds_read_b64_tr_b16 v[42:43], v6 offset:37888
v_mfma_f32_16x16x32_bf16 v[136:139], v[48:51], a[232:235], v[136:139]
v_mfma_f32_16x16x32_bf16 v[140:143], v[48:51], a[236:239], v[140:143]
s_add_u32 m0, s11, 81920
s_add_u32 s18, s49, 40960
v_mfma_f32_16x16x32_bf16 v[144:147], v[52:55], a[224:227], v[144:147]
buffer_load_dwordx4 v21, s[28:31], s18 offen offset:0 lds
v_mfma_f32_16x16x32_bf16 v[148:151], v[52:55], a[228:231], v[148:151]
ds_read_b64_tr_b16 v[44:45], v7 offset:36864
ds_read_b64_tr_b16 v[46:47], v7 offset:37888
v_mfma_f32_16x16x32_bf16 v[152:155], v[52:55], a[232:235], v[152:155]
buffer_load_dwordx4 v21, s[28:31], s18 offen offset:1024 lds
v_mfma_f32_16x16x32_bf16 v[156:159], v[52:55], a[236:239], v[156:159]
s_waitcnt lgkmcnt(4)
v_mfma_f32_16x16x32_bf16 v[160:163], v[56:59], a[224:227], v[160:163]
buffer_load_dwordx4 v21, s[28:31], s18 offen offset:2048 lds
v_mfma_f32_16x16x32_bf16 v[164:167], v[56:59], a[228:231], v[164:167]
ds_read_b64_tr_b16 v[48:49], v8 offset:36864
ds_read_b64_tr_b16 v[50:51], v8 offset:37888
v_mfma_f32_16x16x32_bf16 v[168:171], v[56:59], a[232:235], v[168:171]
buffer_load_dwordx4 v21, s[28:31], s18 offen offset:3072 lds
v_mfma_f32_16x16x32_bf16 v[172:175], v[56:59], a[236:239], v[172:175]
v_mfma_f32_16x16x32_bf16 v[176:179], v[60:63], a[224:227], v[176:179]
ds_read_b64_tr_b16 v[52:53], v9 offset:36864
v_mfma_f32_16x16x32_bf16 v[180:183], v[60:63], a[228:231], v[180:183]
s_add_u32 m0, s11, 98304
ds_read_b64_tr_b16 v[54:55], v9 offset:37888
s_add_u32 s18, s49, 49152
v_mfma_f32_16x16x32_bf16 v[184:187], v[60:63], a[232:235], v[184:187]
buffer_load_dwordx4 v21, s[28:31], s18 offen offset:0 lds
v_mfma_f32_16x16x32_bf16 v[188:191], v[60:63], a[236:239], v[188:191]
s_waitcnt lgkmcnt(4)
s_barrier
v_mfma_f32_16x16x32_bf16 v[192:195], v[40:43], a[224:227], v[192:195]
buffer_load_dwordx4 v21, s[28:31], s18 offen offset:1024 lds
v_mfma_f32_16x16x32_bf16 v[196:199], v[40:43], a[228:231], v[196:199]
ds_read_b64_tr_b16 v[56:57], v2 offset:38912
ds_read_b64_tr_b16 v[58:59], v2 offset:39936
v_mfma_f32_16x16x32_bf16 v[200:203], v[40:43], a[232:235], v[200:203]
buffer_load_dwordx4 v21, s[28:31], s18 offen offset:2048 lds
v_mfma_f32_16x16x32_bf16 v[204:207], v[40:43], a[236:239], v[204:207]
v_mfma_f32_16x16x32_bf16 v[208:211], v[44:47], a[224:227], v[208:211]
buffer_load_dwordx4 v21, s[28:31], s18 offen offset:3072 lds
v_mfma_f32_16x16x32_bf16 v[212:215], v[44:47], a[228:231], v[212:215]
ds_read_b64_tr_b16 v[60:61], v3 offset:38912
ds_read_b64_tr_b16 v[62:63], v3 offset:39936
v_mfma_f32_16x16x32_bf16 v[216:219], v[44:47], a[232:235], v[216:219]
s_waitcnt lgkmcnt(4)
v_mfma_f32_16x16x32_bf16 v[220:223], v[44:47], a[236:239], v[220:223]
buffer_load_dword v29, v28, s[36:39], s15 offen offset:4 sc0 sc1
v_mfma_f32_16x16x32_bf16 v[224:227], v[48:51], a[224:227], v[224:227]
buffer_load_dword v30, v28, s[36:39], s15 offen offset:8 sc0 sc1
v_mfma_f32_16x16x32_bf16 v[228:231], v[48:51], a[228:231], v[228:231]
ds_read_b64_tr_b16 v[40:41], v4 offset:38912
ds_read_b64_tr_b16 v[42:43], v4 offset:39936
v_mfma_f32_16x16x32_bf16 v[232:235], v[48:51], a[232:235], v[232:235]
v_mfma_f32_16x16x32_bf16 v[236:239], v[48:51], a[236:239], v[236:239]
v_mfma_f32_16x16x32_bf16 v[240:243], v[52:55], a[224:227], v[240:243]
ds_read_b64_tr_b16 v[44:45], v5 offset:38912
v_mfma_f32_16x16x32_bf16 v[244:247], v[52:55], a[228:231], v[244:247]
ds_read_b64_tr_b16 v[46:47], v5 offset:39936
v_mfma_f32_16x16x32_bf16 v[248:251], v[52:55], a[232:235], v[248:251]
s_waitcnt lgkmcnt(4)
v_mfma_f32_16x16x32_bf16 v[252:255], v[52:55], a[236:239], v[252:255]
v_mfma_f32_16x16x32_bf16 v[128:131], v[56:59], a[240:243], v[128:131]
ds_read_b64_tr_b16 v[48:49], v6 offset:38912
v_mfma_f32_16x16x32_bf16 v[132:135], v[56:59], a[244:247], v[132:135]
ds_read_b64_tr_b16 v[50:51], v6 offset:39936
v_mfma_f32_16x16x32_bf16 v[136:139], v[56:59], a[248:251], v[136:139]
v_mfma_f32_16x16x32_bf16 v[140:143], v[56:59], a[252:255], v[140:143]
v_mfma_f32_16x16x32_bf16 v[144:147], v[60:63], a[240:243], v[144:147]
ds_read_b64_tr_b16 v[52:53], v7 offset:38912
v_mfma_f32_16x16x32_bf16 v[148:151], v[60:63], a[244:247], v[148:151]
ds_read_b64_tr_b16 v[54:55], v7 offset:39936
v_mfma_f32_16x16x32_bf16 v[152:155], v[60:63], a[248:251], v[152:155]
s_waitcnt lgkmcnt(4)
v_mfma_f32_16x16x32_bf16 v[156:159], v[60:63], a[252:255], v[156:159]
v_mfma_f32_16x16x32_bf16 v[160:163], v[40:43], a[240:243], v[160:163]
ds_read_b64_tr_b16 v[56:57], v8 offset:38912
v_mfma_f32_16x16x32_bf16 v[164:167], v[40:43], a[244:247], v[164:167]
ds_read_b64_tr_b16 v[58:59], v8 offset:39936
v_mfma_f32_16x16x32_bf16 v[168:171], v[40:43], a[248:251], v[168:171]
v_mfma_f32_16x16x32_bf16 v[172:175], v[40:43], a[252:255], v[172:175]
v_cvt_pk_bf16_f32 v128, v128, v129
v_cvt_pk_bf16_f32 v129, v130, v131
v_mfma_f32_16x16x32_bf16 v[176:179], v[44:47], a[240:243], v[176:179]
v_cvt_pk_bf16_f32 v130, v144, v145
v_cvt_pk_bf16_f32 v131, v146, v147
v_mfma_f32_16x16x32_bf16 v[180:183], v[44:47], a[244:247], v[180:183]
ds_read_b64_tr_b16 v[60:61], v9 offset:38912
v_accvgpr_write_b32 a64, v128
v_mfma_f32_16x16x32_bf16 v[184:187], v[44:47], a[248:251], v[184:187]
s_waitcnt lgkmcnt(3)
v_accvgpr_write_b32 a65, v129
v_accvgpr_write_b32 a66, v130
v_mfma_f32_16x16x32_bf16 v[188:191], v[44:47], a[252:255], v[188:191]
v_accvgpr_write_b32 a67, v131
ds_read_b64_tr_b16 v[62:63], v9 offset:39936
v_mfma_f32_16x16x32_bf16 v[192:195], v[48:51], a[240:243], v[192:195]
v_cvt_pk_bf16_f32 v132, v132, v133
v_cvt_pk_bf16_f32 v133, v134, v135
v_mfma_f32_16x16x32_bf16 v[196:199], v[48:51], a[244:247], v[196:199]
v_cvt_pk_bf16_f32 v134, v148, v149
v_cvt_pk_bf16_f32 v135, v150, v151
v_mfma_f32_16x16x32_bf16 v[200:203], v[48:51], a[248:251], v[200:203]
v_accvgpr_write_b32 a80, v132
v_accvgpr_write_b32 a81, v133
v_mfma_f32_16x16x32_bf16 v[204:207], v[48:51], a[252:255], v[204:207]
v_accvgpr_write_b32 a82, v134
v_accvgpr_write_b32 a83, v135
v_mfma_f32_16x16x32_bf16 v[208:211], v[52:55], a[240:243], v[208:211]
v_cvt_pk_bf16_f32 v136, v136, v137
v_cvt_pk_bf16_f32 v137, v138, v139
v_mfma_f32_16x16x32_bf16 v[212:215], v[52:55], a[244:247], v[212:215]
v_cvt_pk_bf16_f32 v138, v152, v153
v_cvt_pk_bf16_f32 v139, v154, v155
v_mfma_f32_16x16x32_bf16 v[216:219], v[52:55], a[248:251], v[216:219]
s_waitcnt lgkmcnt(2)
v_accvgpr_write_b32 a96, v136
v_accvgpr_write_b32 a97, v137
v_mfma_f32_16x16x32_bf16 v[220:223], v[52:55], a[252:255], v[220:223]
v_accvgpr_write_b32 a98, v138
v_accvgpr_write_b32 a99, v139
v_mfma_f32_16x16x32_bf16 v[224:227], v[56:59], a[240:243], v[224:227]
v_cvt_pk_bf16_f32 v140, v140, v141
v_cvt_pk_bf16_f32 v141, v142, v143
v_mfma_f32_16x16x32_bf16 v[228:231], v[56:59], a[244:247], v[228:231]
v_cvt_pk_bf16_f32 v142, v156, v157
v_cvt_pk_bf16_f32 v143, v158, v159
v_mfma_f32_16x16x32_bf16 v[232:235], v[56:59], a[248:251], v[232:235]
s_waitcnt lgkmcnt(0)
v_accvgpr_write_b32 a112, v140
v_accvgpr_write_b32 a113, v141
v_mfma_f32_16x16x32_bf16 v[236:239], v[56:59], a[252:255], v[236:239]
s_waitcnt vmcnt(22)
v_accvgpr_write_b32 a114, v142
v_accvgpr_write_b32 a115, v143
v_mfma_f32_16x16x32_bf16 v[240:243], v[60:63], a[240:243], v[240:243]
v_cvt_pk_bf16_f32 v160, v160, v161
v_cvt_pk_bf16_f32 v161, v162, v163
v_mfma_f32_16x16x32_bf16 v[244:247], v[60:63], a[244:247], v[244:247]
v_cvt_pk_bf16_f32 v162, v176, v177
v_cvt_pk_bf16_f32 v163, v178, v179
v_mfma_f32_16x16x32_bf16 v[248:251], v[60:63], a[248:251], v[248:251]
v_accvgpr_write_b32 a68, v160
v_accvgpr_write_b32 a69, v161
v_mfma_f32_16x16x32_bf16 v[252:255], v[60:63], a[252:255], v[252:255]
v_accvgpr_write_b32 a70, v162
v_accvgpr_write_b32 a71, v163
v_cvt_pk_bf16_f32 v164, v164, v165
v_cvt_pk_bf16_f32 v165, v166, v167
v_cvt_pk_bf16_f32 v166, v180, v181
v_cvt_pk_bf16_f32 v167, v182, v183
v_accvgpr_write_b32 a84, v164
v_accvgpr_write_b32 a85, v165
v_accvgpr_write_b32 a86, v166
v_accvgpr_write_b32 a87, v167
v_cvt_pk_bf16_f32 v168, v168, v169
v_cvt_pk_bf16_f32 v169, v170, v171
v_cvt_pk_bf16_f32 v170, v184, v185
v_cvt_pk_bf16_f32 v171, v186, v187
v_accvgpr_write_b32 a100, v168
v_accvgpr_write_b32 a101, v169
v_accvgpr_write_b32 a102, v170
v_accvgpr_write_b32 a103, v171
v_cvt_pk_bf16_f32 v172, v172, v173
v_cvt_pk_bf16_f32 v173, v174, v175
v_cvt_pk_bf16_f32 v174, v188, v189
v_cvt_pk_bf16_f32 v175, v190, v191
v_accvgpr_write_b32 a116, v172
v_accvgpr_write_b32 a117, v173
v_accvgpr_write_b32 a118, v174
v_accvgpr_write_b32 a119, v175
v_cvt_pk_bf16_f32 v192, v192, v193
v_cvt_pk_bf16_f32 v193, v194, v195
v_cvt_pk_bf16_f32 v194, v208, v209
v_cvt_pk_bf16_f32 v195, v210, v211
s_barrier
v_accvgpr_write_b32 a72, v192
v_accvgpr_write_b32 a73, v193
v_accvgpr_write_b32 a74, v194
v_accvgpr_write_b32 a75, v195
v_mov_b32 v2, v21
v_add_u32 v3, 0x4000, v21
v_cvt_pk_bf16_f32 v196, v196, v197
v_cvt_pk_bf16_f32 v197, v198, v199
v_cvt_pk_bf16_f32 v198, v212, v213
v_cvt_pk_bf16_f32 v199, v214, v215
ds_read_b128 a[0:3], v21 offset:0
ds_read_b128 a[4:7], v21 offset:1024
ds_read_b128 a[8:11], v21 offset:2048
ds_read_b128 a[12:15], v21 offset:3072
v_accvgpr_write_b32 a88, v196
v_accvgpr_write_b32 a89, v197
v_accvgpr_write_b32 a90, v198
v_accvgpr_write_b32 a91, v199
ds_read_b128 a[16:19], v21 offset:4096
ds_read_b128 a[20:23], v21 offset:5120
ds_read_b128 a[24:27], v21 offset:6144
ds_read_b128 a[28:31], v21 offset:7168
v_cvt_pk_bf16_f32 v200, v200, v201
v_cvt_pk_bf16_f32 v201, v202, v203
v_cvt_pk_bf16_f32 v202, v216, v217
v_cvt_pk_bf16_f32 v203, v218, v219
v_accvgpr_write_b32 a104, v200
v_accvgpr_write_b32 a105, v201
v_accvgpr_write_b32 a106, v202
v_accvgpr_write_b32 a107, v203
s_nop 4
v_cvt_pk_bf16_f32 v204, v204, v205
v_cvt_pk_bf16_f32 v205, v206, v207
v_cvt_pk_bf16_f32 v206, v220, v221
v_cvt_pk_bf16_f32 v207, v222, v223
v_accvgpr_write_b32 a120, v204
v_accvgpr_write_b32 a121, v205
v_accvgpr_write_b32 a122, v206
v_accvgpr_write_b32 a123, v207
v_cvt_pk_bf16_f32 v224, v224, v225
v_cvt_pk_bf16_f32 v225, v226, v227
v_cvt_pk_bf16_f32 v226, v240, v241
v_cvt_pk_bf16_f32 v227, v242, v243
v_accvgpr_write_b32 a76, v224
v_accvgpr_write_b32 a77, v225
v_accvgpr_write_b32 a78, v226
v_accvgpr_write_b32 a79, v227
v_cvt_pk_bf16_f32 v228, v228, v229
v_cvt_pk_bf16_f32 v229, v230, v231
v_cvt_pk_bf16_f32 v230, v244, v245
v_cvt_pk_bf16_f32 v231, v246, v247
v_accvgpr_write_b32 a92, v228
v_accvgpr_write_b32 a93, v229
v_accvgpr_write_b32 a94, v230
v_accvgpr_write_b32 a95, v231
v_cvt_pk_bf16_f32 v232, v232, v233
v_cvt_pk_bf16_f32 v233, v234, v235
v_cvt_pk_bf16_f32 v234, v248, v249
v_cvt_pk_bf16_f32 v235, v250, v251
v_accvgpr_write_b32 a108, v232
v_accvgpr_write_b32 a109, v233
v_accvgpr_write_b32 a110, v234
v_accvgpr_write_b32 a111, v235
v_cvt_pk_bf16_f32 v236, v236, v237
v_cvt_pk_bf16_f32 v237, v238, v239
v_cvt_pk_bf16_f32 v238, v252, v253
v_cvt_pk_bf16_f32 v239, v254, v255
v_accvgpr_write_b32 a124, v236
v_accvgpr_write_b32 a125, v237
v_accvgpr_write_b32 a126, v238
v_accvgpr_write_b32 a127, v239
s_add_u32 s48, s43, 0x20000
v_add_u32 v17, s48, v21
ds_write_b128 v17, v[136:139] offset:0
ds_write_b128 v17, v[168:171] offset:1024
ds_write_b128 v17, v[200:203] offset:2048
ds_write_b128 v17, v[232:235] offset:3072
ds_write_b128 v17, v[140:143] offset:4096
ds_write_b128 v17, v[172:175] offset:5120
s_waitcnt lgkmcnt(6)
ds_write_b128 v17, v[204:207] offset:6144
ds_write_b128 v17, v[236:239] offset:7168
v_xor_b32 v17, 0x2000, v17
v_mov_b32 v10, 0xf149f2ca
v_mov_b32 v11, 0x3f803f80
v_accvgpr_write_b32 a144, v11
v_accvgpr_write_b32 a145, v11
v_accvgpr_write_b32 a146, v11
v_accvgpr_write_b32 a147, v11
s_waitcnt lgkmcnt(0)
s_load_dwordx2 s[8:9], s[0:1], 40
s_load_dwordx2 s[12:13], s[0:1], 80
v_mfma_f32_16x16x32_bf16 v[32:35], a[0:3], a[64:67], 0
v_mov_b64 v[128:129], 0
v_mov_b64 v[130:131], 0
v_mfma_f32_16x16x32_bf16 v[36:39], a[0:3], a[80:83], 0
v_mov_b64 v[132:133], 0
v_mov_b64 v[134:135], 0
v_mfma_f32_16x16x32_bf16 v[40:43], a[0:3], a[96:99], 0
v_mov_b64 v[136:137], 0
v_mov_b64 v[138:139], 0
v_mfma_f32_16x16x32_bf16 v[44:47], a[0:3], a[112:115], 0
v_mov_b64 v[140:141], 0
v_mov_b64 v[142:143], 0
v_mfma_f32_16x16x32_bf16 v[32:35], a[4:7], a[68:71], v[32:35]
v_mov_b64 v[144:145], 0
v_mov_b64 v[146:147], 0
v_mfma_f32_16x16x32_bf16 v[36:39], a[4:7], a[84:87], v[36:39]
v_mov_b64 v[148:149], 0
v_mov_b64 v[150:151], 0
v_mfma_f32_16x16x32_bf16 v[40:43], a[4:7], a[100:103], v[40:43]
v_mov_b64 v[152:153], 0
v_mov_b64 v[154:155], 0
v_mfma_f32_16x16x32_bf16 v[44:47], a[4:7], a[116:119], v[44:47]
v_mov_b64 v[156:157], 0
v_mov_b64 v[158:159], 0
v_mfma_f32_16x16x32_bf16 v[32:35], a[8:11], a[72:75], v[32:35]
v_mov_b64 v[160:161], 0
v_mov_b64 v[162:163], 0
v_mfma_f32_16x16x32_bf16 v[36:39], a[8:11], a[88:91], v[36:39]
v_mov_b64 v[164:165], 0
v_mov_b64 v[166:167], 0
v_mfma_f32_16x16x32_bf16 v[40:43], a[8:11], a[104:107], v[40:43]
v_mov_b64 v[168:169], 0
v_mov_b64 v[170:171], 0
v_mfma_f32_16x16x32_bf16 v[44:47], a[8:11], a[120:123], v[44:47]
v_mov_b64 v[172:173], 0
v_mov_b64 v[174:175], 0
v_mfma_f32_16x16x32_bf16 v[32:35], a[12:15], a[76:79], v[32:35]
v_mov_b64 v[176:177], 0
v_mov_b64 v[178:179], 0
v_mfma_f32_16x16x32_bf16 v[36:39], a[12:15], a[92:95], v[36:39]
v_mov_b64 v[180:181], 0
v_mov_b64 v[182:183], 0
v_mfma_f32_16x16x32_bf16 v[40:43], a[12:15], a[108:111], v[40:43]
v_mov_b64 v[184:185], 0
v_mov_b64 v[186:187], 0
v_mfma_f32_16x16x32_bf16 v[44:47], a[12:15], a[124:127], v[44:47]
v_mov_b64 v[188:189], 0
v_mov_b64 v[190:191], 0
v_mfma_f32_16x16x32_bf16 v[48:51], a[16:19], a[64:67], 0
v_mov_b64 v[192:193], 0
v_mov_b64 v[194:195], 0
v_mfma_f32_16x16x32_bf16 v[52:55], a[16:19], a[80:83], 0
v_mov_b64 v[196:197], 0
v_mov_b64 v[198:199], 0
v_mfma_f32_16x16x32_bf16 v[56:59], a[16:19], a[96:99], 0
v_mov_b64 v[200:201], 0
v_mov_b64 v[202:203], 0
v_mfma_f32_16x16x32_bf16 v[60:63], a[16:19], a[112:115], 0
v_mov_b64 v[204:205], 0
v_mov_b64 v[206:207], 0
v_mfma_f32_16x16x32_bf16 v[48:51], a[20:23], a[68:71], v[48:51]
v_mov_b64 v[208:209], 0
v_mov_b64 v[210:211], 0
v_mfma_f32_16x16x32_bf16 v[52:55], a[20:23], a[84:87], v[52:55]
v_mov_b64 v[212:213], 0
v_mov_b64 v[214:215], 0
v_mfma_f32_16x16x32_bf16 v[56:59], a[20:23], a[100:103], v[56:59]
v_mov_b64 v[216:217], 0
v_mov_b64 v[218:219], 0
v_mfma_f32_16x16x32_bf16 v[60:63], a[20:23], a[116:119], v[60:63]
v_mov_b64 v[220:221], 0
v_mov_b64 v[222:223], 0
v_mfma_f32_16x16x32_bf16 v[48:51], a[24:27], a[72:75], v[48:51]
v_mov_b64 v[224:225], 0
v_mov_b64 v[226:227], 0
v_mfma_f32_16x16x32_bf16 v[52:55], a[24:27], a[88:91], v[52:55]
v_mov_b64 v[228:229], 0
v_mov_b64 v[230:231], 0
v_mfma_f32_16x16x32_bf16 v[56:59], a[24:27], a[104:107], v[56:59]
v_mov_b64 v[232:233], 0
v_mov_b64 v[234:235], 0
v_mfma_f32_16x16x32_bf16 v[60:63], a[24:27], a[120:123], v[60:63]
v_mov_b64 v[236:237], 0
v_mov_b64 v[238:239], 0
v_mfma_f32_16x16x32_bf16 v[48:51], a[28:31], a[76:79], v[48:51]
v_mov_b64 v[240:241], 0
v_mov_b64 v[242:243], 0
v_mfma_f32_16x16x32_bf16 v[52:55], a[28:31], a[92:95], v[52:55]
v_mov_b64 v[244:245], 0
v_mov_b64 v[246:247], 0
v_mfma_f32_16x16x32_bf16 v[56:59], a[28:31], a[108:111], v[56:59]
v_mov_b64 v[248:249], 0
v_mov_b64 v[250:251], 0
v_mfma_f32_16x16x32_bf16 v[60:63], a[28:31], a[124:127], v[60:63]
v_mov_b64 v[252:253], 0
v_mov_b64 v[254:255], 0
ds_read_b128 a[0:3], v3 offset:0
ds_read_b128 a[4:7], v3 offset:1024
ds_read_b128 a[8:11], v3 offset:2048
ds_read_b128 a[12:15], v3 offset:3072
ds_read_b128 a[16:19], v3 offset:4096
ds_read_b128 a[20:23], v3 offset:5120
ds_read_b128 a[24:27], v3 offset:6144
ds_read_b128 a[28:31], v3 offset:7168
v_accvgpr_write_b32 a128, 0
v_accvgpr_write_b32 a129, 0
v_accvgpr_write_b32 a130, 0
v_accvgpr_write_b32 a131, 0
v_accvgpr_write_b32 a132, 0
v_accvgpr_write_b32 a133, 0
v_accvgpr_write_b32 a134, 0
v_accvgpr_write_b32 a135, 0
v_accvgpr_write_b32 a136, 0
v_accvgpr_write_b32 a137, 0
v_accvgpr_write_b32 a138, 0
v_accvgpr_write_b32 a139, 0
v_accvgpr_write_b32 a140, 0
v_accvgpr_write_b32 a141, 0
v_accvgpr_write_b32 a142, 0
v_accvgpr_write_b32 a143, 0
s_cmp_lg_u32 s53, 0
s_cbranch_scc1 L_nd0_KN
v_cndmask_b32 v32, v10, v32, s[56:57]
v_mov_b32 v48, v10
v_cndmask_b32 v52, v10, v52, s[56:57]
v_cndmask_b32 v33, v10, v33, s[58:59]
v_mov_b32 v49, v10
v_cndmask_b32 v53, v10, v53, s[58:59]
v_cndmask_b32 v34, v10, v34, s[60:61]
v_mov_b32 v50, v10
v_cndmask_b32 v54, v10, v54, s[60:61]
v_cndmask_b32 v35, v10, v35, s[62:63]
v_mov_b32 v51, v10
v_cndmask_b32 v55, v10, v55, s[62:63]
L_nd0_KN:
v_max3_f32 v4, v32, v33, v34
v_max3_f32 v4, v4, v35, v48
v_max3_f32 v4, v4, v49, v50
v_max_f32 v4, v4, v51
v_max3_f32 v5, v36, v37, v38
v_max3_f32 v5, v5, v39, v52
v_max3_f32 v5, v5, v53, v54
v_max_f32 v5, v5, v55
v_max3_f32 v6, v40, v41, v42
v_max3_f32 v6, v6, v43, v56
v_max3_f32 v6, v6, v57, v58
v_max_f32 v6, v6, v59
v_max3_f32 v7, v44, v45, v46
v_max3_f32 v7, v7, v47, v60
v_max3_f32 v7, v7, v61, v62
v_max_f32 v7, v7, v63
v_mov_b32 v11, v4
v_mov_b32 v12, v5
v_mov_b32 v13, v6
v_mov_b32 v14, v7
v_permlane16_swap_b32 v4, v11
v_permlane16_swap_b32 v5, v12
v_permlane16_swap_b32 v6, v13
v_permlane16_swap_b32 v7, v14
v_max_f32 v4, v4, v11
v_max_f32 v5, v5, v12
v_max_f32 v6, v6, v13
v_max_f32 v7, v7, v14
v_mov_b32 v11, v4
v_mov_b32 v12, v5
v_mov_b32 v13, v6
v_mov_b32 v14, v7
v_permlane32_swap_b32 v4, v11
v_permlane32_swap_b32 v5, v12
v_permlane32_swap_b32 v6, v13
v_permlane32_swap_b32 v7, v14
v_max_f32 v4, v4, v11
v_max_f32 v5, v5, v12
v_max_f32 v6, v6, v13
v_max_f32 v7, v7, v14
v_xor_b32 v4, 0x80000000, v4
v_xor_b32 v5, 0x80000000, v5
v_xor_b32 v6, 0x80000000, v6
v_xor_b32 v7, 0x80000000, v7
s_lshl_b32 s48, s42, 9
s_add_u32 s48, s48, 114688
v_lshlrev_b32 v11, 3, v0
v_add_u32 v11, s48, v11
ds_write_b64 v11, v[6:7]
v_xor_b32 v11, 512, v11
v_add_f32 v32, v32, v4
v_add_f32 v33, v33, v4
v_add_f32 v34, v34, v4
v_add_f32 v35, v35, v4
v_add_f32 v36, v36, v5
v_add_f32 v37, v37, v5
v_add_f32 v38, v38, v5
v_add_f32 v39, v39, v5
v_add_f32 v40, v40, v6
v_add_f32 v41, v41, v6
v_add_f32 v42, v42, v6
v_add_f32 v43, v43, v6
v_add_f32 v44, v44, v7
v_add_f32 v45, v45, v7
v_add_f32 v46, v46, v7
v_add_f32 v47, v47, v7
v_add_f32 v48, v48, v4
v_add_f32 v49, v49, v4
v_add_f32 v50, v50, v4
v_add_f32 v51, v51, v4
v_add_f32 v52, v52, v5
v_add_f32 v53, v53, v5
v_add_f32 v54, v54, v5
v_add_f32 v55, v55, v5
v_add_f32 v56, v56, v6
v_add_f32 v57, v57, v6
v_add_f32 v58, v58, v6
v_add_f32 v59, v59, v6
v_add_f32 v60, v60, v7
v_add_f32 v61, v61, v7
v_add_f32 v62, v62, v7
v_add_f32 v63, v63, v7
s_waitcnt lgkmcnt(0)
s_barrier
ds_read_b64 v[8:9], v11
v_mov_b32 v96, v4
v_mov_b32 v97, v4
v_mov_b32 v98, v4
v_mov_b32 v99, v4
v_mov_b32 v100, v5
v_mov_b32 v101, v5
v_mov_b32 v102, v5
v_mov_b32 v103, v5
v_mov_b32 v104, v6
v_mov_b32 v105, v6
v_mov_b32 v106, v6
v_mov_b32 v107, v6
v_mov_b32 v108, v7
v_mov_b32 v109, v7
v_mov_b32 v110, v7
v_mov_b32 v111, v7
v_mov_b32 v112, v4
v_mov_b32 v113, v4
v_mov_b32 v114, v4
v_mov_b32 v115, v4
v_mov_b32 v116, v5
v_mov_b32 v117, v5
v_mov_b32 v118, v5
v_mov_b32 v119, v5
v_mov_b32 v120, v6
v_mov_b32 v121, v6
v_mov_b32 v122, v6
v_mov_b32 v123, v6
v_mov_b32 v124, v7
v_mov_b32 v125, v7
v_mov_b32 v126, v7
v_mov_b32 v127, v7
s_waitcnt vmcnt(0)
v_readfirstlane_b32 s48, v29
v_readfirstlane_b32 s17, v30
s_or_b32 s17, s17, s16
s_and_b32 s48, s48, s17
s_or_b32 s48, s48, s14
s_cmp_lg_u32 s48, -1
s_cbranch_scc1 L_pstub1_KN
L_pback1_KN:
s_waitcnt lgkmcnt(0)
s_barrier
s_lshl_b32 s17, s41, 4
s_add_u32 s17, s17, s15
s_add_u32 s17, s17, 524
s_mov_b64 exec, 1
buffer_store_dword v31, v21, s[36:39], s17 offen sc1
s_mov_b64 exec, -1
s_add_u32 m0, s11, 114688
s_add_u32 s49, s49, 57344
buffer_load_dwordx4 v21, s[28:31], s49 offen offset:0 lds
buffer_load_dwordx4 v21, s[28:31], s49 offen offset:1024 lds
buffer_load_dwordx4 v21, s[28:31], s49 offen offset:2048 lds
buffer_load_dwordx4 v21, s[28:31], s49 offen offset:3072 lds
s_lshl_b32 s48, s2, 2
s_add_u32 s48, s48, s42
s_lshr_b32 s18, s48, 3
s_and_b32 s48, s48, 7
s_lshl_b32 s100, s18, 8
s_add_u32 s100, s100, s48
s_lshl_b32 s100, s100, 7
v_lshrrev_b32 v30, 3, v0
v_and_b32 v23, 7, v0
v_lshlrev_b32 v29, 12, v30
v_lshl_or_b32 v29, v23, 4, v29
s_mov_b32 s10, 4194304
s_mov_b32 s11, 0x20000
s_and_b32 s9, s9, 0xffff
buffer_load_dwordx4 a[160:163], v29, s[8:11], s100 offen offset:0
buffer_load_dwordx4 a[164:167], v29, s[8:11], s100 offen offset:1024
buffer_load_dwordx4 a[168:171], v29, s[8:11], s100 offen offset:2048
buffer_load_dwordx4 a[172:175], v29, s[8:11], s100 offen offset:3072
v_and_b32 v30, 31, v0
v_lshlrev_b32 v30, 5, v30
v_lshrrev_b32 v20, 5, v0
v_lshl_or_b32 v30, v20, 4, v30
s_lshl_b32 s8, s48, 12
s_lshr_b32 s9, s18, 5
s_lshl_b32 s9, s9, 10
s_add_u32 s8, s8, s9
s_and_b32 s9, s18, 31
s_lshl_b32 s9, s9, 4
s_add_u32 s8, s8, s9
s_add_u32 s8, s8, 57671692
s_lshl_b32 s9, s48, 19
s_lshl_b32 s18, s18, 12
s_add_u32 s9, s9, s18
s_add_u32 s9, s9, 52428800
s_mov_b32 s10, 0x05040100
s_mov_b32 s11, 0x07060302
s_lshl_b32 s100, s41, 2
s_add_u32 s100, s100, s42
s_lshl_b32 s100, s100, 17
s_add_u32 s100, s100, 52428800
s_lshl_b32 s101, s19, 10
s_lshl_b32 s48, s40, 4
s_add_u32 s101, s101, s48
s_add_u32 s101, s101, 57671680
s_min_u32 s48, s40, 27
s_lshl_b32 s48, s48, 3
s_add_u32 s48, s48, s41
s_lshl_b32 s18, s48, 13
s_add_u32 s18, s18, 4096
v_lshl_add_u32 v23, v0, 2, s18
s_lshl_b32 s18, s42, 8
v_add_u32 v23, s18, v23
s_mul_i32 s18, s42, 1792
v_mul_u32_u24 v20, 28, v0
v_add3_u32 v20, v20, v23, s18
global_load_dword v20, v20, s[12:13] offset:-4096
v_lshrrev_b32 v19, 5, v0
v_and_b32 v18, 31, v0
v_mul_u32_u24 v19, 57344, v19
v_lshl_add_u32 v18, v18, 3, v19
v_add_u32 v19, 458752, v18
s_mul_i32 s14, s42, 114688
s_lshl_b32 s48, s48, 8
s_add_u32 s14, s14, s48
s_add_u32 s14, s14, 50348032
s_lshl_b32 s16, s40, 3
s_add_u32 s16, s16, s41
s_lshl_b32 s16, s16, 10
s_add_u32 s16, s16, 56623104
s_cmp_lt_u32 s40, 28
s_cselect_b32 s14, s14, 1073741824
v_exp_f32 v32, v32
v_exp_f32 v33, v33
v_exp_f32 v34, v34
v_exp_f32 v35, v35
v_exp_f32 v36, v36
v_exp_f32 v37, v37
v_exp_f32 v38, v38
v_exp_f32 v39, v39
v_exp_f32 v40, v40
v_exp_f32 v41, v41
v_exp_f32 v42, v42
v_exp_f32 v43, v43
v_exp_f32 v44, v44
v_exp_f32 v45, v45
v_exp_f32 v46, v46
v_exp_f32 v47, v47
v_exp_f32 v48, v48
v_exp_f32 v49, v49
v_exp_f32 v50, v50
v_exp_f32 v51, v51
v_exp_f32 v52, v52
v_exp_f32 v53, v53
v_exp_f32 v54, v54
v_exp_f32 v55, v55
v_cvt_pk_bf16_f32 v64, v32, v33
v_cvt_pk_bf16_f32 v65, v34, v35
v_cvt_pk_bf16_f32 v68, v36, v37
v_cvt_pk_bf16_f32 v69, v38, v39
v_cvt_pk_bf16_f32 v72, v40, v41
v_cvt_pk_bf16_f32 v73, v42, v43
v_cvt_pk_bf16_f32 v76, v44, v45
v_cvt_pk_bf16_f32 v77, v46, v47
v_cvt_pk_bf16_f32 v66, v48, v49
v_cvt_pk_bf16_f32 v67, v50, v51
v_cvt_pk_bf16_f32 v70, v52, v53
v_cvt_pk_bf16_f32 v71, v54, v55
.p2align 6
L_l1_KN:
s_bitcmp1_b64 s[50:51], s44
s_cbranch_scc1 L_stub0_KN
L_back0_KN:
v_mfma_f32_16x16x32_bf16 v[32:35], a[0:3], a[64:67], v[96:99]
v_exp_f32 v56, v56
v_mfma_f32_16x16x32_bf16 v[36:39], a[0:3], a[80:83], v[100:103]
ds_read_b128 a[32:35], v2 offset:8192
ds_read_b128 a[36:39], v2 offset:9216
v_mfma_f32_16x16x32_bf16 v[40:43], a[0:3], a[96:99], v[104:107]
v_exp_f32 v57, v57
v_mfma_f32_16x16x32_bf16 v[44:47], a[0:3], a[112:115], v[108:111]
ds_read_b128 a[40:43], v2 offset:10240
ds_read_b128 a[44:47], v2 offset:11264
v_mfma_f32_16x16x32_bf16 v[32:35], a[4:7], a[68:71], v[32:35]
v_exp_f32 v58, v58
v_mfma_f32_16x16x32_bf16 v[36:39], a[4:7], a[84:87], v[36:39]
ds_read_b128 a[48:51], v2 offset:12288
ds_read_b128 a[52:55], v2 offset:13312
v_mfma_f32_16x16x32_bf16 v[40:43], a[4:7], a[100:103], v[40:43]
v_exp_f32 v59, v59
v_mfma_f32_16x16x32_bf16 v[44:47], a[4:7], a[116:119], v[44:47]
ds_read_b128 a[56:59], v2 offset:14336
ds_read_b128 a[60:63], v2 offset:15360
v_mfma_f32_16x16x32_bf16 v[32:35], a[8:11], a[72:75], v[32:35]
v_exp_f32 v60, v60
v_mfma_f32_16x16x32_bf16 v[36:39], a[8:11], a[88:91], v[36:39]
v_cvt_pk_bf16_f32 v74, v56, v57
v_cvt_pk_bf16_f32 v75, v58, v59
v_mfma_f32_16x16x32_bf16 v[40:43], a[8:11], a[104:107], v[40:43]
v_exp_f32 v61, v61
v_mfma_f32_16x16x32_bf16 v[44:47], a[8:11], a[120:123], v[44:47]
v_cvt_pk_bf16_f32 v78, v60, v61
v_mfma_f32_16x16x32_bf16 v[32:35], a[12:15], a[76:79], v[32:35]
v_exp_f32 v62, v62
v_mfma_f32_16x16x32_bf16 v[36:39], a[12:15], a[92:95], v[36:39]
v_mfma_f32_16x16x32_bf16 v[40:43], a[12:15], a[108:111], v[40:43]
v_exp_f32 v63, v63
v_mfma_f32_16x16x32_bf16 v[44:47], a[12:15], a[124:127], v[44:47]
v_cvt_pk_bf16_f32 v79, v62, v63
v_mfma_f32_16x16x32_bf16 v[48:51], a[16:19], a[64:67], v[112:115]
v_mfma_f32_16x16x32_bf16 v[52:55], a[16:19], a[80:83], v[116:119]
v_exp_f32 v32, v32
v_mfma_f32_16x16x32_bf16 v[56:59], a[16:19], a[96:99], v[120:123]
v_exp_f32 v33, v33
v_mfma_f32_16x16x32_bf16 v[60:63], a[16:19], a[112:115], v[124:127]
s_add_u32 s46, s46, 16384
s_add_u32 s47, s47, 32768
v_mfma_f32_16x16x32_bf16 v[48:51], a[20:23], a[68:71], v[48:51]
v_exp_f32 v34, v34
v_mfma_f32_16x16x32_bf16 v[52:55], a[20:23], a[84:87], v[52:55]
v_exp_f32 v35, v35
v_mfma_f32_16x16x32_bf16 v[56:59], a[20:23], a[100:103], v[56:59]
s_max_i32 s48, s46, s47
s_and_b32 s48, s48, 0x1ffff
v_mfma_f32_16x16x32_bf16 v[60:63], a[20:23], a[116:119], v[60:63]
v_exp_f32 v36, v36
v_mfma_f32_16x16x32_bf16 v[48:51], a[24:27], a[72:75], v[48:51]
v_exp_f32 v37, v37
v_mfma_f32_16x16x32_bf16 v[52:55], a[24:27], a[88:91], v[52:55]
v_add_u32 v2, s48, v21
s_add_u32 s44, s44, 1
v_mfma_f32_16x16x32_bf16 v[56:59], a[24:27], a[104:107], v[56:59]
v_exp_f32 v38, v38
v_mfma_f32_16x16x32_bf16 v[60:63], a[24:27], a[120:123], v[60:63]
v_exp_f32 v39, v39
v_mfma_f32_16x16x32_bf16 v[48:51], a[28:31], a[76:79], v[48:51]
v_cvt_pk_bf16_f32 v80, v32, v33
v_cvt_pk_bf16_f32 v81, v34, v35
v_mfma_f32_16x16x32_bf16 v[52:55], a[28:31], a[92:95], v[52:55]
v_exp_f32 v40, v40
v_mfma_f32_16x16x32_bf16 v[56:59], a[28:31], a[108:111], v[56:59]
v_exp_f32 v41, v41
v_mfma_f32_16x16x32_bf16 v[60:63], a[28:31], a[124:127], v[60:63]
s_waitcnt vmcnt(16) lgkmcnt(0)
s_barrier
v_mfma_f32_16x16x32_bf16 a[128:131], a[144:147], v[64:67], a[128:131]
v_cvt_pk_bf16_f32 v84, v36, v37
v_cvt_pk_bf16_f32 v85, v38, v39
v_mfma_f32_16x16x32_bf16 a[132:135], a[144:147], v[68:71], a[132:135]
v_exp_f32 v42, v42
v_mfma_f32_16x16x32_bf16 a[136:139], a[144:147], v[72:75], a[136:139]
v_cvt_pk_bf16_f32 v88, v40, v41
s_add_u32 m0, m0, 16384
v_mfma_f32_16x16x32_bf16 a[140:143], a[144:147], v[76:79], a[140:143]
v_exp_f32 v43, v43
v_mfma_f32_16x16x32_bf16 v[128:131], a[32:35], v[64:67], v[128:131]
v_cvt_pk_bf16_f32 v89, v42, v43
s_and_b32 m0, m0, 0x1ffff
v_mfma_f32_16x16x32_bf16 v[132:135], a[32:35], v[68:71], v[132:135]
v_exp_f32 v44, v44
v_mfma_f32_16x16x32_bf16 v[136:139], a[32:35], v[72:75], v[136:139]
s_add_u32 s49, s49, 8192
ds_read_b128 a[0:3], v2 offset:0
v_mfma_f32_16x16x32_bf16 v[140:143], a[32:35], v[76:79], v[140:143]
v_exp_f32 v45, v45
v_mfma_f32_16x16x32_bf16 v[144:147], a[36:39], v[64:67], v[144:147]
v_cvt_pk_bf16_f32 v92, v44, v45
buffer_load_dwordx4 v21, s[28:31], s49 offen offset:0 lds
v_mfma_f32_16x16x32_bf16 v[148:151], a[36:39], v[68:71], v[148:151]
v_exp_f32 v46, v46
v_mfma_f32_16x16x32_bf16 v[152:155], a[36:39], v[72:75], v[152:155]
ds_read_b128 a[4:7], v2 offset:1024
buffer_load_dwordx4 v21, s[28:31], s49 offen offset:1024 lds
v_mfma_f32_16x16x32_bf16 v[156:159], a[36:39], v[76:79], v[156:159]
v_exp_f32 v47, v47
v_mfma_f32_16x16x32_bf16 v[160:163], a[40:43], v[64:67], v[160:163]
v_cvt_pk_bf16_f32 v93, v46, v47
ds_read_b128 a[8:11], v2 offset:2048
v_mfma_f32_16x16x32_bf16 v[164:167], a[40:43], v[68:71], v[164:167]
v_exp_f32 v48, v48
v_mfma_f32_16x16x32_bf16 v[168:171], a[40:43], v[72:75], v[168:171]
buffer_load_dwordx4 v21, s[28:31], s49 offen offset:2048 lds
ds_read_b128 a[12:15], v2 offset:3072
v_mfma_f32_16x16x32_bf16 v[172:175], a[40:43], v[76:79], v[172:175]
v_exp_f32 v49, v49
v_mfma_f32_16x16x32_bf16 v[176:179], a[44:47], v[64:67], v[176:179]
v_cvt_pk_bf16_f32 v82, v48, v49
buffer_load_dwordx4 v21, s[28:31], s49 offen offset:3072 lds
v_mfma_f32_16x16x32_bf16 v[180:183], a[44:47], v[68:71], v[180:183]
v_exp_f32 v50, v50
v_mfma_f32_16x16x32_bf16 v[184:187], a[44:47], v[72:75], v[184:187]
ds_read_b128 a[16:19], v2 offset:4096
ds_read_b128 a[20:23], v2 offset:5120
v_mfma_f32_16x16x32_bf16 v[188:191], a[44:47], v[76:79], v[188:191]
v_exp_f32 v51, v51
v_mfma_f32_16x16x32_bf16 v[192:195], a[48:51], v[64:67], v[192:195]
v_cvt_pk_bf16_f32 v83, v50, v51
ds_read_b128 a[24:27], v2 offset:6144
v_mfma_f32_16x16x32_bf16 v[196:199], a[48:51], v[68:71], v[196:199]
v_exp_f32 v52, v52
v_mfma_f32_16x16x32_bf16 v[200:203], a[48:51], v[72:75], v[200:203]
ds_read_b128 a[28:31], v2 offset:7168
v_mfma_f32_16x16x32_bf16 v[204:207], a[48:51], v[76:79], v[204:207]
v_exp_f32 v53, v53
v_mfma_f32_16x16x32_bf16 v[208:211], a[52:55], v[64:67], v[208:211]
v_cvt_pk_bf16_f32 v86, v52, v53
v_mfma_f32_16x16x32_bf16 v[212:215], a[52:55], v[68:71], v[212:215]
v_exp_f32 v54, v54
v_mfma_f32_16x16x32_bf16 v[216:219], a[52:55], v[72:75], v[216:219]
v_mfma_f32_16x16x32_bf16 v[220:223], a[52:55], v[76:79], v[220:223]
v_exp_f32 v55, v55
v_mfma_f32_16x16x32_bf16 v[224:227], a[56:59], v[64:67], v[224:227]
v_cvt_pk_bf16_f32 v87, v54, v55
v_mfma_f32_16x16x32_bf16 v[228:231], a[56:59], v[68:71], v[228:231]
v_mfma_f32_16x16x32_bf16 v[232:235], a[56:59], v[72:75], v[232:235]
v_mfma_f32_16x16x32_bf16 v[236:239], a[56:59], v[76:79], v[236:239]
v_mfma_f32_16x16x32_bf16 v[240:243], a[60:63], v[64:67], v[240:243]
v_mfma_f32_16x16x32_bf16 v[244:247], a[60:63], v[68:71], v[244:247]
v_mfma_f32_16x16x32_bf16 v[248:251], a[60:63], v[72:75], v[248:251]
s_waitcnt lgkmcnt(0)
v_mfma_f32_16x16x32_bf16 v[252:255], a[60:63], v[76:79], v[252:255]
s_bitcmp1_b64 s[50:51], s44
s_cbranch_scc1 L_stub1_KN
L_back1_KN:
v_mfma_f32_16x16x32_bf16 v[32:35], a[0:3], a[64:67], v[96:99]
v_exp_f32 v56, v56
v_mfma_f32_16x16x32_bf16 v[36:39], a[0:3], a[80:83], v[100:103]
ds_read_b128 a[32:35], v3 offset:8192
ds_read_b128 a[36:39], v3 offset:9216
v_mfma_f32_16x16x32_bf16 v[40:43], a[0:3], a[96:99], v[104:107]
v_exp_f32 v57, v57
v_mfma_f32_16x16x32_bf16 v[44:47], a[0:3], a[112:115], v[108:111]
ds_read_b128 a[40:43], v3 offset:10240
ds_read_b128 a[44:47], v3 offset:11264
v_mfma_f32_16x16x32_bf16 v[32:35], a[4:7], a[68:71], v[32:35]
v_exp_f32 v58, v58
v_mfma_f32_16x16x32_bf16 v[36:39], a[4:7], a[84:87], v[36:39]
ds_read_b128 a[48:51], v3 offset:12288
ds_read_b128 a[52:55], v3 offset:13312
v_mfma_f32_16x16x32_bf16 v[40:43], a[4:7], a[100:103], v[40:43]
v_exp_f32 v59, v59
v_mfma_f32_16x16x32_bf16 v[44:47], a[4:7], a[116:119], v[44:47]
ds_read_b128 a[56:59], v3 offset:14336
ds_read_b128 a[60:63], v3 offset:15360
v_mfma_f32_16x16x32_bf16 v[32:35], a[8:11], a[72:75], v[32:35]
v_exp_f32 v60, v60
v_mfma_f32_16x16x32_bf16 v[36:39], a[8:11], a[88:91], v[36:39]
v_cvt_pk_bf16_f32 v90, v56, v57
v_cvt_pk_bf16_f32 v91, v58, v59
v_mfma_f32_16x16x32_bf16 v[40:43], a[8:11], a[104:107], v[40:43]
v_exp_f32 v61, v61
v_mfma_f32_16x16x32_bf16 v[44:47], a[8:11], a[120:123], v[44:47]
v_cvt_pk_bf16_f32 v94, v60, v61
v_mfma_f32_16x16x32_bf16 v[32:35], a[12:15], a[76:79], v[32:35]
v_exp_f32 v62, v62
v_mfma_f32_16x16x32_bf16 v[36:39], a[12:15], a[92:95], v[36:39]
v_mfma_f32_16x16x32_bf16 v[40:43], a[12:15], a[108:111], v[40:43]
v_exp_f32 v63, v63
v_mfma_f32_16x16x32_bf16 v[44:47], a[12:15], a[124:127], v[44:47]
v_cvt_pk_bf16_f32 v95, v62, v63
v_mfma_f32_16x16x32_bf16 v[48:51], a[16:19], a[64:67], v[112:115]
v_mfma_f32_16x16x32_bf16 v[52:55], a[16:19], a[80:83], v[116:119]
v_exp_f32 v32, v32
v_mfma_f32_16x16x32_bf16 v[56:59], a[16:19], a[96:99], v[120:123]
v_exp_f32 v33, v33
v_mfma_f32_16x16x32_bf16 v[60:63], a[16:19], a[112:115], v[124:127]
s_add_u32 s46, s46, 16384
s_add_u32 s47, s47, 32768
v_mfma_f32_16x16x32_bf16 v[48:51], a[20:23], a[68:71], v[48:51]
v_exp_f32 v34, v34
v_mfma_f32_16x16x32_bf16 v[52:55], a[20:23], a[84:87], v[52:55]
v_exp_f32 v35, v35
v_mfma_f32_16x16x32_bf16 v[56:59], a[20:23], a[100:103], v[56:59]
s_max_i32 s48, s46, s47
s_and_b32 s48, s48, 0x1ffff
v_mfma_f32_16x16x32_bf16 v[60:63], a[20:23], a[116:119], v[60:63]
v_exp_f32 v36, v36
v_mfma_f32_16x16x32_bf16 v[48:51], a[24:27], a[72:75], v[48:51]
v_exp_f32 v37, v37
v_mfma_f32_16x16x32_bf16 v[52:55], a[24:27], a[88:91], v[52:55]
v_add_u32 v3, s48, v21
s_add_u32 s44, s44, 1
v_mfma_f32_16x16x32_bf16 v[56:59], a[24:27], a[104:107], v[56:59]
v_exp_f32 v38, v38
v_mfma_f32_16x16x32_bf16 v[60:63], a[24:27], a[120:123], v[60:63]
v_exp_f32 v39, v39
v_mfma_f32_16x16x32_bf16 v[48:51], a[28:31], a[76:79], v[48:51]
v_cvt_pk_bf16_f32 v64, v32, v33
v_cvt_pk_bf16_f32 v65, v34, v35
v_mfma_f32_16x16x32_bf16 v[52:55], a[28:31], a[92:95], v[52:55]
v_exp_f32 v40, v40
v_mfma_f32_16x16x32_bf16 v[56:59], a[28:31], a[108:111], v[56:59]
v_exp_f32 v41, v41
v_mfma_f32_16x16x32_bf16 v[60:63], a[28:31], a[124:127], v[60:63]
s_waitcnt vmcnt(16) lgkmcnt(0)
s_barrier
v_mfma_f32_16x16x32_bf16 a[128:131], a[144:147], v[80:83], a[128:131]
v_cvt_pk_bf16_f32 v68, v36, v37
v_cvt_pk_bf16_f32 v69, v38, v39
v_mfma_f32_16x16x32_bf16 a[132:135], a[144:147], v[84:87], a[132:135]
v_exp_f32 v42, v42
v_mfma_f32_16x16x32_bf16 a[136:139], a[144:147], v[88:91], a[136:139]
v_cvt_pk_bf16_f32 v72, v40, v41
s_add_u32 m0, m0, 16384
v_mfma_f32_16x16x32_bf16 a[140:143], a[144:147], v[92:95], a[140:143]
v_exp_f32 v43, v43
v_mfma_f32_16x16x32_bf16 v[128:131], a[32:35], v[80:83], v[128:131]
v_cvt_pk_bf16_f32 v73, v42, v43
s_and_b32 m0, m0, 0x1ffff
v_mfma_f32_16x16x32_bf16 v[132:135], a[32:35], v[84:87], v[132:135]
v_exp_f32 v44, v44
v_mfma_f32_16x16x32_bf16 v[136:139], a[32:35], v[88:91], v[136:139]
s_add_u32 s49, s49, 8192
ds_read_b128 a[0:3], v3 offset:0
v_mfma_f32_16x16x32_bf16 v[140:143], a[32:35], v[92:95], v[140:143]
v_exp_f32 v45, v45
v_mfma_f32_16x16x32_bf16 v[144:147], a[36:39], v[80:83], v[144:147]
v_cvt_pk_bf16_f32 v76, v44, v45
buffer_load_dwordx4 v21, s[28:31], s49 offen offset:0 lds
v_mfma_f32_16x16x32_bf16 v[148:151], a[36:39], v[84:87], v[148:151]
v_exp_f32 v46, v46
v_mfma_f32_16x16x32_bf16 v[152:155], a[36:39], v[88:91], v[152:155]
ds_read_b128 a[4:7], v3 offset:1024
buffer_load_dwordx4 v21, s[28:31], s49 offen offset:1024 lds
v_mfma_f32_16x16x32_bf16 v[156:159], a[36:39], v[92:95], v[156:159]
v_exp_f32 v47, v47
v_mfma_f32_16x16x32_bf16 v[160:163], a[40:43], v[80:83], v[160:163]
v_cvt_pk_bf16_f32 v77, v46, v47
ds_read_b128 a[8:11], v3 offset:2048
v_mfma_f32_16x16x32_bf16 v[164:167], a[40:43], v[84:87], v[164:167]
v_exp_f32 v48, v48
v_mfma_f32_16x16x32_bf16 v[168:171], a[40:43], v[88:91], v[168:171]
buffer_load_dwordx4 v21, s[28:31], s49 offen offset:2048 lds
ds_read_b128 a[12:15], v3 offset:3072
v_mfma_f32_16x16x32_bf16 v[172:175], a[40:43], v[92:95], v[172:175]
v_exp_f32 v49, v49
v_mfma_f32_16x16x32_bf16 v[176:179], a[44:47], v[80:83], v[176:179]
v_cvt_pk_bf16_f32 v66, v48, v49
buffer_load_dwordx4 v21, s[28:31], s49 offen offset:3072 lds
v_mfma_f32_16x16x32_bf16 v[180:183], a[44:47], v[84:87], v[180:183]
v_exp_f32 v50, v50
v_mfma_f32_16x16x32_bf16 v[184:187], a[44:47], v[88:91], v[184:187]
ds_read_b128 a[16:19], v3 offset:4096
ds_read_b128 a[20:23], v3 offset:5120
v_mfma_f32_16x16x32_bf16 v[188:191], a[44:47], v[92:95], v[188:191]
v_exp_f32 v51, v51
v_mfma_f32_16x16x32_bf16 v[192:195], a[48:51], v[80:83], v[192:195]
v_cvt_pk_bf16_f32 v67, v50, v51
ds_read_b128 a[24:27], v3 offset:6144
v_mfma_f32_16x16x32_bf16 v[196:199], a[48:51], v[84:87], v[196:199]
v_exp_f32 v52, v52
v_mfma_f32_16x16x32_bf16 v[200:203], a[48:51], v[88:91], v[200:203]
ds_read_b128 a[28:31], v3 offset:7168
v_mfma_f32_16x16x32_bf16 v[204:207], a[48:51], v[92:95], v[204:207]
v_exp_f32 v53, v53
v_mfma_f32_16x16x32_bf16 v[208:211], a[52:55], v[80:83], v[208:211]
v_cvt_pk_bf16_f32 v70, v52, v53
v_mfma_f32_16x16x32_bf16 v[212:215], a[52:55], v[84:87], v[212:215]
v_exp_f32 v54, v54
v_mfma_f32_16x16x32_bf16 v[216:219], a[52:55], v[88:91], v[216:219]
v_mfma_f32_16x16x32_bf16 v[220:223], a[52:55], v[92:95], v[220:223]
v_exp_f32 v55, v55
v_mfma_f32_16x16x32_bf16 v[224:227], a[56:59], v[80:83], v[224:227]
v_cvt_pk_bf16_f32 v71, v54, v55
v_mfma_f32_16x16x32_bf16 v[228:231], a[56:59], v[84:87], v[228:231]
v_mfma_f32_16x16x32_bf16 v[232:235], a[56:59], v[88:91], v[232:235]
v_mfma_f32_16x16x32_bf16 v[236:239], a[56:59], v[92:95], v[236:239]
v_mfma_f32_16x16x32_bf16 v[240:243], a[60:63], v[80:83], v[240:243]
v_mfma_f32_16x16x32_bf16 v[244:247], a[60:63], v[84:87], v[244:247]
v_mfma_f32_16x16x32_bf16 v[248:251], a[60:63], v[88:91], v[248:251]
s_waitcnt lgkmcnt(0)
v_mfma_f32_16x16x32_bf16 v[252:255], a[60:63], v[92:95], v[252:255]
s_cmp_lt_u32 s44, s45
s_cbranch_scc1 L_l1_KN
s_cmp_ge_u32 s44, 32
s_cbranch_scc1 L_tail_KN
.p2align 6
L_l2_KN:
s_bitcmp1_b64 s[50:51], s44
s_cbranch_scc1 L_stub2_KN
L_back2_KN:
v_mfma_f32_16x16x32_bf16 v[32:35], a[0:3], a[64:67], v[96:99]
v_exp_f32 v56, v56
v_mfma_f32_16x16x32_bf16 v[36:39], a[0:3], a[80:83], v[100:103]
ds_read_b128 a[32:35], v2 offset:8192
ds_read_b128 a[36:39], v2 offset:9216
v_mfma_f32_16x16x32_bf16 v[40:43], a[0:3], a[96:99], v[104:107]
v_exp_f32 v57, v57
v_mfma_f32_16x16x32_bf16 v[44:47], a[0:3], a[112:115], v[108:111]
ds_read_b128 a[40:43], v2 offset:10240
ds_read_b128 a[44:47], v2 offset:11264
v_mfma_f32_16x16x32_bf16 v[32:35], a[4:7], a[68:71], v[32:35]
v_exp_f32 v58, v58
v_mfma_f32_16x16x32_bf16 v[36:39], a[4:7], a[84:87], v[36:39]
ds_read_b128 a[48:51], v2 offset:12288
ds_read_b128 a[52:55], v2 offset:13312
v_mfma_f32_16x16x32_bf16 v[40:43], a[4:7], a[100:103], v[40:43]
v_exp_f32 v59, v59
v_mfma_f32_16x16x32_bf16 v[44:47], a[4:7], a[116:119], v[44:47]
ds_read_b128 a[56:59], v2 offset:14336
ds_read_b128 a[60:63], v2 offset:15360
v_mfma_f32_16x16x32_bf16 v[32:35], a[8:11], a[72:75], v[32:35]
v_exp_f32 v60, v60
v_mfma_f32_16x16x32_bf16 v[36:39], a[8:11], a[88:91], v[36:39]
v_cvt_pk_bf16_f32 v74, v56, v57
v_cvt_pk_bf16_f32 v75, v58, v59
v_mfma_f32_16x16x32_bf16 v[40:43], a[8:11], a[104:107], v[40:43]
v_exp_f32 v61, v61
v_mfma_f32_16x16x32_bf16 v[44:47], a[8:11], a[120:123], v[44:47]
v_cvt_pk_bf16_f32 v78, v60, v61
v_mfma_f32_16x16x32_bf16 v[32:35], a[12:15], a[76:79], v[32:35]
v_exp_f32 v62, v62
v_mfma_f32_16x16x32_bf16 v[36:39], a[12:15], a[92:95], v[36:39]
v_mfma_f32_16x16x32_bf16 v[40:43], a[12:15], a[108:111], v[40:43]
v_exp_f32 v63, v63
v_mfma_f32_16x16x32_bf16 v[44:47], a[12:15], a[124:127], v[44:47]
v_cvt_pk_bf16_f32 v79, v62, v63
v_mfma_f32_16x16x32_bf16 v[48:51], a[16:19], a[64:67], v[112:115]
v_mfma_f32_16x16x32_bf16 v[52:55], a[16:19], a[80:83], v[116:119]
v_exp_f32 v32, v32
v_mfma_f32_16x16x32_bf16 v[56:59], a[16:19], a[96:99], v[120:123]
v_exp_f32 v33, v33
v_mfma_f32_16x16x32_bf16 v[60:63], a[16:19], a[112:115], v[124:127]
s_add_u32 s47, s47, 32768
s_and_b32 s48, s47, 0x1ffff
v_mfma_f32_16x16x32_bf16 v[48:51], a[20:23], a[68:71], v[48:51]
v_exp_f32 v34, v34
v_mfma_f32_16x16x32_bf16 v[52:55], a[20:23], a[84:87], v[52:55]
v_exp_f32 v35, v35
v_mfma_f32_16x16x32_bf16 v[56:59], a[20:23], a[100:103], v[56:59]
v_cvt_pk_bf16_f32 v80, v32, v33
v_cvt_pk_bf16_f32 v81, v34, v35
v_mfma_f32_16x16x32_bf16 v[60:63], a[20:23], a[116:119], v[60:63]
v_exp_f32 v36, v36
v_mfma_f32_16x16x32_bf16 v[48:51], a[24:27], a[72:75], v[48:51]
v_exp_f32 v37, v37
v_mfma_f32_16x16x32_bf16 v[52:55], a[24:27], a[88:91], v[52:55]
v_add_u32 v2, s48, v21
s_add_u32 s44, s44, 1
v_mfma_f32_16x16x32_bf16 v[56:59], a[24:27], a[104:107], v[56:59]
v_exp_f32 v38, v38
v_mfma_f32_16x16x32_bf16 v[60:63], a[24:27], a[120:123], v[60:63]
v_exp_f32 v39, v39
v_mfma_f32_16x16x32_bf16 v[48:51], a[28:31], a[76:79], v[48:51]
v_cvt_pk_bf16_f32 v84, v36, v37
v_cvt_pk_bf16_f32 v85, v38, v39
v_mfma_f32_16x16x32_bf16 v[52:55], a[28:31], a[92:95], v[52:55]
v_exp_f32 v40, v40
v_mfma_f32_16x16x32_bf16 v[56:59], a[28:31], a[108:111], v[56:59]
v_exp_f32 v41, v41
v_mfma_f32_16x16x32_bf16 v[60:63], a[28:31], a[124:127], v[60:63]
s_waitcnt vmcnt(16) lgkmcnt(0)
s_barrier
v_mfma_f32_16x16x32_bf16 a[128:131], a[144:147], v[64:67], a[128:131]
v_cvt_pk_bf16_f32 v88, v40, v41
s_add_u32 m0, m0, 16384
v_mfma_f32_16x16x32_bf16 a[132:135], a[144:147], v[68:71], a[132:135]
v_exp_f32 v42, v42
v_mfma_f32_16x16x32_bf16 a[136:139], a[144:147], v[72:75], a[136:139]
s_and_b32 m0, m0, 0x1ffff
s_add_u32 s49, s49, 8192
v_mfma_f32_16x16x32_bf16 a[140:143], a[144:147], v[76:79], a[140:143]
v_exp_f32 v43, v43
v_mfma_f32_16x16x32_bf16 v[128:131], a[32:35], v[64:67], v[128:131]
v_cvt_pk_bf16_f32 v89, v42, v43
ds_read_b128 a[0:3], v2 offset:0
v_mfma_f32_16x16x32_bf16 v[132:135], a[32:35], v[68:71], v[132:135]
v_exp_f32 v44, v44
v_mfma_f32_16x16x32_bf16 v[136:139], a[32:35], v[72:75], v[136:139]
buffer_load_dwordx4 v21, s[28:31], s49 offen offset:0 lds
ds_read_b128 a[4:7], v2 offset:1024
v_mfma_f32_16x16x32_bf16 v[140:143], a[32:35], v[76:79], v[140:143]
v_exp_f32 v45, v45
v_mfma_f32_16x16x32_bf16 v[144:147], a[36:39], v[64:67], v[144:147]
v_cvt_pk_bf16_f32 v92, v44, v45
buffer_load_dwordx4 v21, s[28:31], s49 offen offset:1024 lds
v_mfma_f32_16x16x32_bf16 v[148:151], a[36:39], v[68:71], v[148:151]
v_exp_f32 v46, v46
v_mfma_f32_16x16x32_bf16 v[152:155], a[36:39], v[72:75], v[152:155]
ds_read_b128 a[8:11], v2 offset:2048
buffer_load_dwordx4 v21, s[28:31], s49 offen offset:2048 lds
v_mfma_f32_16x16x32_bf16 v[156:159], a[36:39], v[76:79], v[156:159]
v_exp_f32 v47, v47
v_mfma_f32_16x16x32_bf16 v[160:163], a[40:43], v[64:67], v[160:163]
v_cvt_pk_bf16_f32 v93, v46, v47
ds_read_b128 a[12:15], v2 offset:3072
v_mfma_f32_16x16x32_bf16 v[164:167], a[40:43], v[68:71], v[164:167]
v_exp_f32 v48, v48
v_mfma_f32_16x16x32_bf16 v[168:171], a[40:43], v[72:75], v[168:171]
buffer_load_dwordx4 v21, s[28:31], s49 offen offset:3072 lds
s_add_u32 m0, m0, 16384
v_mfma_f32_16x16x32_bf16 v[172:175], a[40:43], v[76:79], v[172:175]
v_exp_f32 v49, v49
v_mfma_f32_16x16x32_bf16 v[176:179], a[44:47], v[64:67], v[176:179]
v_cvt_pk_bf16_f32 v82, v48, v49
s_and_b32 m0, m0, 0x1ffff
v_mfma_f32_16x16x32_bf16 v[180:183], a[44:47], v[68:71], v[180:183]
v_exp_f32 v50, v50
v_mfma_f32_16x16x32_bf16 v[184:187], a[44:47], v[72:75], v[184:187]
ds_read_b128 a[16:19], v2 offset:4096
s_add_u32 s49, s49, 8192
v_mfma_f32_16x16x32_bf16 v[188:191], a[44:47], v[76:79], v[188:191]
v_exp_f32 v51, v51
v_mfma_f32_16x16x32_bf16 v[192:195], a[48:51], v[64:67], v[192:195]
v_cvt_pk_bf16_f32 v83, v50, v51
ds_read_b128 a[20:23], v2 offset:5120
v_mfma_f32_16x16x32_bf16 v[196:199], a[48:51], v[68:71], v[196:199]
v_exp_f32 v52, v52
v_mfma_f32_16x16x32_bf16 v[200:203], a[48:51], v[72:75], v[200:203]
buffer_load_dwordx4 v21, s[28:31], s49 offen offset:0 lds
ds_read_b128 a[24:27], v2 offset:6144
v_mfma_f32_16x16x32_bf16 v[204:207], a[48:51], v[76:79], v[204:207]
v_exp_f32 v53, v53
v_mfma_f32_16x16x32_bf16 v[208:211], a[52:55], v[64:67], v[208:211]
v_cvt_pk_bf16_f32 v86, v52, v53
buffer_load_dwordx4 v21, s[28:31], s49 offen offset:1024 lds
v_mfma_f32_16x16x32_bf16 v[212:215], a[52:55], v[68:71], v[212:215]
v_exp_f32 v54, v54
v_mfma_f32_16x16x32_bf16 v[216:219], a[52:55], v[72:75], v[216:219]
ds_read_b128 a[28:31], v2 offset:7168
buffer_load_dwordx4 v21, s[28:31], s49 offen offset:2048 lds
v_mfma_f32_16x16x32_bf16 v[220:223], a[52:55], v[76:79], v[220:223]
v_exp_f32 v55, v55
v_mfma_f32_16x16x32_bf16 v[224:227], a[56:59], v[64:67], v[224:227]
v_cvt_pk_bf16_f32 v87, v54, v55
buffer_load_dwordx4 v21, s[28:31], s49 offen offset:3072 lds
v_mfma_f32_16x16x32_bf16 v[228:231], a[56:59], v[68:71], v[228:231]
v_mfma_f32_16x16x32_bf16 v[232:235], a[56:59], v[72:75], v[232:235]
v_mfma_f32_16x16x32_bf16 v[236:239], a[56:59], v[76:79], v[236:239]
v_mfma_f32_16x16x32_bf16 v[240:243], a[60:63], v[64:67], v[240:243]
v_mfma_f32_16x16x32_bf16 v[244:247], a[60:63], v[68:71], v[244:247]
v_mfma_f32_16x16x32_bf16 v[248:251], a[60:63], v[72:75], v[248:251]
s_waitcnt lgkmcnt(0)
v_mfma_f32_16x16x32_bf16 v[252:255], a[60:63], v[76:79], v[252:255]
s_bitcmp1_b64 s[50:51], s44
s_cbranch_scc1 L_stub3_KN
L_back3_KN:
v_mfma_f32_16x16x32_bf16 v[32:35], a[0:3], a[64:67], v[96:99]
v_exp_f32 v56, v56
v_mfma_f32_16x16x32_bf16 v[36:39], a[0:3], a[80:83], v[100:103]
ds_read_b128 a[32:35], v3 offset:8192
ds_read_b128 a[36:39], v3 offset:9216
v_mfma_f32_16x16x32_bf16 v[40:43], a[0:3], a[96:99], v[104:107]
v_exp_f32 v57, v57
v_mfma_f32_16x16x32_bf16 v[44:47], a[0:3], a[112:115], v[108:111]
ds_read_b128 a[40:43], v3 offset:10240
ds_read_b128 a[44:47], v3 offset:11264
v_mfma_f32_16x16x32_bf16 v[32:35], a[4:7], a[68:71], v[32:35]
v_exp_f32 v58, v58
v_mfma_f32_16x16x32_bf16 v[36:39], a[4:7], a[84:87], v[36:39]
ds_read_b128 a[48:51], v3 offset:12288
ds_read_b128 a[52:55], v3 offset:13312
v_mfma_f32_16x16x32_bf16 v[40:43], a[4:7], a[100:103], v[40:43]
v_exp_f32 v59, v59
v_mfma_f32_16x16x32_bf16 v[44:47], a[4:7], a[116:119], v[44:47]
ds_read_b128 a[56:59], v3 offset:14336
ds_read_b128 a[60:63], v3 offset:15360
v_mfma_f32_16x16x32_bf16 v[32:35], a[8:11], a[72:75], v[32:35]
v_exp_f32 v60, v60
v_mfma_f32_16x16x32_bf16 v[36:39], a[8:11], a[88:91], v[36:39]
v_cvt_pk_bf16_f32 v90, v56, v57
v_cvt_pk_bf16_f32 v91, v58, v59
v_mfma_f32_16x16x32_bf16 v[40:43], a[8:11], a[104:107], v[40:43]
v_exp_f32 v61, v61
v_mfma_f32_16x16x32_bf16 v[44:47], a[8:11], a[120:123], v[44:47]
v_cvt_pk_bf16_f32 v94, v60, v61
v_mfma_f32_16x16x32_bf16 v[32:35], a[12:15], a[76:79], v[32:35]
v_exp_f32 v62, v62
v_mfma_f32_16x16x32_bf16 v[36:39], a[12:15], a[92:95], v[36:39]
v_mfma_f32_16x16x32_bf16 v[40:43], a[12:15], a[108:111], v[40:43]
v_exp_f32 v63, v63
v_mfma_f32_16x16x32_bf16 v[44:47], a[12:15], a[124:127], v[44:47]
v_cvt_pk_bf16_f32 v95, v62, v63
v_mfma_f32_16x16x32_bf16 v[48:51], a[16:19], a[64:67], v[112:115]
v_mfma_f32_16x16x32_bf16 v[52:55], a[16:19], a[80:83], v[116:119]
v_exp_f32 v32, v32
v_mfma_f32_16x16x32_bf16 v[56:59], a[16:19], a[96:99], v[120:123]
v_exp_f32 v33, v33
v_mfma_f32_16x16x32_bf16 v[60:63], a[16:19], a[112:115], v[124:127]
s_add_u32 s47, s47, 32768
s_and_b32 s48, s47, 0x1ffff
v_mfma_f32_16x16x32_bf16 v[48:51], a[20:23], a[68:71], v[48:51]
v_exp_f32 v34, v34
v_mfma_f32_16x16x32_bf16 v[52:55], a[20:23], a[84:87], v[52:55]
v_exp_f32 v35, v35
v_mfma_f32_16x16x32_bf16 v[56:59], a[20:23], a[100:103], v[56:59]
v_cvt_pk_bf16_f32 v64, v32, v33
v_cvt_pk_bf16_f32 v65, v34, v35
v_mfma_f32_16x16x32_bf16 v[60:63], a[20:23], a[116:119], v[60:63]
v_exp_f32 v36, v36
v_mfma_f32_16x16x32_bf16 v[48:51], a[24:27], a[72:75], v[48:51]
v_exp_f32 v37, v37
v_mfma_f32_16x16x32_bf16 v[52:55], a[24:27], a[88:91], v[52:55]
v_add_u32 v3, s48, v21
s_add_u32 s44, s44, 1
v_mfma_f32_16x16x32_bf16 v[56:59], a[24:27], a[104:107], v[56:59]
v_exp_f32 v38, v38
v_mfma_f32_16x16x32_bf16 v[60:63], a[24:27], a[120:123], v[60:63]
v_exp_f32 v39, v39
v_mfma_f32_16x16x32_bf16 v[48:51], a[28:31], a[76:79], v[48:51]
v_cvt_pk_bf16_f32 v68, v36, v37
v_cvt_pk_bf16_f32 v69, v38, v39
v_mfma_f32_16x16x32_bf16 v[52:55], a[28:31], a[92:95], v[52:55]
v_exp_f32 v40, v40
v_mfma_f32_16x16x32_bf16 v[56:59], a[28:31], a[108:111], v[56:59]
v_exp_f32 v41, v41
v_mfma_f32_16x16x32_bf16 v[60:63], a[28:31], a[124:127], v[60:63]
s_waitcnt vmcnt(16) lgkmcnt(0)
s_barrier
v_mfma_f32_16x16x32_bf16 a[128:131], a[144:147], v[80:83], a[128:131]
v_cvt_pk_bf16_f32 v72, v40, v41
s_add_u32 m0, m0, 16384
v_mfma_f32_16x16x32_bf16 a[132:135], a[144:147], v[84:87], a[132:135]
v_exp_f32 v42, v42
v_mfma_f32_16x16x32_bf16 a[136:139], a[144:147], v[88:91], a[136:139]
s_and_b32 m0, m0, 0x1ffff
s_add_u32 s49, s49, 8192
v_mfma_f32_16x16x32_bf16 a[140:143], a[144:147], v[92:95], a[140:143]
v_exp_f32 v43, v43
v_mfma_f32_16x16x32_bf16 v[128:131], a[32:35], v[80:83], v[128:131]
v_cvt_pk_bf16_f32 v73, v42, v43
ds_read_b128 a[0:3], v3 offset:0
v_mfma_f32_16x16x32_bf16 v[132:135], a[32:35], v[84:87], v[132:135]
v_exp_f32 v44, v44
v_mfma_f32_16x16x32_bf16 v[136:139], a[32:35], v[88:91], v[136:139]
buffer_load_dwordx4 v21, s[28:31], s49 offen offset:0 lds
ds_read_b128 a[4:7], v3 offset:1024
v_mfma_f32_16x16x32_bf16 v[140:143], a[32:35], v[92:95], v[140:143]
v_exp_f32 v45, v45
v_mfma_f32_16x16x32_bf16 v[144:147], a[36:39], v[80:83], v[144:147]
v_cvt_pk_bf16_f32 v76, v44, v45
buffer_load_dwordx4 v21, s[28:31], s49 offen offset:1024 lds
v_mfma_f32_16x16x32_bf16 v[148:151], a[36:39], v[84:87], v[148:151]
v_exp_f32 v46, v46
v_mfma_f32_16x16x32_bf16 v[152:155], a[36:39], v[88:91], v[152:155]
ds_read_b128 a[8:11], v3 offset:2048
buffer_load_dwordx4 v21, s[28:31], s49 offen offset:2048 lds
v_mfma_f32_16x16x32_bf16 v[156:159], a[36:39], v[92:95], v[156:159]
v_exp_f32 v47, v47
v_mfma_f32_16x16x32_bf16 v[160:163], a[40:43], v[80:83], v[160:163]
v_cvt_pk_bf16_f32 v77, v46, v47
ds_read_b128 a[12:15], v3 offset:3072
v_mfma_f32_16x16x32_bf16 v[164:167], a[40:43], v[84:87], v[164:167]
v_exp_f32 v48, v48
v_mfma_f32_16x16x32_bf16 v[168:171], a[40:43], v[88:91], v[168:171]
buffer_load_dwordx4 v21, s[28:31], s49 offen offset:3072 lds
s_add_u32 m0, m0, 16384
v_mfma_f32_16x16x32_bf16 v[172:175], a[40:43], v[92:95], v[172:175]
v_exp_f32 v49, v49
v_mfma_f32_16x16x32_bf16 v[176:179], a[44:47], v[80:83], v[176:179]
v_cvt_pk_bf16_f32 v66, v48, v49
s_and_b32 m0, m0, 0x1ffff
v_mfma_f32_16x16x32_bf16 v[180:183], a[44:47], v[84:87], v[180:183]
v_exp_f32 v50, v50
v_mfma_f32_16x16x32_bf16 v[184:187], a[44:47], v[88:91], v[184:187]
ds_read_b128 a[16:19], v3 offset:4096
s_add_u32 s49, s49, 8192
v_mfma_f32_16x16x32_bf16 v[188:191], a[44:47], v[92:95], v[188:191]
v_exp_f32 v51, v51
v_mfma_f32_16x16x32_bf16 v[192:195], a[48:51], v[80:83], v[192:195]
v_cvt_pk_bf16_f32 v67, v50, v51
ds_read_b128 a[20:23], v3 offset:5120
v_mfma_f32_16x16x32_bf16 v[196:199], a[48:51], v[84:87], v[196:199]
v_exp_f32 v52, v52
v_mfma_f32_16x16x32_bf16 v[200:203], a[48:51], v[88:91], v[200:203]
buffer_load_dwordx4 v21, s[28:31], s49 offen offset:0 lds
ds_read_b128 a[24:27], v3 offset:6144
v_mfma_f32_16x16x32_bf16 v[204:207], a[48:51], v[92:95], v[204:207]
v_exp_f32 v53, v53
v_mfma_f32_16x16x32_bf16 v[208:211], a[52:55], v[80:83], v[208:211]
v_cvt_pk_bf16_f32 v70, v52, v53
buffer_load_dwordx4 v21, s[28:31], s49 offen offset:1024 lds
v_mfma_f32_16x16x32_bf16 v[212:215], a[52:55], v[84:87], v[212:215]
v_exp_f32 v54, v54
v_mfma_f32_16x16x32_bf16 v[216:219], a[52:55], v[88:91], v[216:219]
ds_read_b128 a[28:31], v3 offset:7168
buffer_load_dwordx4 v21, s[28:31], s49 offen offset:2048 lds
v_mfma_f32_16x16x32_bf16 v[220:223], a[52:55], v[92:95], v[220:223]
v_exp_f32 v55, v55
v_mfma_f32_16x16x32_bf16 v[224:227], a[56:59], v[80:83], v[224:227]
v_cvt_pk_bf16_f32 v71, v54, v55
buffer_load_dwordx4 v21, s[28:31], s49 offen offset:3072 lds
v_mfma_f32_16x16x32_bf16 v[228:231], a[56:59], v[84:87], v[228:231]
v_mfma_f32_16x16x32_bf16 v[232:235], a[56:59], v[88:91], v[232:235]
v_mfma_f32_16x16x32_bf16 v[236:239], a[56:59], v[92:95], v[236:239]
v_mfma_f32_16x16x32_bf16 v[240:243], a[60:63], v[80:83], v[240:243]
v_mfma_f32_16x16x32_bf16 v[244:247], a[60:63], v[84:87], v[244:247]
v_mfma_f32_16x16x32_bf16 v[248:251], a[60:63], v[88:91], v[248:251]
s_waitcnt lgkmcnt(0)
v_mfma_f32_16x16x32_bf16 v[252:255], a[60:63], v[92:95], v[252:255]
s_cmp_lt_u32 s44, 32
s_cbranch_scc1 L_l2_KN
L_tail_KN:
s_waitcnt vmcnt(4)
v_cmp_eq_u32 vcc, 0, v24
s_and_b32 s48, vcc_hi, 0xff
s_or_b32 s48, s48, vcc_lo
s_cbranch_scc1 L_wstub_KN
L_wback_KN:
L_pback2_KN:
s_bitcmp1_b64 s[50:51], s44
s_cbranch_scc1 L_stub4_KN
L_back4_KN:
buffer_load_dwordx4 v[24:27], v21, s[36:39], s16 offen sc0 sc1
s_getpc_b64 s[64:65]
L_pc2_KN:
s_lshl_b32 s48, s42, 12
v_lshl_add_u32 v29, v0, 6, s48
v_min_u32 v29, L_last_KN-L_pc2_KN-2052, v29
global_load_dword v29, v29, s[64:65] offset:2048
buffer_load_dwordx4 a[160:163], v21, s[36:39], s100 offen offset:0
buffer_load_dwordx4 a[164:167], v21, s[36:39], s100 offen offset:1024
buffer_load_dwordx4 a[168:171], v21, s[36:39], s100 offen offset:2048
buffer_load_dwordx4 a[172:175], v21, s[36:39], s100 offen offset:3072
s_add_u32 s100, s100, 4096
buffer_load_dwordx4 a[176:179], v21, s[36:39], s100 offen offset:0
buffer_load_dwordx4 a[180:183], v21, s[36:39], s100 offen offset:1024
buffer_load_dwordx4 a[184:187], v21, s[36:39], s100 offen offset:2048
buffer_load_dwordx4 a[188:191], v21, s[36:39], s100 offen offset:3072
s_add_u32 s100, s100, 4096
buffer_load_dwordx4 a[192:195], v21, s[36:39], s100 offen offset:0
buffer_load_dwordx4 a[196:199], v21, s[36:39], s100 offen offset:1024
buffer_load_dwordx4 a[200:203], v21, s[36:39], s100 offen offset:2048
buffer_load_dwordx4 a[204:207], v21, s[36:39], s100 offen offset:3072
s_add_u32 s100, s100, 4096
buffer_load_dwordx4 a[208:211], v21, s[36:39], s100 offen offset:0
buffer_load_dwordx4 a[212:215], v21, s[36:39], s100 offen offset:1024
buffer_load_dwordx4 a[216:219], v21, s[36:39], s100 offen offset:2048
buffer_load_dwordx4 a[220:223], v21, s[36:39], s100 offen offset:3072
s_add_u32 s100, s100, 4096
buffer_load_dwordx4 a[224:227], v21, s[36:39], s100 offen offset:0
buffer_load_dwordx4 a[228:231], v21, s[36:39], s100 offen offset:1024
buffer_load_dwordx4 a[232:235], v21, s[36:39], s100 offen offset:2048
buffer_load_dwordx4 a[236:239], v21, s[36:39], s100 offen offset:3072
s_add_u32 s100, s100, 4096
buffer_load_dwordx4 a[240:243], v21, s[36:39], s100 offen offset:0
buffer_load_dwordx4 a[244:247], v21, s[36:39], s100 offen offset:1024
buffer_load_dwordx4 a[248:251], v21, s[36:39], s100 offen offset:2048
buffer_load_dwordx4 a[252:255], v21, s[36:39], s100 offen offset:3072
s_add_u32 s100, s100, 4096
v_mfma_f32_16x16x32_bf16 v[32:35], a[0:3], a[64:67], v[96:99]
v_exp_f32 v56, v56
v_mfma_f32_16x16x32_bf16 v[36:39], a[0:3], a[80:83], v[100:103]
ds_read_b128 a[32:35], v2 offset:8192
ds_read_b128 a[36:39], v2 offset:9216
v_mfma_f32_16x16x32_bf16 v[40:43], a[0:3], a[96:99], v[104:107]
v_exp_f32 v57, v57
v_mfma_f32_16x16x32_bf16 v[44:47], a[0:3], a[112:115], v[108:111]
ds_read_b128 a[40:43], v2 offset:10240
ds_read_b128 a[44:47], v2 offset:11264
v_mfma_f32_16x16x32_bf16 v[32:35], a[4:7], a[68:71], v[32:35]
v_exp_f32 v58, v58
v_mfma_f32_16x16x32_bf16 v[36:39], a[4:7], a[84:87], v[36:39]
ds_read_b128 a[48:51], v2 offset:12288
ds_read_b128 a[52:55], v2 offset:13312
v_mfma_f32_16x16x32_bf16 v[40:43], a[4:7], a[100:103], v[40:43]
v_exp_f32 v59, v59
v_mfma_f32_16x16x32_bf16 v[44:47], a[4:7], a[116:119], v[44:47]
ds_read_b128 a[56:59], v2 offset:14336
ds_read_b128 a[60:63], v2 offset:15360
v_mfma_f32_16x16x32_bf16 v[32:35], a[8:11], a[72:75], v[32:35]
v_exp_f32 v60, v60
v_mfma_f32_16x16x32_bf16 v[36:39], a[8:11], a[88:91], v[36:39]
v_cvt_pk_bf16_f32 v74, v56, v57
v_cvt_pk_bf16_f32 v75, v58, v59
v_mfma_f32_16x16x32_bf16 v[40:43], a[8:11], a[104:107], v[40:43]
v_exp_f32 v61, v61
v_mfma_f32_16x16x32_bf16 v[44:47], a[8:11], a[120:123], v[44:47]
v_cvt_pk_bf16_f32 v78, v60, v61
v_mfma_f32_16x16x32_bf16 v[32:35], a[12:15], a[76:79], v[32:35]
v_exp_f32 v62, v62
v_mfma_f32_16x16x32_bf16 v[36:39], a[12:15], a[92:95], v[36:39]
v_mfma_f32_16x16x32_bf16 v[40:43], a[12:15], a[108:111], v[40:43]
v_exp_f32 v63, v63
v_mfma_f32_16x16x32_bf16 v[44:47], a[12:15], a[124:127], v[44:47]
v_cvt_pk_bf16_f32 v79, v62, v63
v_mfma_f32_16x16x32_bf16 v[48:51], a[16:19], a[64:67], v[112:115]
v_mfma_f32_16x16x32_bf16 v[52:55], a[16:19], a[80:83], v[116:119]
v_exp_f32 v32, v32
v_mfma_f32_16x16x32_bf16 v[56:59], a[16:19], a[96:99], v[120:123]
v_exp_f32 v33, v33
v_mfma_f32_16x16x32_bf16 v[60:63], a[16:19], a[112:115], v[124:127]
s_add_u32 s47, s47, 32768
s_and_b32 s48, s47, 0x1ffff
v_mfma_f32_16x16x32_bf16 v[48:51], a[20:23], a[68:71], v[48:51]
v_exp_f32 v34, v34
v_mfma_f32_16x16x32_bf16 v[52:55], a[20:23], a[84:87], v[52:55]
v_exp_f32 v35, v35
v_mfma_f32_16x16x32_bf16 v[56:59], a[20:23], a[100:103], v[56:59]
v_cvt_pk_bf16_f32 v80, v32, v33
v_cvt_pk_bf16_f32 v81, v34, v35
v_mfma_f32_16x16x32_bf16 v[60:63], a[20:23], a[116:119], v[60:63]
v_exp_f32 v36, v36
v_mfma_f32_16x16x32_bf16 v[48:51], a[24:27], a[72:75], v[48:51]
v_exp_f32 v37, v37
v_mfma_f32_16x16x32_bf16 v[52:55], a[24:27], a[88:91], v[52:55]
v_add_u32 v2, s48, v21
s_add_u32 s44, s44, 1
v_mfma_f32_16x16x32_bf16 v[56:59], a[24:27], a[104:107], v[56:59]
v_exp_f32 v38, v38
v_mfma_f32_16x16x32_bf16 v[60:63], a[24:27], a[120:123], v[60:63]
v_exp_f32 v39, v39
v_mfma_f32_16x16x32_bf16 v[48:51], a[28:31], a[76:79], v[48:51]
v_cvt_pk_bf16_f32 v84, v36, v37
v_cvt_pk_bf16_f32 v85, v38, v39
v_mfma_f32_16x16x32_bf16 v[52:55], a[28:31], a[92:95], v[52:55]
v_exp_f32 v40, v40
v_mfma_f32_16x16x32_bf16 v[56:59], a[28:31], a[108:111], v[56:59]
v_exp_f32 v41, v41
v_mfma_f32_16x16x32_bf16 v[60:63], a[28:31], a[124:127], v[60:63]
s_waitcnt vmcnt(26) lgkmcnt(0)
s_barrier
v_mfma_f32_16x16x32_bf16 a[128:131], a[144:147], v[64:67], a[128:131]
v_cvt_pk_bf16_f32 v88, v40, v41
global_load_dword v96, v23, s[12:13] offset:-4096
v_mfma_f32_16x16x32_bf16 a[132:135], a[144:147], v[68:71], a[132:135]
v_exp_f32 v42, v42
v_mfma_f32_16x16x32_bf16 a[136:139], a[144:147], v[72:75], a[136:139]
global_load_dword v97, v23, s[12:13] offset:-3072
global_load_dword v98, v23, s[12:13] offset:-2048
v_mfma_f32_16x16x32_bf16 a[140:143], a[144:147], v[76:79], a[140:143]
v_exp_f32 v43, v43
v_mfma_f32_16x16x32_bf16 v[128:131], a[32:35], v[64:67], v[128:131]
v_cvt_pk_bf16_f32 v89, v42, v43
global_load_dword v99, v23, s[12:13] offset:-1024
v_mfma_f32_16x16x32_bf16 v[132:135], a[32:35], v[68:71], v[132:135]
v_exp_f32 v44, v44
v_mfma_f32_16x16x32_bf16 v[136:139], a[32:35], v[72:75], v[136:139]
global_load_dword v100, v23, s[12:13] offset:0
global_load_dword v101, v23, s[12:13] offset:1024
v_mfma_f32_16x16x32_bf16 v[140:143], a[32:35], v[76:79], v[140:143]
v_exp_f32 v45, v45
v_mfma_f32_16x16x32_bf16 v[144:147], a[36:39], v[64:67], v[144:147]
v_cvt_pk_bf16_f32 v92, v44, v45
global_load_dword v102, v23, s[12:13] offset:2048
v_mfma_f32_16x16x32_bf16 v[148:151], a[36:39], v[68:71], v[148:151]
v_exp_f32 v46, v46
v_mfma_f32_16x16x32_bf16 v[152:155], a[36:39], v[72:75], v[152:155]
global_load_dword v103, v23, s[12:13] offset:3072
v_mfma_f32_16x16x32_bf16 v[156:159], a[36:39], v[76:79], v[156:159]
v_exp_f32 v47, v47
v_mfma_f32_16x16x32_bf16 v[160:163], a[40:43], v[64:67], v[160:163]
v_cvt_pk_bf16_f32 v93, v46, v47
v_mfma_f32_16x16x32_bf16 v[164:167], a[40:43], v[68:71], v[164:167]
v_exp_f32 v48, v48
v_mfma_f32_16x16x32_bf16 v[168:171], a[40:43], v[72:75], v[168:171]
v_mfma_f32_16x16x32_bf16 v[172:175], a[40:43], v[76:79], v[172:175]
v_exp_f32 v49, v49
v_mfma_f32_16x16x32_bf16 v[176:179], a[44:47], v[64:67], v[176:179]
v_cvt_pk_bf16_f32 v82, v48, v49
v_mfma_f32_16x16x32_bf16 v[180:183], a[44:47], v[68:71], v[180:183]
v_exp_f32 v50, v50
v_mfma_f32_16x16x32_bf16 v[184:187], a[44:47], v[72:75], v[184:187]
v_mfma_f32_16x16x32_bf16 v[188:191], a[44:47], v[76:79], v[188:191]
v_exp_f32 v51, v51
v_mfma_f32_16x16x32_bf16 v[192:195], a[48:51], v[64:67], v[192:195]
v_cvt_pk_bf16_f32 v83, v50, v51
v_mfma_f32_16x16x32_bf16 v[196:199], a[48:51], v[68:71], v[196:199]
v_exp_f32 v52, v52
v_mfma_f32_16x16x32_bf16 v[200:203], a[48:51], v[72:75], v[200:203]
v_mfma_f32_16x16x32_bf16 v[204:207], a[48:51], v[76:79], v[204:207]
v_exp_f32 v53, v53
v_mfma_f32_16x16x32_bf16 v[208:211], a[52:55], v[64:67], v[208:211]
v_cvt_pk_bf16_f32 v86, v52, v53
v_mfma_f32_16x16x32_bf16 v[212:215], a[52:55], v[68:71], v[212:215]
v_exp_f32 v54, v54
v_mfma_f32_16x16x32_bf16 v[216:219], a[52:55], v[72:75], v[216:219]
v_mfma_f32_16x16x32_bf16 v[220:223], a[52:55], v[76:79], v[220:223]
v_exp_f32 v55, v55
v_mfma_f32_16x16x32_bf16 v[224:227], a[56:59], v[64:67], v[224:227]
v_cvt_pk_bf16_f32 v87, v54, v55
v_mfma_f32_16x16x32_bf16 v[228:231], a[56:59], v[68:71], v[228:231]
v_mfma_f32_16x16x32_bf16 v[232:235], a[56:59], v[72:75], v[232:235]
v_mfma_f32_16x16x32_bf16 v[236:239], a[56:59], v[76:79], v[236:239]
v_mfma_f32_16x16x32_bf16 v[240:243], a[60:63], v[64:67], v[240:243]
v_mfma_f32_16x16x32_bf16 v[244:247], a[60:63], v[68:71], v[244:247]
v_mfma_f32_16x16x32_bf16 v[248:251], a[60:63], v[72:75], v[248:251]
s_waitcnt lgkmcnt(0)
v_mfma_f32_16x16x32_bf16 v[252:255], a[60:63], v[76:79], v[252:255]
ds_read_b128 a[32:35], v3 offset:8192
ds_read_b128 a[36:39], v3 offset:9216
ds_read_b128 a[40:43], v3 offset:10240
ds_read_b128 a[44:47], v3 offset:11264
ds_read_b128 a[48:51], v3 offset:12288
ds_read_b128 a[52:55], v3 offset:13312
ds_read_b128 a[56:59], v3 offset:14336
ds_read_b128 a[60:63], v3 offset:15360
v_exp_f32 v56, v56
v_exp_f32 v57, v57
v_exp_f32 v58, v58
v_exp_f32 v59, v59
v_exp_f32 v60, v60
v_exp_f32 v61, v61
v_exp_f32 v62, v62
v_exp_f32 v63, v63
v_cvt_pk_bf16_f32 v90, v56, v57
v_cvt_pk_bf16_f32 v91, v58, v59
v_cvt_pk_bf16_f32 v94, v60, v61
v_cvt_pk_bf16_f32 v95, v62, v63
s_waitcnt lgkmcnt(0)
v_mfma_f32_16x16x32_bf16 a[128:131], a[144:147], v[80:83], a[128:131]
buffer_load_dwordx4 a[0:3], v21, s[36:39], s100 offen offset:0
s_waitcnt vmcnt(34)
s_cmp_eq_u64 s[32:33], 0
s_cselect_b32 s17, s101, 1073741824
s_mov_b64 exec, 1
buffer_store_dword v31, v21, s[36:39], s17 offen sc1
s_mov_b64 exec, -1
v_add_f32_dpp v24, v24, v24 row_ror:8 row_mask:0xf bank_mask:0xf
v_add_f32_dpp v25, v25, v25 row_ror:8 row_mask:0xf bank_mask:0xf
v_mfma_f32_16x16x32_bf16 a[132:135], a[144:147], v[84:87], a[132:135]
buffer_load_dwordx4 a[4:7], v21, s[36:39], s100 offen offset:1024
v_add_f32_dpp v26, v26, v26 row_ror:8 row_mask:0xf bank_mask:0xf
v_add_f32_dpp v27, v27, v27 row_ror:8 row_mask:0xf bank_mask:0xf
v_permlane16_swap_b32 v24, v25
v_mfma_f32_16x16x32_bf16 a[136:139], a[144:147], v[88:91], a[136:139]
buffer_load_dwordx4 a[8:11], v21, s[36:39], s100 offen offset:2048
v_permlane16_swap_b32 v26, v27
v_add_f32 v24, v24, v25
v_mfma_f32_16x16x32_bf16 a[140:143], a[144:147], v[92:95], a[140:143]
buffer_load_dwordx4 a[12:15], v21, s[36:39], s100 offen offset:3072
v_add_f32 v26, v26, v27
v_mov_b32 v25, v24
v_mov_b32 v27, v26
v_mfma_f32_16x16x32_bf16 v[128:131], a[32:35], v[80:83], v[128:131]
s_add_u32 s100, s100, 4096
v_permlane32_swap_b32 v24, v25
v_permlane32_swap_b32 v26, v27
v_add_f32 v24, v24, v25
v_mfma_f32_16x16x32_bf16 v[132:135], a[32:35], v[84:87], v[132:135]
v_add_f32 v26, v26, v27
v_cvt_pk_bf16_f32 v24, v24, v24
v_mfma_f32_16x16x32_bf16 v[136:139], a[32:35], v[88:91], v[136:139]
buffer_load_dwordx4 a[16:19], v21, s[36:39], s100 offen offset:0
v_cvt_pk_bf16_f32 v26, v26, v26
v_and_b32 v24, 0xffff0000, v24
v_and_b32 v26, 0xffff0000, v26
v_mfma_f32_16x16x32_bf16 v[140:143], a[32:35], v[92:95], v[140:143]
buffer_load_dwordx4 a[20:23], v21, s[36:39], s100 offen offset:1024
v_mul_f32 v104, 0xbfb8aa3b, v24
v_exp_f32 v104, v104
s_nop 0
v_add_f32 v104, 1.0, v104
v_mfma_f32_16x16x32_bf16 v[144:147], a[36:39], v[80:83], v[144:147]
buffer_load_dwordx4 a[24:27], v21, s[36:39], s100 offen offset:2048
v_rcp_f32 v104, v104
s_nop 0
v_mul_f32 v24, v24, v104
v_mfma_f32_16x16x32_bf16 v[148:151], a[36:39], v[84:87], v[148:151]
buffer_load_dwordx4 a[28:31], v21, s[36:39], s100 offen offset:3072
v_cvt_pk_bf16_f32 v24, v24, v24
v_and_b32 v24, 0xffff0000, v24
v_mul_f32 v24, v24, v26
v_mfma_f32_16x16x32_bf16 v[152:155], a[36:39], v[88:91], v[152:155]
s_add_u32 s100, s100, 4096
v_cvt_pk_bf16_f32 v24, v24, v24
v_and_b32 v24, 0xffff0000, v24
s_waitcnt vmcnt(9)
v_mfma_f32_16x16x32_bf16 v[156:159], a[36:39], v[92:95], v[156:159]
v_readlane_b32 s8, v24, 0
v_readlane_b32 s9, v24, 16
v_mfma_f32_16x16x32_bf16 v[160:163], a[40:43], v[80:83], v[160:163]
buffer_load_dwordx4 a[64:67], v21, s[36:39], s100 offen offset:0
v_lshlrev_b32 v104, 16, v96
v_and_b32 v105, 0xffff0000, v96
v_readlane_b32 s10, v24, 1
v_mfma_f32_16x16x32_bf16 v[164:167], a[40:43], v[84:87], v[164:167]
buffer_load_dwordx4 a[68:71], v21, s[36:39], s100 offen offset:1024
v_readlane_b32 s11, v24, 17
v_mul_f32 v108, s8, v104
v_mul_f32 v109, s8, v105
v_mfma_f32_16x16x32_bf16 v[168:171], a[40:43], v[88:91], v[168:171]
buffer_load_dwordx4 a[72:75], v21, s[36:39], s100 offen offset:2048
v_mul_f32 v110, s9, v104
v_mul_f32 v111, s9, v105
v_mfma_f32_16x16x32_bf16 v[172:175], a[40:43], v[92:95], v[172:175]
buffer_load_dwordx4 a[76:79], v21, s[36:39], s100 offen offset:3072
v_lshlrev_b32 v106, 16, v97
v_and_b32 v107, 0xffff0000, v97
v_readlane_b32 s8, v24, 2
v_mfma_f32_16x16x32_bf16 v[176:179], a[44:47], v[80:83], v[176:179]
s_add_u32 s100, s100, 4096
v_readlane_b32 s9, v24, 18
v_fmac_f32 v108, s10, v106
v_fmac_f32 v109, s10, v107
v_mfma_f32_16x16x32_bf16 v[180:183], a[44:47], v[84:87], v[180:183]
v_fmac_f32 v110, s11, v106
v_fmac_f32 v111, s11, v107
v_mfma_f32_16x16x32_bf16 v[184:187], a[44:47], v[88:91], v[184:187]
buffer_load_dwordx4 a[80:83], v21, s[36:39], s100 offen offset:0
v_lshlrev_b32 v104, 16, v98
v_and_b32 v105, 0xffff0000, v98
v_readlane_b32 s10, v24, 3
v_mfma_f32_16x16x32_bf16 v[188:191], a[44:47], v[92:95], v[188:191]
buffer_load_dwordx4 a[84:87], v21, s[36:39], s100 offen offset:1024
v_readlane_b32 s11, v24, 19
v_fmac_f32 v108, s8, v104
v_fmac_f32 v109, s8, v105
v_mfma_f32_16x16x32_bf16 v[192:195], a[48:51], v[80:83], v[192:195]
buffer_load_dwordx4 a[88:91], v21, s[36:39], s100 offen offset:2048
v_fmac_f32 v110, s9, v104
v_fmac_f32 v111, s9, v105
v_mfma_f32_16x16x32_bf16 v[196:199], a[48:51], v[84:87], v[196:199]
buffer_load_dwordx4 a[92:95], v21, s[36:39], s100 offen offset:3072
v_lshlrev_b32 v106, 16, v99
v_and_b32 v107, 0xffff0000, v99
v_readlane_b32 s8, v24, 4
v_mfma_f32_16x16x32_bf16 v[200:203], a[48:51], v[88:91], v[200:203]
s_add_u32 s100, s100, 4096
v_readlane_b32 s9, v24, 20
v_fmac_f32 v108, s10, v106
v_fmac_f32 v109, s10, v107
v_mfma_f32_16x16x32_bf16 v[204:207], a[48:51], v[92:95], v[204:207]
v_fmac_f32 v110, s11, v106
v_fmac_f32 v111, s11, v107
v_mfma_f32_16x16x32_bf16 v[208:211], a[52:55], v[80:83], v[208:211]
buffer_load_dwordx4 a[96:99], v21, s[36:39], s100 offen offset:0
v_lshlrev_b32 v104, 16, v100
v_and_b32 v105, 0xffff0000, v100
v_readlane_b32 s10, v24, 5
v_mfma_f32_16x16x32_bf16 v[212:215], a[52:55], v[84:87], v[212:215]
buffer_load_dwordx4 a[100:103], v21, s[36:39], s100 offen offset:1024
v_readlane_b32 s11, v24, 21
v_fmac_f32 v108, s8, v104
v_fmac_f32 v109, s8, v105
v_mfma_f32_16x16x32_bf16 v[216:219], a[52:55], v[88:91], v[216:219]
buffer_load_dwordx4 a[104:107], v21, s[36:39], s100 offen offset:2048
v_fmac_f32 v110, s9, v104
v_fmac_f32 v111, s9, v105
v_mfma_f32_16x16x32_bf16 v[220:223], a[52:55], v[92:95], v[220:223]
buffer_load_dwordx4 a[108:111], v21, s[36:39], s100 offen offset:3072
v_lshlrev_b32 v106, 16, v101
v_and_b32 v107, 0xffff0000, v101
v_readlane_b32 s8, v24, 6
v_mfma_f32_16x16x32_bf16 v[224:227], a[56:59], v[80:83], v[224:227]
s_add_u32 s100, s100, 4096
v_readlane_b32 s9, v24, 22
v_fmac_f32 v108, s10, v106
v_fmac_f32 v109, s10, v107
v_mfma_f32_16x16x32_bf16 v[228:231], a[56:59], v[84:87], v[228:231]
v_fmac_f32 v110, s11, v106
v_fmac_f32 v111, s11, v107
v_mfma_f32_16x16x32_bf16 v[232:235], a[56:59], v[88:91], v[232:235]
buffer_load_dwordx4 a[112:115], v21, s[36:39], s100 offen offset:0
v_lshlrev_b32 v104, 16, v102
v_and_b32 v105, 0xffff0000, v102
v_readlane_b32 s10, v24, 7
v_mfma_f32_16x16x32_bf16 v[236:239], a[56:59], v[92:95], v[236:239]
buffer_load_dwordx4 a[116:119], v21, s[36:39], s100 offen offset:1024
v_readlane_b32 s11, v24, 23
v_fmac_f32 v108, s8, v104
v_fmac_f32 v109, s8, v105
v_mfma_f32_16x16x32_bf16 v[240:243], a[60:63], v[80:83], v[240:243]
buffer_load_dwordx4 a[120:123], v21, s[36:39], s100 offen offset:2048
v_fmac_f32 v110, s9, v104
v_fmac_f32 v111, s9, v105
v_mfma_f32_16x16x32_bf16 v[244:247], a[60:63], v[84:87], v[244:247]
buffer_load_dwordx4 a[124:127], v21, s[36:39], s100 offen offset:3072
v_lshlrev_b32 v106, 16, v103
v_and_b32 v107, 0xffff0000, v103
v_fmac_f32 v108, s10, v106
v_mfma_f32_16x16x32_bf16 v[248:251], a[60:63], v[88:91], v[248:251]
s_add_u32 s100, s100, 4096
v_fmac_f32 v109, s10, v107
v_fmac_f32 v110, s11, v106
v_fmac_f32 v111, s11, v107
v_mfma_f32_16x16x32_bf16 v[252:255], a[60:63], v[92:95], v[252:255]
buffer_store_dwordx2 v[108:109], v18, s[36:39], s14 offen sc1
buffer_store_dwordx2 v[110:111], v19, s[36:39], s14 offen sc1
s_lshl_b32 s14, s40, 10
s_add_u32 s14, s14, 57671680
buffer_load_dword v29, v21, s[36:39], s14 offen sc0 sc1
buffer_load_dwordx4 a[32:35], v21, s[36:39], s100 offen offset:0
buffer_load_dwordx4 a[36:39], v21, s[36:39], s100 offen offset:1024
buffer_load_dwordx4 a[40:43], v21, s[36:39], s100 offen offset:2048
buffer_load_dwordx4 a[44:47], v21, s[36:39], s100 offen offset:3072
s_add_u32 s100, s100, 4096
buffer_load_dwordx4 a[48:51], v21, s[36:39], s100 offen offset:0
buffer_load_dwordx4 a[52:55], v21, s[36:39], s100 offen offset:1024
buffer_load_dwordx4 a[56:59], v21, s[36:39], s100 offen offset:2048
buffer_load_dwordx4 a[60:63], v21, s[36:39], s100 offen offset:3072
s_add_u32 s100, s100, 4096
s_barrier
s_lshl_b32 s48, s42, 14
v_add_u32 v11, s48, v21
s_lshl_b32 s48, s42, 9
s_add_u32 s48, s48, 65536
v_lshlrev_b32 v12, 2, v0
v_add_u32 v12, s48, v12
ds_write_b128 v11, v[128:131] offset:0
ds_write_b128 v11, v[132:135] offset:1024
ds_write_b128 v11, v[144:147] offset:2048
ds_write_b128 v11, v[148:151] offset:3072
ds_write_b128 v11, v[160:163] offset:4096
ds_write_b128 v11, v[164:167] offset:5120
ds_write_b128 v11, v[176:179] offset:6144
ds_write_b128 v11, v[180:183] offset:7168
ds_write_b128 v11, v[192:195] offset:8192
ds_write_b128 v11, v[196:199] offset:9216
ds_write_b128 v11, v[208:211] offset:10240
ds_write_b128 v11, v[212:215] offset:11264
s_waitcnt lgkmcnt(8)
ds_write_b128 v11, v[224:227] offset:12288
ds_write_b128 v11, v[228:231] offset:13312
ds_write_b128 v11, v[240:243] offset:14336
ds_write_b128 v11, v[244:247] offset:15360
ds_write_b32 v12, a128 offset:0
ds_write_b32 v12, a132 offset:256
v_xor_b32 v11, 0x4000, v11
v_xor_b32 v12, 512, v12
v_accvgpr_read_b32 v4, a136
v_accvgpr_read_b32 v6, a140
v_mov_b32 v15, 0x5d800000
s_waitcnt lgkmcnt(0)
buffer_load_dwordx4 a[128:131], v21, s[36:39], s100 offen offset:0
buffer_load_dwordx4 a[132:135], v21, s[36:39], s100 offen offset:1024
buffer_load_dwordx4 a[136:139], v21, s[36:39], s100 offen offset:2048
buffer_load_dwordx4 a[140:143], v21, s[36:39], s100 offen offset:3072
s_add_u32 s100, s100, 4096
buffer_load_dwordx4 a[144:147], v21, s[36:39], s100 offen offset:0
buffer_load_dwordx4 a[148:151], v21, s[36:39], s100 offen offset:1024
buffer_load_dwordx4 a[152:155], v21, s[36:39], s100 offen offset:2048
buffer_load_dwordx4 a[156:159], v21, s[36:39], s100 offen offset:3072
s_add_u32 s100, s100, 4096
s_barrier
ds_read_b32 v8, v12 offset:0
ds_read_b32 v9, v12 offset:256
ds_read_b128 v[32:35], v11 offset:0
ds_read_b128 v[36:39], v11 offset:2048
ds_read_b128 v[40:43], v11 offset:4096
ds_read_b128 v[44:47], v11 offset:6144
ds_read_b128 v[48:51], v11 offset:8192
ds_read_b128 v[52:55], v11 offset:10240
ds_read_b128 v[56:59], v11 offset:12288
ds_read_b128 v[60:63], v11 offset:14336
ds_read_b128 v[64:67], v11 offset:1024
ds_read_b128 v[68:71], v11 offset:3072
ds_read_b128 v[72:75], v11 offset:5120
ds_read_b128 v[76:79], v11 offset:7168
s_waitcnt lgkmcnt(12)
v_add_f32 v4, v4, v8
v_add_f32 v6, v6, v9
s_waitcnt lgkmcnt(11)
ds_read_b128 v[80:83], v11 offset:9216
v_pk_add_f32 v[136:137], v[136:137], v[32:33]
v_pk_add_f32 v[138:139], v[138:139], v[34:35]
s_waitcnt lgkmcnt(11)
ds_read_b128 v[84:87], v11 offset:11264
v_pk_add_f32 v[152:153], v[152:153], v[36:37]
v_pk_add_f32 v[154:155], v[154:155], v[38:39]
s_waitcnt lgkmcnt(11)
ds_read_b128 v[88:91], v11 offset:13312
v_pk_add_f32 v[168:169], v[168:169], v[40:41]
v_pk_add_f32 v[170:171], v[170:171], v[42:43]
s_waitcnt lgkmcnt(11)
ds_read_b128 v[92:95], v11 offset:15360
v_pk_add_f32 v[184:185], v[184:185], v[44:45]
v_pk_add_f32 v[186:187], v[186:187], v[46:47]
s_waitcnt lgkmcnt(11)
v_pk_add_f32 v[200:201], v[200:201], v[48:49]
v_pk_add_f32 v[202:203], v[202:203], v[50:51]
s_waitcnt lgkmcnt(10)
v_pk_add_f32 v[216:217], v[216:217], v[52:53]
v_pk_add_f32 v[218:219], v[218:219], v[54:55]
s_waitcnt lgkmcnt(9)
v_pk_add_f32 v[232:233], v[232:233], v[56:57]
v_pk_add_f32 v[234:235], v[234:235], v[58:59]
s_waitcnt lgkmcnt(8)
v_pk_add_f32 v[248:249], v[248:249], v[60:61]
v_pk_add_f32 v[250:251], v[250:251], v[62:63]
s_waitcnt lgkmcnt(7)
v_pk_add_f32 v[140:141], v[140:141], v[64:65]
v_pk_add_f32 v[142:143], v[142:143], v[66:67]
s_waitcnt lgkmcnt(6)
v_pk_add_f32 v[156:157], v[156:157], v[68:69]
v_pk_add_f32 v[158:159], v[158:159], v[70:71]
s_waitcnt lgkmcnt(5)
v_pk_add_f32 v[172:173], v[172:173], v[72:73]
v_pk_add_f32 v[174:175], v[174:175], v[74:75]
s_waitcnt lgkmcnt(4)
v_pk_add_f32 v[188:189], v[188:189], v[76:77]
v_pk_add_f32 v[190:191], v[190:191], v[78:79]
s_waitcnt lgkmcnt(3)
v_pk_add_f32 v[204:205], v[204:205], v[80:81]
v_pk_add_f32 v[206:207], v[206:207], v[82:83]
s_waitcnt lgkmcnt(2)
v_pk_add_f32 v[220:221], v[220:221], v[84:85]
v_pk_add_f32 v[222:223], v[222:223], v[86:87]
s_waitcnt lgkmcnt(1)
v_pk_add_f32 v[236:237], v[236:237], v[88:89]
v_pk_add_f32 v[238:239], v[238:239], v[90:91]
s_waitcnt lgkmcnt(0)
v_pk_add_f32 v[252:253], v[252:253], v[92:93]
v_pk_add_f32 v[254:255], v[254:255], v[94:95]
v_cmp_nlt_f32 vcc, v4, v15
v_rcp_f32 v4, v4
s_or_b64 s[34:35], s[34:35], vcc
v_cmp_nlt_f32 vcc, v6, v15
v_rcp_f32 v6, v6
s_or_b64 s[34:35], s[34:35], vcc
v_pk_mul_f32 v[136:137], v[136:137], v[4:5] op_sel_hi:[1,0]
v_pk_mul_f32 v[138:139], v[138:139], v[4:5] op_sel_hi:[1,0]
v_pk_mul_f32 v[152:153], v[152:153], v[4:5] op_sel_hi:[1,0]
v_pk_mul_f32 v[154:155], v[154:155], v[4:5] op_sel_hi:[1,0]
v_cvt_pk_bf16_f32 v136, v136, v137
v_cvt_pk_bf16_f32 v137, v138, v139
v_cvt_pk_bf16_f32 v138, v152, v153
v_cvt_pk_bf16_f32 v139, v154, v155
buffer_store_dwordx4 v[136:139], v21, s[36:39], s67 offen offset:0 sc1
v_pk_mul_f32 v[168:169], v[168:169], v[4:5] op_sel_hi:[1,0]
v_pk_mul_f32 v[170:171], v[170:171], v[4:5] op_sel_hi:[1,0]
v_pk_mul_f32 v[184:185], v[184:185], v[4:5] op_sel_hi:[1,0]
v_pk_mul_f32 v[186:187], v[186:187], v[4:5] op_sel_hi:[1,0]
v_cvt_pk_bf16_f32 v168, v168, v169
v_cvt_pk_bf16_f32 v169, v170, v171
v_cvt_pk_bf16_f32 v170, v184, v185
v_cvt_pk_bf16_f32 v171, v186, v187
buffer_store_dwordx4 v[168:171], v21, s[36:39], s67 offen offset:1024 sc1
v_pk_mul_f32 v[200:201], v[200:201], v[4:5] op_sel_hi:[1,0]
v_pk_mul_f32 v[202:203], v[202:203], v[4:5] op_sel_hi:[1,0]
v_pk_mul_f32 v[216:217], v[216:217], v[4:5] op_sel_hi:[1,0]
v_pk_mul_f32 v[218:219], v[218:219], v[4:5] op_sel_hi:[1,0]
v_cvt_pk_bf16_f32 v200, v200, v201
v_cvt_pk_bf16_f32 v201, v202, v203
v_cvt_pk_bf16_f32 v202, v216, v217
v_cvt_pk_bf16_f32 v203, v218, v219
buffer_store_dwordx4 v[200:203], v21, s[36:39], s67 offen offset:2048 sc1
v_pk_mul_f32 v[232:233], v[232:233], v[4:5] op_sel_hi:[1,0]
v_pk_mul_f32 v[234:235], v[234:235], v[4:5] op_sel_hi:[1,0]
v_pk_mul_f32 v[248:249], v[248:249], v[4:5] op_sel_hi:[1,0]
v_pk_mul_f32 v[250:251], v[250:251], v[4:5] op_sel_hi:[1,0]
v_cvt_pk_bf16_f32 v232, v232, v233
v_cvt_pk_bf16_f32 v233, v234, v235
v_cvt_pk_bf16_f32 v234, v248, v249
v_cvt_pk_bf16_f32 v235, v250, v251
buffer_store_dwordx4 v[232:235], v21, s[36:39], s67 offen offset:3072 sc1
s_add_u32 s18, s67, 131072
v_pk_mul_f32 v[140:141], v[140:141], v[6:7] op_sel_hi:[1,0]
v_pk_mul_f32 v[142:143], v[142:143], v[6:7] op_sel_hi:[1,0]
v_pk_mul_f32 v[156:157], v[156:157], v[6:7] op_sel_hi:[1,0]
v_pk_mul_f32 v[158:159], v[158:159], v[6:7] op_sel_hi:[1,0]
v_cvt_pk_bf16_f32 v140, v140, v141
v_cvt_pk_bf16_f32 v141, v142, v143
v_cvt_pk_bf16_f32 v142, v156, v157
v_cvt_pk_bf16_f32 v143, v158, v159
buffer_store_dwordx4 v[140:143], v21, s[36:39], s18 offen offset:0 sc1
v_pk_mul_f32 v[172:173], v[172:173], v[6:7] op_sel_hi:[1,0]
v_pk_mul_f32 v[174:175], v[174:175], v[6:7] op_sel_hi:[1,0]
v_pk_mul_f32 v[188:189], v[188:189], v[6:7] op_sel_hi:[1,0]
v_pk_mul_f32 v[190:191], v[190:191], v[6:7] op_sel_hi:[1,0]
v_cvt_pk_bf16_f32 v172, v172, v173
v_cvt_pk_bf16_f32 v173, v174, v175
v_cvt_pk_bf16_f32 v174, v188, v189
v_cvt_pk_bf16_f32 v175, v190, v191
buffer_store_dwordx4 v[172:175], v21, s[36:39], s18 offen offset:1024 sc1
v_pk_mul_f32 v[204:205], v[204:205], v[6:7] op_sel_hi:[1,0]
v_pk_mul_f32 v[206:207], v[206:207], v[6:7] op_sel_hi:[1,0]
v_pk_mul_f32 v[220:221], v[220:221], v[6:7] op_sel_hi:[1,0]
v_pk_mul_f32 v[222:223], v[222:223], v[6:7] op_sel_hi:[1,0]
v_cvt_pk_bf16_f32 v204, v204, v205
v_cvt_pk_bf16_f32 v205, v206, v207
v_cvt_pk_bf16_f32 v206, v220, v221
v_cvt_pk_bf16_f32 v207, v222, v223
buffer_store_dwordx4 v[204:207], v21, s[36:39], s18 offen offset:2048 sc1
v_pk_mul_f32 v[236:237], v[236:237], v[6:7] op_sel_hi:[1,0]
v_pk_mul_f32 v[238:239], v[238:239], v[6:7] op_sel_hi:[1,0]
v_pk_mul_f32 v[252:253], v[252:253], v[6:7] op_sel_hi:[1,0]
v_pk_mul_f32 v[254:255], v[254:255], v[6:7] op_sel_hi:[1,0]
v_cvt_pk_bf16_f32 v236, v236, v237
v_cvt_pk_bf16_f32 v237, v238, v239
v_cvt_pk_bf16_f32 v238, v252, v253
v_cvt_pk_bf16_f32 v239, v254, v255
buffer_store_dwordx4 v[236:239], v21, s[36:39], s18 offen offset:3072 sc1
s_or_b64 s[12:13], s[32:33], s[34:35]
s_cbranch_scc1 L_slow_KN
L_fin_KN:
s_lshl_b32 s14, s40, 10
s_add_u32 s14, s14, 57671680
s_load_dwordx2 s[28:29], s[0:1], 96
s_lshl_b32 s10, s40, 18
s_lshl_b32 s48, s42, 15
s_add_u32 s10, s10, s48
s_add_u32 s10, s10, 33554432
s_add_u32 s56, s10, 0
s_add_u32 s57, s10, 4096
s_add_u32 s58, s10, 8192
s_add_u32 s59, s10, 12288
s_add_u32 s60, s10, 16384
s_add_u32 s61, s10, 20480
s_add_u32 s62, s10, 24576
s_add_u32 s63, s10, 28672
v_add_u32 v18, 131072, v21
v_add_u32 v19, 8388608, v21
v_add_u32 v20, 8519680, v21
s_lshl_b32 s9, s40, 1
s_and_b32 s48, s42, 1
s_add_u32 s9, s9, s48
s_and_b32 s48, s42, 2
s_lshl_b32 s48, s48, 5
s_add_u32 s9, s9, s48
v_and_b32 v8, 15, v0
v_lshlrev_b32 v2, 10, v8
v_lshl_or_b32 v2, v22, 5, v2
s_lshl_b32 s11, s9, 14
s_lshl_b32 s48, s41, 7
s_add_u32 s11, s11, s48
s_lshl_b32 s48, s9, 4
v_add_u32 v3, s48, v8
v_lshlrev_b32 v8, 2, v8
s_lshl_b32 s12, s9, 6
s_add_u32 s12, s12, 50339840
s_lshl_b32 s48, s40, 4
s_add_u32 s48, s48, 57671680
s_lshl_b32 s101, s19, 10
s_add_u32 s101, s101, s48
s_cmp_eq_u64 s[32:33], 0
s_cselect_b32 s101, 1073741824, s101
s_lshl_b32 s17, s54, 10
s_add_u32 s17, s17, s48
s_sub_u32 s17, s17, 32256
s_waitcnt vmcnt(24)
v_cmp_eq_u32 vcc, 0, v29
s_cmp_lg_u32 vcc_lo, 0
s_cbranch_scc1 L_estub_KN
L_eback_KN:
buffer_load_dwordx4 v[96:99], v21, s[36:39], s56 offen offset:0
buffer_load_dwordx4 v[100:103], v18, s[36:39], s56 offen offset:0
buffer_load_dwordx4 v[104:107], v21, s[36:39], s56 offen offset:1024
buffer_load_dwordx4 v[108:111], v18, s[36:39], s56 offen offset:1024
buffer_load_dwordx4 v[112:115], v21, s[36:39], s56 offen offset:2048
buffer_load_dwordx4 v[116:119], v18, s[36:39], s56 offen offset:2048
buffer_load_dwordx4 v[120:123], v21, s[36:39], s56 offen offset:3072
buffer_load_dwordx4 v[124:127], v18, s[36:39], s56 offen offset:3072
s_waitcnt vmcnt(8)
s_mov_b64 exec, 1
buffer_store_dword v31, v21, s[36:39], s17 offen sc1
s_mov_b64 exec, -1
s_mov_b64 exec, 1
buffer_store_dword v31, v21, s[36:39], s101 offen sc1
s_mov_b64 exec, -1
buffer_load_dwordx4 v[128:131], v21, s[36:39], s57 offen offset:0
buffer_load_dwordx4 v[132:135], v18, s[36:39], s57 offen offset:0
buffer_load_dwordx4 v[136:139], v21, s[36:39], s57 offen offset:1024
buffer_load_dwordx4 v[140:143], v18, s[36:39], s57 offen offset:1024
buffer_load_dwordx4 v[144:147], v21, s[36:39], s57 offen offset:2048
buffer_load_dwordx4 v[148:151], v18, s[36:39], s57 offen offset:2048
s_barrier
buffer_load_dwordx4 v[152:155], v21, s[36:39], s57 offen offset:3072
buffer_load_dwordx4 v[156:159], v18, s[36:39], s57 offen offset:3072
buffer_load_dwordx4 v[160:163], v21, s[36:39], s58 offen offset:0
buffer_load_dwordx4 v[164:167], v18, s[36:39], s58 offen offset:0
buffer_load_dwordx4 v[168:171], v21, s[36:39], s58 offen offset:1024
buffer_load_dwordx4 v[172:175], v18, s[36:39], s58 offen offset:1024
buffer_load_dwordx4 v[176:179], v21, s[36:39], s58 offen offset:2048
buffer_load_dwordx4 v[180:183], v18, s[36:39], s58 offen offset:2048
buffer_load_dwordx4 v[184:187], v21, s[36:39], s58 offen offset:3072
buffer_load_dwordx4 v[188:191], v18, s[36:39], s58 offen offset:3072
buffer_load_dwordx4 v[192:195], v21, s[36:39], s59 offen offset:0
buffer_load_dwordx4 v[196:199], v18, s[36:39], s59 offen offset:0
buffer_load_dwordx4 v[200:203], v21, s[36:39], s59 offen offset:1024
buffer_load_dwordx4 v[204:207], v18, s[36:39], s59 offen offset:1024
buffer_load_dwordx4 v[208:211], v21, s[36:39], s59 offen offset:2048
buffer_load_dwordx4 v[212:215], v18, s[36:39], s59 offen offset:2048
buffer_load_dwordx4 v[216:219], v21, s[36:39], s59 offen offset:3072
buffer_load_dwordx4 v[220:223], v18, s[36:39], s59 offen offset:3072
s_mul_i32 s13, s41, 57344
s_mul_i32 s16, s42, 14336
s_add_u32 s13, s13, s16
s_add_u32 s13, s13, 50348032
v_lshlrev_b32 v4, 6, v22
v_add_u32 v9, 0x10000, v4
s_lshl_b32 s16, s42, 15
v_add_u32 v5, s16, v21
v_mov_b32 v7, 0
s_mov_b32 s48, 51265536
s_mul_i32 s18, s42, 56
v_min_u32 v6, 55, v0
v_add_u32 v6, s18, v6
v_and_b32 v16, 7, v6
v_lshrrev_b32 v6, 3, v6
s_lshr_b32 s18, s41, 1
s_lshl_b32 s18, s18, 10
s_add_u32 s18, s18, 57700864
v_lshlrev_b32 v16, 12, v16
v_lshl_add_u32 v6, v6, 4, s18
v_sub_u32 v6, v6, v16
s_mov_b32 s30, 2097152
s_mov_b32 s31, 0x20000
s_waitcnt lgkmcnt(0)
s_and_b32 s29, s29, 0xffff
s_add_u32 m0, s16, 0
s_nop 0
buffer_load_dwordx4 v21, s[36:39], s100 offen offset:0 lds
buffer_load_dwordx4 v21, s[36:39], s100 offen offset:1024 lds
buffer_load_dwordx4 v21, s[36:39], s100 offen offset:2048 lds
buffer_load_dwordx4 v21, s[36:39], s100 offen offset:3072 lds
s_add_u32 s100, s100, 4096
s_waitcnt vmcnt(36)
v_mfma_f32_16x16x32_bf16 v[32:35], a[160:163], v[96:99], 0
s_lshl_b32 s10, s42, 13
s_add_u32 s10, s10, 98304
v_add_u32 v17, s10, v21
s_add_u32 m0, s16, 4096
s_nop 0
buffer_load_dwordx4 v21, s[36:39], s100 offen offset:0 lds
v_mfma_f32_16x16x32_bf16 v[36:39], a[160:163], v[100:103], 0
buffer_load_dwordx2 v[14:15], v7, s[36:39], s48 offen sc0 sc1
v_mfma_f32_16x16x32_bf16 v[48:51], a[164:167], v[96:99], 0
buffer_load_dwordx4 v[24:27], v2, s[20:23], s11 offen offset:0
v_mfma_f32_16x16x32_bf16 v[52:55], a[164:167], v[100:103], 0
buffer_load_dwordx4 v[28:31], v2, s[20:23], s11 offen offset:16
buffer_load_dwordx4 v21, s[36:39], s100 offen offset:1024 lds
v_mfma_f32_16x16x32_bf16 v[64:67], a[168:171], v[96:99], 0
buffer_load_dword v10, v8, s[36:39], s12 offen sc0 sc1
v_mfma_f32_16x16x32_bf16 v[68:71], a[168:171], v[100:103], 0
v_and_b32 v1, 31, v0
v_lshlrev_b32 v1, 7, v1
v_lshrrev_b32 v23, 5, v0
v_lshl_or_b32 v1, v23, 17, v1
v_lshlrev_b32 v23, 7, v0
v_mfma_f32_16x16x32_bf16 v[80:83], a[172:175], v[96:99], 0
buffer_load_dwordx4 v21, s[36:39], s100 offen offset:2048 lds
v_mfma_f32_16x16x32_bf16 v[84:87], a[172:175], v[100:103], 0
s_waitcnt vmcnt(41)
v_mfma_f32_16x16x32_bf16 v[32:35], a[176:179], v[104:107], v[32:35]
v_mfma_f32_16x16x32_bf16 v[36:39], a[176:179], v[108:111], v[36:39]
buffer_load_dwordx4 v21, s[36:39], s100 offen offset:3072 lds
s_add_u32 s100, s100, 4096
v_mfma_f32_16x16x32_bf16 v[48:51], a[180:183], v[104:107], v[48:51]
buffer_load_dwordx4 v[96:99], v21, s[36:39], s60 offen offset:0
v_mfma_f32_16x16x32_bf16 v[52:55], a[180:183], v[108:111], v[52:55]
v_mfma_f32_16x16x32_bf16 v[64:67], a[184:187], v[104:107], v[64:67]
s_add_u32 m0, s16, 8192
s_nop 0
buffer_load_dwordx4 v21, s[36:39], s100 offen offset:0 lds
v_mfma_f32_16x16x32_bf16 v[68:71], a[184:187], v[108:111], v[68:71]
buffer_load_dwordx4 v[100:103], v18, s[36:39], s60 offen offset:0
v_mfma_f32_16x16x32_bf16 v[80:83], a[188:191], v[104:107], v[80:83]
v_mfma_f32_16x16x32_bf16 v[84:87], a[188:191], v[108:111], v[84:87]
buffer_load_dwordx4 v21, s[36:39], s100 offen offset:1024 lds
s_waitcnt vmcnt(44)
v_mfma_f32_16x16x32_bf16 v[32:35], a[192:195], v[112:115], v[32:35]
v_mfma_f32_16x16x32_bf16 v[36:39], a[192:195], v[116:119], v[36:39]
v_mfma_f32_16x16x32_bf16 v[48:51], a[196:199], v[112:115], v[48:51]
buffer_load_dwordx4 v21, s[36:39], s100 offen offset:2048 lds
buffer_load_dwordx4 v[104:107], v21, s[36:39], s60 offen offset:1024
v_mfma_f32_16x16x32_bf16 v[52:55], a[196:199], v[116:119], v[52:55]
v_mfma_f32_16x16x32_bf16 v[64:67], a[200:203], v[112:115], v[64:67]
v_mfma_f32_16x16x32_bf16 v[68:71], a[200:203], v[116:119], v[68:71]
buffer_load_dwordx4 v21, s[36:39], s100 offen offset:3072 lds
s_add_u32 s100, s100, 4096
buffer_load_dwordx4 v[108:111], v18, s[36:39], s60 offen offset:1024
v_mfma_f32_16x16x32_bf16 v[80:83], a[204:207], v[112:115], v[80:83]
v_mfma_f32_16x16x32_bf16 v[84:87], a[204:207], v[116:119], v[84:87]
s_waitcnt vmcnt(46)
v_mfma_f32_16x16x32_bf16 v[32:35], a[208:211], v[120:123], v[32:35]
s_add_u32 m0, s16, 12288
s_nop 0
buffer_load_dwordx4 v21, s[36:39], s100 offen offset:0 lds
v_mfma_f32_16x16x32_bf16 v[36:39], a[208:211], v[124:127], v[36:39]
v_mfma_f32_16x16x32_bf16 v[48:51], a[212:215], v[120:123], v[48:51]
buffer_load_dwordx4 v[112:115], v21, s[36:39], s60 offen offset:2048
v_mfma_f32_16x16x32_bf16 v[52:55], a[212:215], v[124:127], v[52:55]
buffer_load_dwordx4 v21, s[36:39], s100 offen offset:1024 lds
v_mfma_f32_16x16x32_bf16 v[64:67], a[216:219], v[120:123], v[64:67]
v_mfma_f32_16x16x32_bf16 v[68:71], a[216:219], v[124:127], v[68:71]
buffer_load_dwordx4 v[116:119], v18, s[36:39], s60 offen offset:2048
v_mfma_f32_16x16x32_bf16 v[80:83], a[220:223], v[120:123], v[80:83]
buffer_load_dwordx4 v21, s[36:39], s100 offen offset:2048 lds
v_mfma_f32_16x16x32_bf16 v[84:87], a[220:223], v[124:127], v[84:87]
s_waitcnt vmcnt(47)
v_mfma_f32_16x16x32_bf16 v[32:35], a[224:227], v[128:131], v[32:35]
v_mfma_f32_16x16x32_bf16 v[36:39], a[224:227], v[132:135], v[36:39]
buffer_load_dwordx4 v21, s[36:39], s100 offen offset:3072 lds
s_add_u32 s100, s100, 4096
v_mfma_f32_16x16x32_bf16 v[48:51], a[228:231], v[128:131], v[48:51]
buffer_load_dwordx4 v[120:123], v21, s[36:39], s60 offen offset:3072
v_mfma_f32_16x16x32_bf16 v[52:55], a[228:231], v[132:135], v[52:55]
v_mfma_f32_16x16x32_bf16 v[64:67], a[232:235], v[128:131], v[64:67]
s_add_u32 m0, s16, 16384
s_nop 0
buffer_load_dwordx4 v21, s[36:39], s100 offen offset:0 lds
v_mfma_f32_16x16x32_bf16 v[68:71], a[232:235], v[132:135], v[68:71]
buffer_load_dwordx4 v[124:127], v18, s[36:39], s60 offen offset:3072
v_mfma_f32_16x16x32_bf16 v[80:83], a[236:239], v[128:131], v[80:83]
v_mfma_f32_16x16x32_bf16 v[84:87], a[236:239], v[132:135], v[84:87]
buffer_load_dwordx4 v21, s[36:39], s100 offen offset:1024 lds
s_waitcnt vmcnt(50)
v_mfma_f32_16x16x32_bf16 v[32:35], a[240:243], v[136:139], v[32:35]
v_mfma_f32_16x16x32_bf16 v[36:39], a[240:243], v[140:143], v[36:39]
v_mfma_f32_16x16x32_bf16 v[48:51], a[244:247], v[136:139], v[48:51]
buffer_load_dwordx4 v21, s[36:39], s100 offen offset:2048 lds
buffer_load_dwordx4 v[128:131], v21, s[36:39], s61 offen offset:0
v_mfma_f32_16x16x32_bf16 v[52:55], a[244:247], v[140:143], v[52:55]
v_mfma_f32_16x16x32_bf16 v[64:67], a[248:251], v[136:139], v[64:67]
v_mfma_f32_16x16x32_bf16 v[68:71], a[248:251], v[140:143], v[68:71]
buffer_load_dwordx4 v21, s[36:39], s100 offen offset:3072 lds
s_add_u32 s100, s100, 4096
buffer_load_dwordx4 v[132:135], v18, s[36:39], s61 offen offset:0
v_mfma_f32_16x16x32_bf16 v[80:83], a[252:255], v[136:139], v[80:83]
v_mfma_f32_16x16x32_bf16 v[84:87], a[252:255], v[140:143], v[84:87]
s_waitcnt vmcnt(52)
v_mfma_f32_16x16x32_bf16 v[32:35], a[0:3], v[144:147], v[32:35]
s_add_u32 m0, s16, 20480
s_nop 0
buffer_load_dwordx4 v21, s[36:39], s100 offen offset:0 lds
v_mfma_f32_16x16x32_bf16 v[36:39], a[0:3], v[148:151], v[36:39]
v_mfma_f32_16x16x32_bf16 v[48:51], a[4:7], v[144:147], v[48:51]
buffer_load_dwordx4 v[136:139], v21, s[36:39], s61 offen offset:1024
buffer_load_dword v11, v21, s[36:39], s14 offen sc0 sc1
v_mfma_f32_16x16x32_bf16 v[52:55], a[4:7], v[148:151], v[52:55]
buffer_load_dwordx4 v21, s[36:39], s100 offen offset:1024 lds
v_mfma_f32_16x16x32_bf16 v[64:67], a[8:11], v[144:147], v[64:67]
v_mfma_f32_16x16x32_bf16 v[68:71], a[8:11], v[148:151], v[68:71]
buffer_load_dwordx4 v[140:143], v18, s[36:39], s61 offen offset:1024
v_mfma_f32_16x16x32_bf16 v[80:83], a[12:15], v[144:147], v[80:83]
buffer_load_dwordx4 v21, s[36:39], s100 offen offset:2048 lds
v_mfma_f32_16x16x32_bf16 v[84:87], a[12:15], v[148:151], v[84:87]
s_waitcnt vmcnt(56)
v_mfma_f32_16x16x32_bf16 v[32:35], a[16:19], v[152:155], v[32:35]
v_mfma_f32_16x16x32_bf16 v[36:39], a[16:19], v[156:159], v[36:39]
buffer_load_dwordx4 v21, s[36:39], s100 offen offset:3072 lds
s_add_u32 s100, s100, 4096
v_mfma_f32_16x16x32_bf16 v[48:51], a[20:23], v[152:155], v[48:51]
buffer_load_dwordx4 v[144:147], v21, s[36:39], s61 offen offset:2048
v_mfma_f32_16x16x32_bf16 v[52:55], a[20:23], v[156:159], v[52:55]
v_mfma_f32_16x16x32_bf16 v[64:67], a[24:27], v[152:155], v[64:67]
s_add_u32 m0, s16, 24576
s_nop 0
buffer_load_dwordx4 v21, s[36:39], s100 offen offset:0 lds
v_mfma_f32_16x16x32_bf16 v[68:71], a[24:27], v[156:159], v[68:71]
buffer_load_dwordx4 v[148:151], v18, s[36:39], s61 offen offset:2048
v_mfma_f32_16x16x32_bf16 v[80:83], a[28:31], v[152:155], v[80:83]
v_mfma_f32_16x16x32_bf16 v[84:87], a[28:31], v[156:159], v[84:87]
buffer_load_dwordx4 v21, s[36:39], s100 offen offset:1024 lds
s_waitcnt vmcnt(59)
v_mfma_f32_16x16x32_bf16 v[32:35], a[64:67], v[160:163], v[32:35]
v_mfma_f32_16x16x32_bf16 v[36:39], a[64:67], v[164:167], v[36:39]
v_mfma_f32_16x16x32_bf16 v[48:51], a[68:71], v[160:163], v[48:51]
buffer_load_dwordx4 v21, s[36:39], s100 offen offset:2048 lds
buffer_load_dwordx4 v[152:155], v21, s[36:39], s61 offen offset:3072
v_mfma_f32_16x16x32_bf16 v[52:55], a[68:71], v[164:167], v[52:55]
v_mfma_f32_16x16x32_bf16 v[64:67], a[72:75], v[160:163], v[64:67]
v_mfma_f32_16x16x32_bf16 v[68:71], a[72:75], v[164:167], v[68:71]
buffer_load_dwordx4 v21, s[36:39], s100 offen offset:3072 lds
s_add_u32 s100, s100, 4096
buffer_load_dwordx4 v[156:159], v18, s[36:39], s61 offen offset:3072
v_mfma_f32_16x16x32_bf16 v[80:83], a[76:79], v[160:163], v[80:83]
v_mfma_f32_16x16x32_bf16 v[84:87], a[76:79], v[164:167], v[84:87]
s_waitcnt vmcnt(61)
v_mfma_f32_16x16x32_bf16 v[32:35], a[80:83], v[168:171], v[32:35]
s_add_u32 m0, s16, 28672
s_nop 0
buffer_load_dwordx4 v21, s[36:39], s100 offen offset:0 lds
v_mfma_f32_16x16x32_bf16 v[36:39], a[80:83], v[172:175], v[36:39]
v_mfma_f32_16x16x32_bf16 v[48:51], a[84:87], v[168:171], v[48:51]
v_mfma_f32_16x16x32_bf16 v[52:55], a[84:87], v[172:175], v[52:55]
buffer_load_dwordx4 v21, s[36:39], s100 offen offset:1024 lds
v_mfma_f32_16x16x32_bf16 v[64:67], a[88:91], v[168:171], v[64:67]
v_mfma_f32_16x16x32_bf16 v[68:71], a[88:91], v[172:175], v[68:71]
v_mfma_f32_16x16x32_bf16 v[80:83], a[92:95], v[168:171], v[80:83]
s_waitcnt vmcnt(62)
buffer_load_dwordx4 v21, s[36:39], s100 offen offset:2048 lds
v_mfma_f32_16x16x32_bf16 v[84:87], a[92:95], v[172:175], v[84:87]
s_waitcnt vmcnt(62)
v_mfma_f32_16x16x32_bf16 v[32:35], a[96:99], v[176:179], v[32:35]
v_mfma_f32_16x16x32_bf16 v[36:39], a[96:99], v[180:183], v[36:39]
buffer_load_dwordx4 v21, s[36:39], s100 offen offset:3072 lds
s_add_u32 s100, s100, 4096
v_mfma_f32_16x16x32_bf16 v[48:51], a[100:103], v[176:179], v[48:51]
v_mfma_f32_16x16x32_bf16 v[52:55], a[100:103], v[180:183], v[52:55]
v_mfma_f32_16x16x32_bf16 v[64:67], a[104:107], v[176:179], v[64:67]
s_add_u32 m0, s10, 32768
s_waitcnt vmcnt(62)
buffer_load_dwordx4 v21, s[36:39], s100 offen offset:0 lds
v_mfma_f32_16x16x32_bf16 v[68:71], a[104:107], v[180:183], v[68:71]
v_mfma_f32_16x16x32_bf16 v[80:83], a[108:111], v[176:179], v[80:83]
v_mfma_f32_16x16x32_bf16 v[84:87], a[108:111], v[180:183], v[84:87]
s_waitcnt vmcnt(62)
buffer_load_dwordx4 v21, s[36:39], s100 offen offset:1024 lds
v_mfma_f32_16x16x32_bf16 v[32:35], a[112:115], v[184:187], v[32:35]
v_mfma_f32_16x16x32_bf16 v[36:39], a[112:115], v[188:191], v[36:39]
v_mfma_f32_16x16x32_bf16 v[48:51], a[116:119], v[184:187], v[48:51]
s_waitcnt vmcnt(62)
buffer_load_dwordx4 v21, s[36:39], s100 offen offset:2048 lds
v_mfma_f32_16x16x32_bf16 v[52:55], a[116:119], v[188:191], v[52:55]
v_mfma_f32_16x16x32_bf16 v[64:67], a[120:123], v[184:187], v[64:67]
v_mfma_f32_16x16x32_bf16 v[68:71], a[120:123], v[188:191], v[68:71]
s_waitcnt vmcnt(62)
buffer_load_dwordx4 v21, s[36:39], s100 offen offset:3072 lds
s_add_u32 s100, s100, 4096
v_mfma_f32_16x16x32_bf16 v[80:83], a[124:127], v[184:187], v[80:83]
v_mfma_f32_16x16x32_bf16 v[84:87], a[124:127], v[188:191], v[84:87]
v_mfma_f32_16x16x32_bf16 v[32:35], a[32:35], v[192:195], v[32:35]
s_add_u32 m0, s10, 36864
s_waitcnt vmcnt(62)
buffer_load_dwordx4 v21, s[36:39], s100 offen offset:0 lds
v_mfma_f32_16x16x32_bf16 v[36:39], a[32:35], v[196:199], v[36:39]
v_mfma_f32_16x16x32_bf16 v[48:51], a[36:39], v[192:195], v[48:51]
v_mfma_f32_16x16x32_bf16 v[52:55], a[36:39], v[196:199], v[52:55]
s_waitcnt vmcnt(62)
buffer_load_dwordx4 v21, s[36:39], s100 offen offset:1024 lds
v_mfma_f32_16x16x32_bf16 v[64:67], a[40:43], v[192:195], v[64:67]
v_mfma_f32_16x16x32_bf16 v[68:71], a[40:43], v[196:199], v[68:71]
v_mfma_f32_16x16x32_bf16 v[80:83], a[44:47], v[192:195], v[80:83]
s_waitcnt vmcnt(62)
buffer_load_dwordx4 v21, s[36:39], s100 offen offset:2048 lds
v_mfma_f32_16x16x32_bf16 v[84:87], a[44:47], v[196:199], v[84:87]
v_mfma_f32_16x16x32_bf16 v[32:35], a[48:51], v[200:203], v[32:35]
v_mfma_f32_16x16x32_bf16 v[36:39], a[48:51], v[204:207], v[36:39]
s_waitcnt vmcnt(62)
buffer_load_dwordx4 v21, s[36:39], s100 offen offset:3072 lds
s_add_u32 s100, s100, 4096
v_mfma_f32_16x16x32_bf16 v[48:51], a[52:55], v[200:203], v[48:51]
v_mfma_f32_16x16x32_bf16 v[52:55], a[52:55], v[204:207], v[52:55]
v_mfma_f32_16x16x32_bf16 v[64:67], a[56:59], v[200:203], v[64:67]
v_mfma_f32_16x16x32_bf16 v[68:71], a[56:59], v[204:207], v[68:71]
v_mfma_f32_16x16x32_bf16 v[80:83], a[60:63], v[200:203], v[80:83]
v_mfma_f32_16x16x32_bf16 v[84:87], a[60:63], v[204:207], v[84:87]
v_mfma_f32_16x16x32_bf16 v[32:35], a[128:131], v[208:211], v[32:35]
v_mfma_f32_16x16x32_bf16 v[36:39], a[128:131], v[212:215], v[36:39]
v_mfma_f32_16x16x32_bf16 v[48:51], a[132:135], v[208:211], v[48:51]
v_mfma_f32_16x16x32_bf16 v[52:55], a[132:135], v[212:215], v[52:55]
v_mfma_f32_16x16x32_bf16 v[64:67], a[136:139], v[208:211], v[64:67]
v_mfma_f32_16x16x32_bf16 v[68:71], a[136:139], v[212:215], v[68:71]
v_mfma_f32_16x16x32_bf16 v[80:83], a[140:143], v[208:211], v[80:83]
v_mfma_f32_16x16x32_bf16 v[84:87], a[140:143], v[212:215], v[84:87]
s_waitcnt vmcnt(61)
v_mfma_f32_16x16x32_bf16 v[32:35], a[144:147], v[216:219], v[32:35]
v_mfma_f32_16x16x32_bf16 v[36:39], a[144:147], v[220:223], v[36:39]
v_mfma_f32_16x16x32_bf16 v[48:51], a[148:151], v[216:219], v[48:51]
v_mfma_f32_16x16x32_bf16 v[52:55], a[148:151], v[220:223], v[52:55]
v_mfma_f32_16x16x32_bf16 v[64:67], a[152:155], v[216:219], v[64:67]
v_mfma_f32_16x16x32_bf16 v[68:71], a[152:155], v[220:223], v[68:71]
v_mfma_f32_16x16x32_bf16 v[80:83], a[156:159], v[216:219], v[80:83]
v_mfma_f32_16x16x32_bf16 v[84:87], a[156:159], v[220:223], v[84:87]
s_waitcnt vmcnt(55)
v_readfirstlane_b32 s44, v14
s_andn2_b32 s46, 0x7ff, s44
s_bfe_u32 s48, s46, 0x50005
s_add_u32 s50, s13, 0
s_cmp_eq_u32 s48, s40
s_cselect_b32 s50, s50, 1073741824
s_cselect_b32 s52, 0, -1
v_readfirstlane_b32 s45, v15
s_andn2_b32 s47, 0x7ff, s45
s_bfe_u32 s48, s47, 0x50005
s_add_u32 s51, s13, 458752
s_cmp_eq_u32 s48, s40
s_cselect_b32 s51, s51, 1073741824
s_cselect_b32 s53, 0, -1
s_and_b32 s15, s52, s53
s_and_b32 s8, s15, 1073741824
s_waitcnt vmcnt(24)
v_cmp_eq_u32 vcc, 0, v11
s_cmp_lg_u32 vcc_hi, 0
s_cbranch_scc1 L_cstub_KN
L_cback_KN:
buffer_load_dwordx4 v[160:163], v19, s[36:39], s56 offen offset:0
buffer_load_dwordx4 v[164:167], v20, s[36:39], s56 offen offset:0
buffer_load_dwordx4 v[168:171], v19, s[36:39], s56 offen offset:1024
buffer_load_dwordx4 v[172:175], v20, s[36:39], s56 offen offset:1024
buffer_load_dwordx4 v[176:179], v19, s[36:39], s56 offen offset:2048
buffer_load_dwordx4 v[180:183], v20, s[36:39], s56 offen offset:2048
buffer_load_dwordx4 v[184:187], v19, s[36:39], s56 offen offset:3072
buffer_load_dwordx4 v[188:191], v20, s[36:39], s56 offen offset:3072
buffer_load_dwordx4 v[192:195], v19, s[36:39], s57 offen offset:0
buffer_load_dwordx4 v[196:199], v20, s[36:39], s57 offen offset:0
buffer_load_dwordx4 v[200:203], v19, s[36:39], s57 offen offset:1024
buffer_load_dwordx4 v[204:207], v20, s[36:39], s57 offen offset:1024
buffer_load_dwordx4 v[208:211], v19, s[36:39], s57 offen offset:2048
buffer_load_dwordx4 v[212:215], v20, s[36:39], s57 offen offset:2048
buffer_load_dwordx4 v[216:219], v19, s[36:39], s57 offen offset:3072
buffer_load_dwordx4 v[220:223], v20, s[36:39], s57 offen offset:3072
s_waitcnt vmcnt(14)
v_mfma_f32_16x16x32_bf16 v[40:43], a[160:163], v[160:163], 0
v_mfma_f32_16x16x32_bf16 v[44:47], a[160:163], v[164:167], 0
v_mfma_f32_16x16x32_bf16 v[56:59], a[164:167], v[160:163], 0
v_mfma_f32_16x16x32_bf16 v[60:63], a[164:167], v[164:167], 0
v_mfma_f32_16x16x32_bf16 v[72:75], a[168:171], v[160:163], 0
v_mfma_f32_16x16x32_bf16 v[76:79], a[168:171], v[164:167], 0
v_mfma_f32_16x16x32_bf16 v[88:91], a[172:175], v[160:163], 0
v_mfma_f32_16x16x32_bf16 v[92:95], a[172:175], v[164:167], 0
s_waitcnt vmcnt(12)
v_mfma_f32_16x16x32_bf16 v[40:43], a[176:179], v[168:171], v[40:43]
v_mfma_f32_16x16x32_bf16 v[44:47], a[176:179], v[172:175], v[44:47]
buffer_load_dwordx4 v[160:163], v19, s[36:39], s58 offen offset:0
v_mfma_f32_16x16x32_bf16 v[56:59], a[180:183], v[168:171], v[56:59]
buffer_load_dwordx4 v[164:167], v20, s[36:39], s58 offen offset:0
v_mfma_f32_16x16x32_bf16 v[60:63], a[180:183], v[172:175], v[60:63]
ds_read_b128 a[160:163], v5 offset:0
v_mfma_f32_16x16x32_bf16 v[72:75], a[184:187], v[168:171], v[72:75]
ds_read_b128 a[164:167], v5 offset:1024
v_mfma_f32_16x16x32_bf16 v[76:79], a[184:187], v[172:175], v[76:79]
ds_read_b128 a[168:171], v5 offset:2048
v_mfma_f32_16x16x32_bf16 v[88:91], a[188:191], v[168:171], v[88:91]
ds_read_b128 a[172:175], v5 offset:3072
v_mfma_f32_16x16x32_bf16 v[92:95], a[188:191], v[172:175], v[92:95]
s_waitcnt vmcnt(12)
v_mfma_f32_16x16x32_bf16 v[40:43], a[192:195], v[176:179], v[40:43]
v_mfma_f32_16x16x32_bf16 v[44:47], a[192:195], v[180:183], v[44:47]
buffer_load_dwordx4 v[168:171], v19, s[36:39], s58 offen offset:1024
v_mfma_f32_16x16x32_bf16 v[56:59], a[196:199], v[176:179], v[56:59]
buffer_load_dwordx4 v[172:175], v20, s[36:39], s58 offen offset:1024
v_mfma_f32_16x16x32_bf16 v[60:63], a[196:199], v[180:183], v[60:63]
ds_read_b128 a[176:179], v5 offset:4096
v_mfma_f32_16x16x32_bf16 v[72:75], a[200:203], v[176:179], v[72:75]
buffer_load_dword v16, v6, s[36:39], s8 offen sc0 sc1
ds_read_b128 a[180:183], v5 offset:5120
v_mfma_f32_16x16x32_bf16 v[76:79], a[200:203], v[180:183], v[76:79]
ds_read_b128 a[184:187], v5 offset:6144
v_mfma_f32_16x16x32_bf16 v[88:91], a[204:207], v[176:179], v[88:91]
ds_read_b128 a[188:191], v5 offset:7168
v_mfma_f32_16x16x32_bf16 v[92:95], a[204:207], v[180:183], v[92:95]
s_waitcnt vmcnt(13)
v_mfma_f32_16x16x32_bf16 v[40:43], a[208:211], v[184:187], v[40:43]
v_mfma_f32_16x16x32_bf16 v[44:47], a[208:211], v[188:191], v[44:47]
buffer_load_dwordx4 v[176:179], v19, s[36:39], s58 offen offset:2048
v_mfma_f32_16x16x32_bf16 v[56:59], a[212:215], v[184:187], v[56:59]
buffer_load_dwordx4 v[180:183], v20, s[36:39], s58 offen offset:2048
s_waitcnt lgkmcnt(4)
v_mfma_f32_16x16x32_bf16 v[60:63], a[212:215], v[188:191], v[60:63]
ds_read_b128 a[192:195], v5 offset:8192
v_mfma_f32_16x16x32_bf16 v[72:75], a[216:219], v[184:187], v[72:75]
ds_read_b128 a[196:199], v5 offset:9216
v_mfma_f32_16x16x32_bf16 v[76:79], a[216:219], v[188:191], v[76:79]
ds_read_b128 a[200:203], v5 offset:10240
v_mfma_f32_16x16x32_bf16 v[88:91], a[220:223], v[184:187], v[88:91]
ds_read_b128 a[204:207], v5 offset:11264
v_mfma_f32_16x16x32_bf16 v[92:95], a[220:223], v[188:191], v[92:95]
s_waitcnt vmcnt(13)
v_mfma_f32_16x16x32_bf16 v[40:43], a[224:227], v[192:195], v[40:43]
v_mfma_f32_16x16x32_bf16 v[44:47], a[224:227], v[196:199], v[44:47]
buffer_load_dwordx4 v[184:187], v19, s[36:39], s58 offen offset:3072
v_mfma_f32_16x16x32_bf16 v[56:59], a[228:231], v[192:195], v[56:59]
buffer_load_dwordx4 v[188:191], v20, s[36:39], s58 offen offset:3072
s_waitcnt lgkmcnt(4)
v_mfma_f32_16x16x32_bf16 v[60:63], a[228:231], v[196:199], v[60:63]
ds_read_b128 a[208:211], v5 offset:12288
v_mfma_f32_16x16x32_bf16 v[72:75], a[232:235], v[192:195], v[72:75]
ds_read_b128 a[212:215], v5 offset:13312
v_mfma_f32_16x16x32_bf16 v[76:79], a[232:235], v[196:199], v[76:79]
ds_read_b128 a[216:219], v5 offset:14336
v_mfma_f32_16x16x32_bf16 v[88:91], a[236:239], v[192:195], v[88:91]
ds_read_b128 a[220:223], v5 offset:15360
v_mfma_f32_16x16x32_bf16 v[92:95], a[236:239], v[196:199], v[92:95]
s_waitcnt vmcnt(13)
v_mfma_f32_16x16x32_bf16 v[40:43], a[240:243], v[200:203], v[40:43]
v_mfma_f32_16x16x32_bf16 v[44:47], a[240:243], v[204:207], v[44:47]
buffer_load_dwordx4 v[192:195], v19, s[36:39], s59 offen offset:0
v_mfma_f32_16x16x32_bf16 v[56:59], a[244:247], v[200:203], v[56:59]
buffer_load_dwordx4 v[196:199], v20, s[36:39], s59 offen offset:0
s_waitcnt lgkmcnt(4)
v_mfma_f32_16x16x32_bf16 v[60:63], a[244:247], v[204:207], v[60:63]
ds_read_b128 a[224:227], v5 offset:16384
v_mfma_f32_16x16x32_bf16 v[72:75], a[248:251], v[200:203], v[72:75]
ds_read_b128 a[228:231], v5 offset:17408
v_mfma_f32_16x16x32_bf16 v[76:79], a[248:251], v[204:207], v[76:79]
ds_read_b128 a[232:235], v5 offset:18432
v_mfma_f32_16x16x32_bf16 v[88:91], a[252:255], v[200:203], v[88:91]
ds_read_b128 a[236:239], v5 offset:19456
v_mfma_f32_16x16x32_bf16 v[92:95], a[252:255], v[204:207], v[92:95]
s_waitcnt vmcnt(13)
v_mfma_f32_16x16x32_bf16 v[40:43], a[0:3], v[208:211], v[40:43]
v_mfma_f32_16x16x32_bf16 v[44:47], a[0:3], v[212:215], v[44:47]
buffer_load_dwordx4 v[200:203], v19, s[36:39], s59 offen offset:1024
v_mfma_f32_16x16x32_bf16 v[56:59], a[4:7], v[208:211], v[56:59]
buffer_load_dwordx4 v[204:207], v20, s[36:39], s59 offen offset:1024
s_waitcnt lgkmcnt(4)
v_mfma_f32_16x16x32_bf16 v[60:63], a[4:7], v[212:215], v[60:63]
ds_read_b128 a[240:243], v5 offset:20480
v_mfma_f32_16x16x32_bf16 v[72:75], a[8:11], v[208:211], v[72:75]
ds_read_b128 a[244:247], v5 offset:21504
v_mfma_f32_16x16x32_bf16 v[76:79], a[8:11], v[212:215], v[76:79]
ds_read_b128 a[248:251], v5 offset:22528
v_mfma_f32_16x16x32_bf16 v[88:91], a[12:15], v[208:211], v[88:91]
ds_read_b128 a[252:255], v5 offset:23552
v_mfma_f32_16x16x32_bf16 v[92:95], a[12:15], v[212:215], v[92:95]
s_waitcnt vmcnt(13)
v_mfma_f32_16x16x32_bf16 v[40:43], a[16:19], v[216:219], v[40:43]
v_mfma_f32_16x16x32_bf16 v[44:47], a[16:19], v[220:223], v[44:47]
buffer_load_dwordx4 v[208:211], v19, s[36:39], s59 offen offset:2048
v_mfma_f32_16x16x32_bf16 v[56:59], a[20:23], v[216:219], v[56:59]
buffer_load_dwordx4 v[212:215], v20, s[36:39], s59 offen offset:2048
s_waitcnt lgkmcnt(4)
v_mfma_f32_16x16x32_bf16 v[60:63], a[20:23], v[220:223], v[60:63]
ds_read_b128 a[0:3], v5 offset:24576
v_mfma_f32_16x16x32_bf16 v[72:75], a[24:27], v[216:219], v[72:75]
ds_read_b128 a[4:7], v5 offset:25600
v_mfma_f32_16x16x32_bf16 v[76:79], a[24:27], v[220:223], v[76:79]
ds_read_b128 a[8:11], v5 offset:26624
v_mfma_f32_16x16x32_bf16 v[88:91], a[28:31], v[216:219], v[88:91]
ds_read_b128 a[12:15], v5 offset:27648
v_mfma_f32_16x16x32_bf16 v[92:95], a[28:31], v[220:223], v[92:95]
s_waitcnt vmcnt(13)
v_mfma_f32_16x16x32_bf16 v[40:43], a[64:67], v[160:163], v[40:43]
v_mfma_f32_16x16x32_bf16 v[44:47], a[64:67], v[164:167], v[44:47]
buffer_load_dwordx4 v[216:219], v19, s[36:39], s59 offen offset:3072
v_mfma_f32_16x16x32_bf16 v[56:59], a[68:71], v[160:163], v[56:59]
buffer_load_dwordx4 v[220:223], v20, s[36:39], s59 offen offset:3072
s_waitcnt lgkmcnt(4)
v_mfma_f32_16x16x32_bf16 v[60:63], a[68:71], v[164:167], v[60:63]
ds_read_b128 a[16:19], v5 offset:28672
v_mfma_f32_16x16x32_bf16 v[72:75], a[72:75], v[160:163], v[72:75]
ds_read_b128 a[20:23], v5 offset:29696
v_mfma_f32_16x16x32_bf16 v[76:79], a[72:75], v[164:167], v[76:79]
ds_read_b128 a[24:27], v5 offset:30720
v_mfma_f32_16x16x32_bf16 v[88:91], a[76:79], v[160:163], v[88:91]
ds_read_b128 a[28:31], v5 offset:31744
v_mfma_f32_16x16x32_bf16 v[92:95], a[76:79], v[164:167], v[92:95]
s_waitcnt vmcnt(13)
v_mfma_f32_16x16x32_bf16 v[40:43], a[80:83], v[168:171], v[40:43]
v_mfma_f32_16x16x32_bf16 v[44:47], a[80:83], v[172:175], v[44:47]
buffer_load_dwordx4 v[160:163], v19, s[36:39], s60 offen offset:0
v_mfma_f32_16x16x32_bf16 v[56:59], a[84:87], v[168:171], v[56:59]
buffer_load_dwordx4 v[164:167], v20, s[36:39], s60 offen offset:0
s_waitcnt lgkmcnt(4)
v_mfma_f32_16x16x32_bf16 v[60:63], a[84:87], v[172:175], v[60:63]
ds_read_b128 a[64:67], v17 offset:32768
v_mfma_f32_16x16x32_bf16 v[72:75], a[88:91], v[168:171], v[72:75]
ds_read_b128 a[68:71], v17 offset:33792
v_mfma_f32_16x16x32_bf16 v[76:79], a[88:91], v[172:175], v[76:79]
ds_read_b128 a[72:75], v17 offset:34816
v_mfma_f32_16x16x32_bf16 v[88:91], a[92:95], v[168:171], v[88:91]
ds_read_b128 a[76:79], v17 offset:35840
v_mfma_f32_16x16x32_bf16 v[92:95], a[92:95], v[172:175], v[92:95]
s_waitcnt vmcnt(12)
v_mfma_f32_16x16x32_bf16 v[40:43], a[96:99], v[176:179], v[40:43]
v_mfma_f32_16x16x32_bf16 v[44:47], a[96:99], v[180:183], v[44:47]
buffer_load_dwordx4 v[168:171], v19, s[36:39], s60 offen offset:1024
v_mfma_f32_16x16x32_bf16 v[56:59], a[100:103], v[176:179], v[56:59]
buffer_load_dwordx4 v[172:175], v20, s[36:39], s60 offen offset:1024
s_waitcnt lgkmcnt(4)
v_mfma_f32_16x16x32_bf16 v[60:63], a[100:103], v[180:183], v[60:63]
ds_read_b128 a[80:83], v17 offset:36864
v_mfma_f32_16x16x32_bf16 v[72:75], a[104:107], v[176:179], v[72:75]
ds_read_b128 a[84:87], v17 offset:37888
v_mfma_f32_16x16x32_bf16 v[76:79], a[104:107], v[180:183], v[76:79]
ds_read_b128 a[88:91], v17 offset:38912
v_mfma_f32_16x16x32_bf16 v[88:91], a[108:111], v[176:179], v[88:91]
ds_read_b128 a[92:95], v17 offset:39936
v_mfma_f32_16x16x32_bf16 v[92:95], a[108:111], v[180:183], v[92:95]
s_waitcnt vmcnt(12)
v_mfma_f32_16x16x32_bf16 v[40:43], a[112:115], v[184:187], v[40:43]
v_mfma_f32_16x16x32_bf16 v[44:47], a[112:115], v[188:191], v[44:47]
buffer_load_dwordx4 v[176:179], v19, s[36:39], s60 offen offset:2048
v_mfma_f32_16x16x32_bf16 v[56:59], a[116:119], v[184:187], v[56:59]
buffer_load_dwordx4 v[180:183], v20, s[36:39], s60 offen offset:2048
s_waitcnt lgkmcnt(0)
v_mfma_f32_16x16x32_bf16 v[60:63], a[116:119], v[188:191], v[60:63]
buffer_load_dwordx4 a[96:99], v21, s[36:39], s100 offen offset:0
v_mfma_f32_16x16x32_bf16 v[72:75], a[120:123], v[184:187], v[72:75]
buffer_load_dwordx4 a[100:103], v21, s[36:39], s100 offen offset:1024
v_mfma_f32_16x16x32_bf16 v[76:79], a[120:123], v[188:191], v[76:79]
buffer_load_dwordx4 a[104:107], v21, s[36:39], s100 offen offset:2048
v_mfma_f32_16x16x32_bf16 v[88:91], a[124:127], v[184:187], v[88:91]
buffer_load_dwordx4 a[108:111], v21, s[36:39], s100 offen offset:3072
s_add_u32 s100, s100, 4096
v_mfma_f32_16x16x32_bf16 v[92:95], a[124:127], v[188:191], v[92:95]
s_waitcnt vmcnt(16)
v_mfma_f32_16x16x32_bf16 v[40:43], a[32:35], v[192:195], v[40:43]
v_mfma_f32_16x16x32_bf16 v[44:47], a[32:35], v[196:199], v[44:47]
v_or_b32 v16, s15, v16
buffer_load_dwordx4 v[184:187], v19, s[36:39], s60 offen offset:3072
v_mfma_f32_16x16x32_bf16 v[56:59], a[36:39], v[192:195], v[56:59]
v_cmp_eq_u32 vcc, 0, v16
buffer_load_dwordx4 v[188:191], v20, s[36:39], s60 offen offset:3072
v_mfma_f32_16x16x32_bf16 v[60:63], a[36:39], v[196:199], v[60:63]
s_cbranch_vccnz L_ystub_KN
L_yback_KN:
s_add_u32 m0, s16, 0
buffer_load_dwordx4 a[112:115], v21, s[36:39], s100 offen offset:0
v_mfma_f32_16x16x32_bf16 v[72:75], a[40:43], v[192:195], v[72:75]
buffer_load_dwordx4 v21, s[36:39], s50 offen offset:0 lds
buffer_load_dwordx4 a[116:119], v21, s[36:39], s100 offen offset:1024
v_mfma_f32_16x16x32_bf16 v[76:79], a[40:43], v[196:199], v[76:79]
buffer_load_dwordx4 a[120:123], v21, s[36:39], s100 offen offset:2048
v_mfma_f32_16x16x32_bf16 v[88:91], a[44:47], v[192:195], v[88:91]
buffer_load_dwordx4 a[124:127], v21, s[36:39], s100 offen offset:3072
s_add_u32 s100, s100, 4096
v_mfma_f32_16x16x32_bf16 v[92:95], a[44:47], v[196:199], v[92:95]
buffer_load_dwordx4 v21, s[36:39], s50 offen offset:1024 lds
s_waitcnt vmcnt(22)
v_mfma_f32_16x16x32_bf16 v[40:43], a[48:51], v[200:203], v[40:43]
v_mfma_f32_16x16x32_bf16 v[44:47], a[48:51], v[204:207], v[44:47]
buffer_load_dwordx4 v[192:195], v19, s[36:39], s61 offen offset:0
v_mfma_f32_16x16x32_bf16 v[56:59], a[52:55], v[200:203], v[56:59]
buffer_load_dwordx4 v21, s[36:39], s50 offen offset:2048 lds
buffer_load_dwordx4 v[196:199], v20, s[36:39], s61 offen offset:0
v_mfma_f32_16x16x32_bf16 v[60:63], a[52:55], v[204:207], v[60:63]
buffer_load_dwordx4 a[32:35], v21, s[36:39], s100 offen offset:0
v_mfma_f32_16x16x32_bf16 v[72:75], a[56:59], v[200:203], v[72:75]
buffer_load_dwordx4 a[36:39], v21, s[36:39], s100 offen offset:1024
v_mfma_f32_16x16x32_bf16 v[76:79], a[56:59], v[204:207], v[76:79]
buffer_load_dwordx4 v21, s[36:39], s50 offen offset:3072 lds
buffer_load_dwordx4 a[40:43], v21, s[36:39], s100 offen offset:2048
v_mfma_f32_16x16x32_bf16 v[88:91], a[60:63], v[200:203], v[88:91]
s_add_u32 s50, s50, 4096
buffer_load_dwordx4 a[44:47], v21, s[36:39], s100 offen offset:3072
s_add_u32 s100, s100, 4096
v_mfma_f32_16x16x32_bf16 v[92:95], a[60:63], v[204:207], v[92:95]
s_waitcnt vmcnt(28)
v_mfma_f32_16x16x32_bf16 v[40:43], a[128:131], v[208:211], v[40:43]
v_mfma_f32_16x16x32_bf16 v[44:47], a[128:131], v[212:215], v[44:47]
buffer_load_dwordx4 v[200:203], v19, s[36:39], s61 offen offset:1024
v_mfma_f32_16x16x32_bf16 v[56:59], a[132:135], v[208:211], v[56:59]
buffer_load_dwordx4 v[204:207], v20, s[36:39], s61 offen offset:1024
v_mfma_f32_16x16x32_bf16 v[60:63], a[132:135], v[212:215], v[60:63]
s_add_u32 m0, s16, 4096
buffer_load_dwordx4 a[48:51], v21, s[36:39], s100 offen offset:0
v_mfma_f32_16x16x32_bf16 v[72:75], a[136:139], v[208:211], v[72:75]
buffer_load_dwordx4 v21, s[36:39], s50 offen offset:0 lds
buffer_load_dwordx4 a[52:55], v21, s[36:39], s100 offen offset:1024
v_mfma_f32_16x16x32_bf16 v[76:79], a[136:139], v[212:215], v[76:79]
buffer_load_dwordx4 a[56:59], v21, s[36:39], s100 offen offset:2048
v_mfma_f32_16x16x32_bf16 v[88:91], a[140:143], v[208:211], v[88:91]
buffer_load_dwordx4 a[60:63], v21, s[36:39], s100 offen offset:3072
s_add_u32 s100, s100, 4096
v_mfma_f32_16x16x32_bf16 v[92:95], a[140:143], v[212:215], v[92:95]
buffer_load_dwordx4 v21, s[36:39], s50 offen offset:1024 lds
s_waitcnt vmcnt(34)
v_mfma_f32_16x16x32_bf16 v[40:43], a[144:147], v[216:219], v[40:43]
v_mfma_f32_16x16x32_bf16 v[44:47], a[144:147], v[220:223], v[44:47]
buffer_load_dwordx4 v[208:211], v19, s[36:39], s61 offen offset:2048
v_mfma_f32_16x16x32_bf16 v[56:59], a[148:151], v[216:219], v[56:59]
buffer_load_dwordx4 v21, s[36:39], s50 offen offset:2048 lds
buffer_load_dwordx4 v[212:215], v20, s[36:39], s61 offen offset:2048
v_mfma_f32_16x16x32_bf16 v[60:63], a[148:151], v[220:223], v[60:63]
buffer_load_dwordx4 a[128:131], v21, s[36:39], s100 offen offset:0
v_mfma_f32_16x16x32_bf16 v[72:75], a[152:155], v[216:219], v[72:75]
buffer_load_dwordx4 a[132:135], v21, s[36:39], s100 offen offset:1024
v_mfma_f32_16x16x32_bf16 v[76:79], a[152:155], v[220:223], v[76:79]
buffer_load_dwordx4 v21, s[36:39], s50 offen offset:3072 lds
buffer_load_dwordx4 a[136:139], v21, s[36:39], s100 offen offset:2048
v_mfma_f32_16x16x32_bf16 v[88:91], a[156:159], v[216:219], v[88:91]
s_add_u32 s50, s50, 4096
buffer_load_dwordx4 a[140:143], v21, s[36:39], s100 offen offset:3072
s_add_u32 s100, s100, 4096
v_mfma_f32_16x16x32_bf16 v[92:95], a[156:159], v[220:223], v[92:95]
s_waitcnt vmcnt(40)
v_mfma_f32_16x16x32_bf16 v[32:35], a[160:163], v[96:99], v[32:35]
v_mfma_f32_16x16x32_bf16 v[36:39], a[160:163], v[100:103], v[36:39]
buffer_load_dwordx4 v[216:219], v19, s[36:39], s61 offen offset:3072
v_mfma_f32_16x16x32_bf16 v[40:43], a[160:163], v[160:163], v[40:43]
v_mfma_f32_16x16x32_bf16 v[44:47], a[160:163], v[164:167], v[44:47]
s_add_u32 m0, s16, 8192
buffer_load_dwordx4 v[220:223], v20, s[36:39], s61 offen offset:3072
v_mfma_f32_16x16x32_bf16 v[48:51], a[164:167], v[96:99], v[48:51]
buffer_load_dwordx4 v21, s[36:39], s50 offen offset:0 lds
v_mfma_f32_16x16x32_bf16 v[52:55], a[164:167], v[100:103], v[52:55]
buffer_load_dwordx4 a[144:147], v21, s[36:39], s100 offen offset:0
v_mfma_f32_16x16x32_bf16 v[56:59], a[164:167], v[160:163], v[56:59]
v_mfma_f32_16x16x32_bf16 v[60:63], a[164:167], v[164:167], v[60:63]
buffer_load_dwordx4 v21, s[36:39], s50 offen offset:1024 lds
buffer_load_dwordx4 a[148:151], v21, s[36:39], s100 offen offset:1024
v_mfma_f32_16x16x32_bf16 v[64:67], a[168:171], v[96:99], v[64:67]
v_mfma_f32_16x16x32_bf16 v[68:71], a[168:171], v[100:103], v[68:71]
buffer_load_dwordx4 a[152:155], v21, s[36:39], s100 offen offset:2048
v_mfma_f32_16x16x32_bf16 v[72:75], a[168:171], v[160:163], v[72:75]
buffer_load_dwordx4 v21, s[36:39], s50 offen offset:2048 lds
v_mfma_f32_16x16x32_bf16 v[76:79], a[168:171], v[164:167], v[76:79]
buffer_load_dwordx4 a[156:159], v21, s[36:39], s100 offen offset:3072
v_mfma_f32_16x16x32_bf16 v[80:83], a[172:175], v[96:99], v[80:83]
v_mfma_f32_16x16x32_bf16 v[84:87], a[172:175], v[100:103], v[84:87]
buffer_load_dwordx4 v21, s[36:39], s50 offen offset:3072 lds
v_mfma_f32_16x16x32_bf16 v[88:91], a[172:175], v[160:163], v[88:91]
s_add_u32 s50, s50, 4096
v_mfma_f32_16x16x32_bf16 v[92:95], a[172:175], v[164:167], v[92:95]
s_waitcnt vmcnt(48)
v_mfma_f32_16x16x32_bf16 v[32:35], a[176:179], v[104:107], v[32:35]
v_mfma_f32_16x16x32_bf16 v[36:39], a[176:179], v[108:111], v[36:39]
buffer_load_dwordx4 v[160:163], v19, s[36:39], s62 offen offset:0
v_mfma_f32_16x16x32_bf16 v[40:43], a[176:179], v[168:171], v[40:43]
v_mfma_f32_16x16x32_bf16 v[44:47], a[176:179], v[172:175], v[44:47]
s_add_u32 m0, s16, 12288
buffer_load_dwordx4 v[164:167], v20, s[36:39], s62 offen offset:0
v_mfma_f32_16x16x32_bf16 v[48:51], a[180:183], v[104:107], v[48:51]
buffer_load_dwordx4 v21, s[36:39], s50 offen offset:0 lds
v_mfma_f32_16x16x32_bf16 v[52:55], a[180:183], v[108:111], v[52:55]
buffer_load_dwordx4 v[96:99], v21, s[36:39], s62 offen offset:0
v_mfma_f32_16x16x32_bf16 v[56:59], a[180:183], v[168:171], v[56:59]
v_mfma_f32_16x16x32_bf16 v[60:63], a[180:183], v[172:175], v[60:63]
buffer_load_dwordx4 v21, s[36:39], s50 offen offset:1024 lds
buffer_load_dwordx4 v[100:103], v18, s[36:39], s62 offen offset:0
v_mfma_f32_16x16x32_bf16 v[64:67], a[184:187], v[104:107], v[64:67]
v_mfma_f32_16x16x32_bf16 v[68:71], a[184:187], v[108:111], v[68:71]
v_mfma_f32_16x16x32_bf16 v[72:75], a[184:187], v[168:171], v[72:75]
v_mfma_f32_16x16x32_bf16 v[76:79], a[184:187], v[172:175], v[76:79]
v_mfma_f32_16x16x32_bf16 v[80:83], a[188:191], v[104:107], v[80:83]
v_mfma_f32_16x16x32_bf16 v[84:87], a[188:191], v[108:111], v[84:87]
v_mfma_f32_16x16x32_bf16 v[88:91], a[188:191], v[168:171], v[88:91]
s_add_u32 s50, s50, 4096
v_mfma_f32_16x16x32_bf16 v[92:95], a[188:191], v[172:175], v[92:95]
s_waitcnt vmcnt(52)
v_mfma_f32_16x16x32_bf16 v[32:35], a[192:195], v[112:115], v[32:35]
v_mfma_f32_16x16x32_bf16 v[36:39], a[192:195], v[116:119], v[36:39]
buffer_load_dwordx4 v[168:171], v19, s[36:39], s62 offen offset:1024
v_mfma_f32_16x16x32_bf16 v[40:43], a[192:195], v[176:179], v[40:43]
v_mfma_f32_16x16x32_bf16 v[44:47], a[192:195], v[180:183], v[44:47]
s_add_u32 m0, s16, 14336
buffer_load_dwordx4 v[172:175], v20, s[36:39], s62 offen offset:1024
v_mfma_f32_16x16x32_bf16 v[48:51], a[196:199], v[112:115], v[48:51]
buffer_load_dwordx4 v21, s[36:39], s51 offen offset:0 lds
v_mfma_f32_16x16x32_bf16 v[52:55], a[196:199], v[116:119], v[52:55]
buffer_load_dwordx4 v[104:107], v21, s[36:39], s62 offen offset:1024
v_mfma_f32_16x16x32_bf16 v[56:59], a[196:199], v[176:179], v[56:59]
v_mfma_f32_16x16x32_bf16 v[60:63], a[196:199], v[180:183], v[60:63]
buffer_load_dwordx4 v21, s[36:39], s51 offen offset:1024 lds
buffer_load_dwordx4 v[108:111], v18, s[36:39], s62 offen offset:1024
v_mfma_f32_16x16x32_bf16 v[64:67], a[200:203], v[112:115], v[64:67]
v_mfma_f32_16x16x32_bf16 v[68:71], a[200:203], v[116:119], v[68:71]
v_mfma_f32_16x16x32_bf16 v[72:75], a[200:203], v[176:179], v[72:75]
buffer_load_dwordx4 v21, s[36:39], s51 offen offset:2048 lds
v_mfma_f32_16x16x32_bf16 v[76:79], a[200:203], v[180:183], v[76:79]
v_mfma_f32_16x16x32_bf16 v[80:83], a[204:207], v[112:115], v[80:83]
v_mfma_f32_16x16x32_bf16 v[84:87], a[204:207], v[116:119], v[84:87]
buffer_load_dwordx4 v21, s[36:39], s51 offen offset:3072 lds
v_mfma_f32_16x16x32_bf16 v[88:91], a[204:207], v[176:179], v[88:91]
s_add_u32 s51, s51, 4096
v_mfma_f32_16x16x32_bf16 v[92:95], a[204:207], v[180:183], v[92:95]
s_waitcnt vmcnt(54)
v_mfma_f32_16x16x32_bf16 v[32:35], a[208:211], v[120:123], v[32:35]
v_mfma_f32_16x16x32_bf16 v[36:39], a[208:211], v[124:127], v[36:39]
buffer_load_dwordx4 v[176:179], v19, s[36:39], s62 offen offset:2048
v_mfma_f32_16x16x32_bf16 v[40:43], a[208:211], v[184:187], v[40:43]
v_mfma_f32_16x16x32_bf16 v[44:47], a[208:211], v[188:191], v[44:47]
s_add_u32 m0, s16, 18432
buffer_load_dwordx4 v[180:183], v20, s[36:39], s62 offen offset:2048
v_mfma_f32_16x16x32_bf16 v[48:51], a[212:215], v[120:123], v[48:51]
buffer_load_dwordx4 v21, s[36:39], s51 offen offset:0 lds
v_mfma_f32_16x16x32_bf16 v[52:55], a[212:215], v[124:127], v[52:55]
buffer_load_dwordx4 v[112:115], v21, s[36:39], s62 offen offset:2048
v_mfma_f32_16x16x32_bf16 v[56:59], a[212:215], v[184:187], v[56:59]
v_mfma_f32_16x16x32_bf16 v[60:63], a[212:215], v[188:191], v[60:63]
buffer_load_dwordx4 v21, s[36:39], s51 offen offset:1024 lds
buffer_load_dwordx4 v[116:119], v18, s[36:39], s62 offen offset:2048
v_mfma_f32_16x16x32_bf16 v[64:67], a[216:219], v[120:123], v[64:67]
v_mfma_f32_16x16x32_bf16 v[68:71], a[216:219], v[124:127], v[68:71]
v_mfma_f32_16x16x32_bf16 v[72:75], a[216:219], v[184:187], v[72:75]
buffer_load_dwordx4 v21, s[36:39], s51 offen offset:2048 lds
v_mfma_f32_16x16x32_bf16 v[76:79], a[216:219], v[188:191], v[76:79]
v_mfma_f32_16x16x32_bf16 v[80:83], a[220:223], v[120:123], v[80:83]
v_mfma_f32_16x16x32_bf16 v[84:87], a[220:223], v[124:127], v[84:87]
buffer_load_dwordx4 v21, s[36:39], s51 offen offset:3072 lds
v_mfma_f32_16x16x32_bf16 v[88:91], a[220:223], v[184:187], v[88:91]
s_add_u32 s51, s51, 4096
v_mfma_f32_16x16x32_bf16 v[92:95], a[220:223], v[188:191], v[92:95]
s_waitcnt vmcnt(53)
v_mfma_f32_16x16x32_bf16 v[32:35], a[224:227], v[128:131], v[32:35]
v_mfma_f32_16x16x32_bf16 v[36:39], a[224:227], v[132:135], v[36:39]
buffer_load_dwordx4 v[184:187], v19, s[36:39], s62 offen offset:3072
v_mfma_f32_16x16x32_bf16 v[40:43], a[224:227], v[192:195], v[40:43]
v_mfma_f32_16x16x32_bf16 v[44:47], a[224:227], v[196:199], v[44:47]
s_add_u32 m0, s16, 22528
buffer_load_dwordx4 v[188:191], v20, s[36:39], s62 offen offset:3072
v_mfma_f32_16x16x32_bf16 v[48:51], a[228:231], v[128:131], v[48:51]
buffer_load_dwordx4 v21, s[36:39], s51 offen offset:0 lds
v_mfma_f32_16x16x32_bf16 v[52:55], a[228:231], v[132:135], v[52:55]
buffer_load_dwordx4 v[120:123], v21, s[36:39], s62 offen offset:3072
v_mfma_f32_16x16x32_bf16 v[56:59], a[228:231], v[192:195], v[56:59]
v_mfma_f32_16x16x32_bf16 v[60:63], a[228:231], v[196:199], v[60:63]
buffer_load_dwordx4 v21, s[36:39], s51 offen offset:1024 lds
buffer_load_dwordx4 v[124:127], v18, s[36:39], s62 offen offset:3072
v_mfma_f32_16x16x32_bf16 v[64:67], a[232:235], v[128:131], v[64:67]
v_mfma_f32_16x16x32_bf16 v[68:71], a[232:235], v[132:135], v[68:71]
v_mfma_f32_16x16x32_bf16 v[72:75], a[232:235], v[192:195], v[72:75]
buffer_load_dwordx4 v21, s[36:39], s51 offen offset:2048 lds
v_mfma_f32_16x16x32_bf16 v[76:79], a[232:235], v[196:199], v[76:79]
v_mfma_f32_16x16x32_bf16 v[80:83], a[236:239], v[128:131], v[80:83]
v_mfma_f32_16x16x32_bf16 v[84:87], a[236:239], v[132:135], v[84:87]
buffer_load_dwordx4 v21, s[36:39], s51 offen offset:3072 lds
v_mfma_f32_16x16x32_bf16 v[88:91], a[236:239], v[192:195], v[88:91]
s_add_u32 s51, s51, 4096
v_mfma_f32_16x16x32_bf16 v[92:95], a[236:239], v[196:199], v[92:95]
s_waitcnt vmcnt(54)
v_mfma_f32_16x16x32_bf16 v[32:35], a[240:243], v[136:139], v[32:35]
v_mfma_f32_16x16x32_bf16 v[36:39], a[240:243], v[140:143], v[36:39]
buffer_load_dwordx4 v[192:195], v19, s[36:39], s63 offen offset:0
v_mfma_f32_16x16x32_bf16 v[40:43], a[240:243], v[200:203], v[40:43]
v_mfma_f32_16x16x32_bf16 v[44:47], a[240:243], v[204:207], v[44:47]
s_add_u32 m0, s16, 26624
buffer_load_dwordx4 v[196:199], v20, s[36:39], s63 offen offset:0
v_mfma_f32_16x16x32_bf16 v[48:51], a[244:247], v[136:139], v[48:51]
buffer_load_dwordx4 v21, s[36:39], s51 offen offset:0 lds
v_mfma_f32_16x16x32_bf16 v[52:55], a[244:247], v[140:143], v[52:55]
buffer_load_dwordx4 v[128:131], v21, s[36:39], s63 offen offset:0
v_mfma_f32_16x16x32_bf16 v[56:59], a[244:247], v[200:203], v[56:59]
v_mfma_f32_16x16x32_bf16 v[60:63], a[244:247], v[204:207], v[60:63]
buffer_load_dwordx4 v21, s[36:39], s51 offen offset:1024 lds
buffer_load_dwordx4 v[132:135], v18, s[36:39], s63 offen offset:0
v_mfma_f32_16x16x32_bf16 v[64:67], a[248:251], v[136:139], v[64:67]
v_mfma_f32_16x16x32_bf16 v[68:71], a[248:251], v[140:143], v[68:71]
v_mfma_f32_16x16x32_bf16 v[72:75], a[248:251], v[200:203], v[72:75]
v_mfma_f32_16x16x32_bf16 v[76:79], a[248:251], v[204:207], v[76:79]
v_mfma_f32_16x16x32_bf16 v[80:83], a[252:255], v[136:139], v[80:83]
v_mfma_f32_16x16x32_bf16 v[84:87], a[252:255], v[140:143], v[84:87]
v_mfma_f32_16x16x32_bf16 v[88:91], a[252:255], v[200:203], v[88:91]
s_add_u32 s51, s51, 4096
v_mfma_f32_16x16x32_bf16 v[92:95], a[252:255], v[204:207], v[92:95]
s_waitcnt vmcnt(51)
v_mfma_f32_16x16x32_bf16 v[32:35], a[0:3], v[144:147], v[32:35]
v_mfma_f32_16x16x32_bf16 v[36:39], a[0:3], v[148:151], v[36:39]
buffer_load_dwordx4 v[200:203], v19, s[36:39], s63 offen offset:1024
v_mfma_f32_16x16x32_bf16 v[40:43], a[0:3], v[208:211], v[40:43]
v_mfma_f32_16x16x32_bf16 v[44:47], a[0:3], v[212:215], v[44:47]
buffer_load_dwordx4 v[204:207], v20, s[36:39], s63 offen offset:1024
v_mfma_f32_16x16x32_bf16 v[48:51], a[4:7], v[144:147], v[48:51]
v_mfma_f32_16x16x32_bf16 v[52:55], a[4:7], v[148:151], v[52:55]
buffer_load_dwordx4 v[136:139], v21, s[36:39], s63 offen offset:1024
v_mfma_f32_16x16x32_bf16 v[56:59], a[4:7], v[208:211], v[56:59]
v_mfma_f32_16x16x32_bf16 v[60:63], a[4:7], v[212:215], v[60:63]
buffer_load_dwordx4 v[140:143], v18, s[36:39], s63 offen offset:1024
v_mfma_f32_16x16x32_bf16 v[64:67], a[8:11], v[144:147], v[64:67]
v_mfma_f32_16x16x32_bf16 v[68:71], a[8:11], v[148:151], v[68:71]
v_mfma_f32_16x16x32_bf16 v[72:75], a[8:11], v[208:211], v[72:75]
s_waitcnt vmcnt(35)
s_cmp_eq_u32 s52, 0
s_cbranch_scc1 L_own0_KN
L_ownr0_KN:
v_mfma_f32_16x16x32_bf16 v[76:79], a[8:11], v[212:215], v[76:79]
v_mfma_f32_16x16x32_bf16 v[80:83], a[12:15], v[144:147], v[80:83]
v_mfma_f32_16x16x32_bf16 v[84:87], a[12:15], v[148:151], v[84:87]
v_mfma_f32_16x16x32_bf16 v[88:91], a[12:15], v[208:211], v[88:91]
v_mfma_f32_16x16x32_bf16 v[92:95], a[12:15], v[212:215], v[92:95]
v_mfma_f32_16x16x32_bf16 v[32:35], a[16:19], v[152:155], v[32:35]
v_mfma_f32_16x16x32_bf16 v[36:39], a[16:19], v[156:159], v[36:39]
buffer_load_dwordx4 v[208:211], v19, s[36:39], s63 offen offset:2048
v_mfma_f32_16x16x32_bf16 v[40:43], a[16:19], v[216:219], v[40:43]
v_mfma_f32_16x16x32_bf16 v[44:47], a[16:19], v[220:223], v[44:47]
buffer_load_dwordx4 v[212:215], v20, s[36:39], s63 offen offset:2048
v_mfma_f32_16x16x32_bf16 v[48:51], a[20:23], v[152:155], v[48:51]
v_mfma_f32_16x16x32_bf16 v[52:55], a[20:23], v[156:159], v[52:55]
buffer_load_dwordx4 v[144:147], v21, s[36:39], s63 offen offset:2048
v_mfma_f32_16x16x32_bf16 v[56:59], a[20:23], v[216:219], v[56:59]
v_mfma_f32_16x16x32_bf16 v[60:63], a[20:23], v[220:223], v[60:63]
buffer_load_dwordx4 v[148:151], v18, s[36:39], s63 offen offset:2048
v_mfma_f32_16x16x32_bf16 v[64:67], a[24:27], v[152:155], v[64:67]
v_mfma_f32_16x16x32_bf16 v[68:71], a[24:27], v[156:159], v[68:71]
v_mfma_f32_16x16x32_bf16 v[72:75], a[24:27], v[216:219], v[72:75]
v_mfma_f32_16x16x32_bf16 v[76:79], a[24:27], v[220:223], v[76:79]
v_mfma_f32_16x16x32_bf16 v[80:83], a[28:31], v[152:155], v[80:83]
v_mfma_f32_16x16x32_bf16 v[84:87], a[28:31], v[156:159], v[84:87]
v_mfma_f32_16x16x32_bf16 v[88:91], a[28:31], v[216:219], v[88:91]
v_mfma_f32_16x16x32_bf16 v[92:95], a[28:31], v[220:223], v[92:95]
s_waitcnt vmcnt(38)
v_mfma_f32_16x16x32_bf16 v[32:35], a[64:67], v[96:99], v[32:35]
v_mfma_f32_16x16x32_bf16 v[36:39], a[64:67], v[100:103], v[36:39]
buffer_load_dwordx4 v[216:219], v19, s[36:39], s63 offen offset:3072
v_mfma_f32_16x16x32_bf16 v[40:43], a[64:67], v[160:163], v[40:43]
v_mfma_f32_16x16x32_bf16 v[44:47], a[64:67], v[164:167], v[44:47]
buffer_load_dwordx4 v[220:223], v20, s[36:39], s63 offen offset:3072
v_mfma_f32_16x16x32_bf16 v[48:51], a[68:71], v[96:99], v[48:51]
v_mfma_f32_16x16x32_bf16 v[52:55], a[68:71], v[100:103], v[52:55]
buffer_load_dwordx4 v[152:155], v21, s[36:39], s63 offen offset:3072
v_mfma_f32_16x16x32_bf16 v[56:59], a[68:71], v[160:163], v[56:59]
v_mfma_f32_16x16x32_bf16 v[60:63], a[68:71], v[164:167], v[60:63]
buffer_load_dwordx4 v[156:159], v18, s[36:39], s63 offen offset:3072
v_mfma_f32_16x16x32_bf16 v[64:67], a[72:75], v[96:99], v[64:67]
v_mfma_f32_16x16x32_bf16 v[68:71], a[72:75], v[100:103], v[68:71]
v_mfma_f32_16x16x32_bf16 v[72:75], a[72:75], v[160:163], v[72:75]
v_mfma_f32_16x16x32_bf16 v[76:79], a[72:75], v[164:167], v[76:79]
v_mfma_f32_16x16x32_bf16 v[80:83], a[76:79], v[96:99], v[80:83]
v_mfma_f32_16x16x32_bf16 v[84:87], a[76:79], v[100:103], v[84:87]
v_mfma_f32_16x16x32_bf16 v[88:91], a[76:79], v[160:163], v[88:91]
v_mfma_f32_16x16x32_bf16 v[92:95], a[76:79], v[164:167], v[92:95]
s_waitcnt vmcnt(36)
v_mfma_f32_16x16x32_bf16 v[32:35], a[80:83], v[104:107], v[32:35]
v_mfma_f32_16x16x32_bf16 v[36:39], a[80:83], v[108:111], v[36:39]
v_mfma_f32_16x16x32_bf16 v[40:43], a[80:83], v[168:171], v[40:43]
v_mfma_f32_16x16x32_bf16 v[44:47], a[80:83], v[172:175], v[44:47]
v_mfma_f32_16x16x32_bf16 v[48:51], a[84:87], v[104:107], v[48:51]
v_mfma_f32_16x16x32_bf16 v[52:55], a[84:87], v[108:111], v[52:55]
v_mfma_f32_16x16x32_bf16 v[56:59], a[84:87], v[168:171], v[56:59]
v_mfma_f32_16x16x32_bf16 v[60:63], a[84:87], v[172:175], v[60:63]
v_mfma_f32_16x16x32_bf16 v[64:67], a[88:91], v[104:107], v[64:67]
v_mfma_f32_16x16x32_bf16 v[68:71], a[88:91], v[108:111], v[68:71]
v_mfma_f32_16x16x32_bf16 v[72:75], a[88:91], v[168:171], v[72:75]
s_waitcnt vmcnt(13)
s_cmp_eq_u32 s53, 0
s_cbranch_scc1 L_own1_KN
L_ownr1_KN:
v_mfma_f32_16x16x32_bf16 v[76:79], a[88:91], v[172:175], v[76:79]
v_mfma_f32_16x16x32_bf16 v[80:83], a[92:95], v[104:107], v[80:83]
v_mfma_f32_16x16x32_bf16 v[84:87], a[92:95], v[108:111], v[84:87]
v_mfma_f32_16x16x32_bf16 v[88:91], a[92:95], v[168:171], v[88:91]
v_mfma_f32_16x16x32_bf16 v[92:95], a[92:95], v[172:175], v[92:95]
v_mfma_f32_16x16x32_bf16 v[32:35], a[96:99], v[112:115], v[32:35]
v_sub_f32 v12, 1.0, v10
v_mfma_f32_16x16x32_bf16 v[36:39], a[96:99], v[116:119], v[36:39]
v_cvt_pk_bf16_f32 v12, v12, v12
v_mfma_f32_16x16x32_bf16 v[40:43], a[96:99], v[176:179], v[40:43]
v_and_b32 v12, 0xffff0000, v12
v_mfma_f32_16x16x32_bf16 v[44:47], a[96:99], v[180:183], v[44:47]
v_lshlrev_b32 v224, 16, v24
v_mfma_f32_16x16x32_bf16 v[48:51], a[100:103], v[112:115], v[48:51]
v_and_b32 v225, 0xffff0000, v24
v_mfma_f32_16x16x32_bf16 v[52:55], a[100:103], v[116:119], v[52:55]
v_mul_f32 v224, v224, v12
v_mfma_f32_16x16x32_bf16 v[56:59], a[100:103], v[176:179], v[56:59]
v_mul_f32 v225, v225, v12
v_mfma_f32_16x16x32_bf16 v[60:63], a[100:103], v[180:183], v[60:63]
v_cvt_pk_bf16_f32 v225, v224, v225
v_mfma_f32_16x16x32_bf16 v[64:67], a[104:107], v[112:115], v[64:67]
v_lshlrev_b32 v224, 16, v225
v_mfma_f32_16x16x32_bf16 v[68:71], a[104:107], v[116:119], v[68:71]
v_and_b32 v225, 0xffff0000, v225
v_mfma_f32_16x16x32_bf16 v[72:75], a[104:107], v[176:179], v[72:75]
v_lshlrev_b32 v226, 16, v25
v_mfma_f32_16x16x32_bf16 v[76:79], a[104:107], v[180:183], v[76:79]
v_and_b32 v227, 0xffff0000, v25
v_mfma_f32_16x16x32_bf16 v[80:83], a[108:111], v[112:115], v[80:83]
v_mul_f32 v226, v226, v12
v_mfma_f32_16x16x32_bf16 v[84:87], a[108:111], v[116:119], v[84:87]
v_mul_f32 v227, v227, v12
v_mfma_f32_16x16x32_bf16 v[88:91], a[108:111], v[176:179], v[88:91]
v_cvt_pk_bf16_f32 v227, v226, v227
v_mfma_f32_16x16x32_bf16 v[92:95], a[108:111], v[180:183], v[92:95]
v_lshlrev_b32 v226, 16, v227
v_mfma_f32_16x16x32_bf16 v[32:35], a[112:115], v[120:123], v[32:35]
v_and_b32 v227, 0xffff0000, v227
v_mfma_f32_16x16x32_bf16 v[36:39], a[112:115], v[124:127], v[36:39]
v_lshlrev_b32 v228, 16, v26
v_mfma_f32_16x16x32_bf16 v[40:43], a[112:115], v[184:187], v[40:43]
v_and_b32 v229, 0xffff0000, v26
v_mfma_f32_16x16x32_bf16 v[44:47], a[112:115], v[188:191], v[44:47]
v_mul_f32 v228, v228, v12
v_mfma_f32_16x16x32_bf16 v[48:51], a[116:119], v[120:123], v[48:51]
v_mul_f32 v229, v229, v12
v_mfma_f32_16x16x32_bf16 v[52:55], a[116:119], v[124:127], v[52:55]
v_cvt_pk_bf16_f32 v229, v228, v229
v_mfma_f32_16x16x32_bf16 v[56:59], a[116:119], v[184:187], v[56:59]
v_lshlrev_b32 v228, 16, v229
v_mfma_f32_16x16x32_bf16 v[60:63], a[116:119], v[188:191], v[60:63]
v_and_b32 v229, 0xffff0000, v229
v_mfma_f32_16x16x32_bf16 v[64:67], a[120:123], v[120:123], v[64:67]
v_lshlrev_b32 v230, 16, v27
v_mfma_f32_16x16x32_bf16 v[68:71], a[120:123], v[124:127], v[68:71]
v_and_b32 v231, 0xffff0000, v27
v_mfma_f32_16x16x32_bf16 v[72:75], a[120:123], v[184:187], v[72:75]
v_mul_f32 v230, v230, v12
v_mfma_f32_16x16x32_bf16 v[76:79], a[120:123], v[188:191], v[76:79]
v_mul_f32 v231, v231, v12
v_mfma_f32_16x16x32_bf16 v[80:83], a[124:127], v[120:123], v[80:83]
v_cvt_pk_bf16_f32 v231, v230, v231
v_mfma_f32_16x16x32_bf16 v[84:87], a[124:127], v[124:127], v[84:87]
v_lshlrev_b32 v230, 16, v231
v_mfma_f32_16x16x32_bf16 v[88:91], a[124:127], v[184:187], v[88:91]
v_and_b32 v231, 0xffff0000, v231
v_mfma_f32_16x16x32_bf16 v[92:95], a[124:127], v[188:191], v[92:95]
s_waitcnt vmcnt(12)
v_lshlrev_b32 v232, 16, v28
v_mfma_f32_16x16x32_bf16 v[32:35], a[32:35], v[128:131], v[32:35]
v_and_b32 v233, 0xffff0000, v28
v_mfma_f32_16x16x32_bf16 v[36:39], a[32:35], v[132:135], v[36:39]
v_mul_f32 v232, v232, v12
v_mfma_f32_16x16x32_bf16 v[40:43], a[32:35], v[192:195], v[40:43]
v_mul_f32 v233, v233, v12
v_mfma_f32_16x16x32_bf16 v[44:47], a[32:35], v[196:199], v[44:47]
v_cvt_pk_bf16_f32 v233, v232, v233
v_mfma_f32_16x16x32_bf16 v[48:51], a[36:39], v[128:131], v[48:51]
v_lshlrev_b32 v232, 16, v233
v_mfma_f32_16x16x32_bf16 v[52:55], a[36:39], v[132:135], v[52:55]
v_and_b32 v233, 0xffff0000, v233
v_mfma_f32_16x16x32_bf16 v[56:59], a[36:39], v[192:195], v[56:59]
v_lshlrev_b32 v234, 16, v29
v_mfma_f32_16x16x32_bf16 v[60:63], a[36:39], v[196:199], v[60:63]
v_and_b32 v235, 0xffff0000, v29
v_mfma_f32_16x16x32_bf16 v[64:67], a[40:43], v[128:131], v[64:67]
v_mul_f32 v234, v234, v12
v_mfma_f32_16x16x32_bf16 v[68:71], a[40:43], v[132:135], v[68:71]
v_mul_f32 v235, v235, v12
v_mfma_f32_16x16x32_bf16 v[72:75], a[40:43], v[192:195], v[72:75]
v_cvt_pk_bf16_f32 v235, v234, v235
v_mfma_f32_16x16x32_bf16 v[76:79], a[40:43], v[196:199], v[76:79]
v_lshlrev_b32 v234, 16, v235
v_mfma_f32_16x16x32_bf16 v[80:83], a[44:47], v[128:131], v[80:83]
v_and_b32 v235, 0xffff0000, v235
v_mfma_f32_16x16x32_bf16 v[84:87], a[44:47], v[132:135], v[84:87]
v_lshlrev_b32 v236, 16, v30
v_mfma_f32_16x16x32_bf16 v[88:91], a[44:47], v[192:195], v[88:91]
v_and_b32 v237, 0xffff0000, v30
v_mfma_f32_16x16x32_bf16 v[92:95], a[44:47], v[196:199], v[92:95]
s_waitcnt vmcnt(8)
v_mul_f32 v236, v236, v12
v_mfma_f32_16x16x32_bf16 v[32:35], a[48:51], v[136:139], v[32:35]
v_mul_f32 v237, v237, v12
v_mfma_f32_16x16x32_bf16 v[36:39], a[48:51], v[140:143], v[36:39]
v_cvt_pk_bf16_f32 v237, v236, v237
v_mfma_f32_16x16x32_bf16 v[40:43], a[48:51], v[200:203], v[40:43]
v_lshlrev_b32 v236, 16, v237
v_mfma_f32_16x16x32_bf16 v[44:47], a[48:51], v[204:207], v[44:47]
v_and_b32 v237, 0xffff0000, v237
v_mfma_f32_16x16x32_bf16 v[48:51], a[52:55], v[136:139], v[48:51]
v_lshlrev_b32 v238, 16, v31
v_mfma_f32_16x16x32_bf16 v[52:55], a[52:55], v[140:143], v[52:55]
v_and_b32 v239, 0xffff0000, v31
v_mfma_f32_16x16x32_bf16 v[56:59], a[52:55], v[200:203], v[56:59]
v_mul_f32 v238, v238, v12
v_mfma_f32_16x16x32_bf16 v[60:63], a[52:55], v[204:207], v[60:63]
v_mul_f32 v239, v239, v12
v_mfma_f32_16x16x32_bf16 v[64:67], a[56:59], v[136:139], v[64:67]
v_cvt_pk_bf16_f32 v239, v238, v239
v_mfma_f32_16x16x32_bf16 v[68:71], a[56:59], v[140:143], v[68:71]
v_lshlrev_b32 v238, 16, v239
v_mfma_f32_16x16x32_bf16 v[72:75], a[56:59], v[200:203], v[72:75]
v_and_b32 v239, 0xffff0000, v239
v_mfma_f32_16x16x32_bf16 v[76:79], a[56:59], v[204:207], v[76:79]
s_lshl_b32 s48, s42, 12
v_mfma_f32_16x16x32_bf16 v[80:83], a[60:63], v[136:139], v[80:83]
v_add_u32 v4, s48, v21
v_mfma_f32_16x16x32_bf16 v[84:87], a[60:63], v[140:143], v[84:87]
v_add_u32 v9, 0x10000, v4
v_mfma_f32_16x16x32_bf16 v[88:91], a[60:63], v[200:203], v[88:91]
v_mfma_f32_16x16x32_bf16 v[92:95], a[60:63], v[204:207], v[92:95]
s_waitcnt vmcnt(4)
v_mfma_f32_16x16x32_bf16 v[32:35], a[128:131], v[144:147], v[32:35]
v_mfma_f32_16x16x32_bf16 v[36:39], a[128:131], v[148:151], v[36:39]
v_mfma_f32_16x16x32_bf16 v[40:43], a[128:131], v[208:211], v[40:43]
v_mfma_f32_16x16x32_bf16 v[44:47], a[128:131], v[212:215], v[44:47]
v_mfma_f32_16x16x32_bf16 v[48:51], a[132:135], v[144:147], v[48:51]
v_mfma_f32_16x16x32_bf16 v[52:55], a[132:135], v[148:151], v[52:55]
v_mfma_f32_16x16x32_bf16 v[56:59], a[132:135], v[208:211], v[56:59]
v_mfma_f32_16x16x32_bf16 v[60:63], a[132:135], v[212:215], v[60:63]
v_mfma_f32_16x16x32_bf16 v[64:67], a[136:139], v[144:147], v[64:67]
v_mfma_f32_16x16x32_bf16 v[68:71], a[136:139], v[148:151], v[68:71]
v_mfma_f32_16x16x32_bf16 v[72:75], a[136:139], v[208:211], v[72:75]
v_mfma_f32_16x16x32_bf16 v[76:79], a[136:139], v[212:215], v[76:79]
v_mfma_f32_16x16x32_bf16 v[80:83], a[140:143], v[144:147], v[80:83]
v_mfma_f32_16x16x32_bf16 v[84:87], a[140:143], v[148:151], v[84:87]
v_mfma_f32_16x16x32_bf16 v[88:91], a[140:143], v[208:211], v[88:91]
v_mfma_f32_16x16x32_bf16 v[92:95], a[140:143], v[212:215], v[92:95]
s_waitcnt vmcnt(0)
v_mfma_f32_16x16x32_bf16 v[32:35], a[144:147], v[152:155], v[32:35]
v_mfma_f32_16x16x32_bf16 v[36:39], a[144:147], v[156:159], v[36:39]
v_mfma_f32_16x16x32_bf16 v[40:43], a[144:147], v[216:219], v[40:43]
v_mfma_f32_16x16x32_bf16 v[44:47], a[144:147], v[220:223], v[44:47]
v_mfma_f32_16x16x32_bf16 v[48:51], a[148:151], v[152:155], v[48:51]
v_mfma_f32_16x16x32_bf16 v[52:55], a[148:151], v[156:159], v[52:55]
v_mfma_f32_16x16x32_bf16 v[56:59], a[148:151], v[216:219], v[56:59]
v_mfma_f32_16x16x32_bf16 v[60:63], a[148:151], v[220:223], v[60:63]
v_mfma_f32_16x16x32_bf16 v[64:67], a[152:155], v[152:155], v[64:67]
v_mfma_f32_16x16x32_bf16 v[68:71], a[152:155], v[156:159], v[68:71]
v_mfma_f32_16x16x32_bf16 v[72:75], a[152:155], v[216:219], v[72:75]
v_mfma_f32_16x16x32_bf16 v[76:79], a[152:155], v[220:223], v[76:79]
v_mfma_f32_16x16x32_bf16 v[80:83], a[156:159], v[152:155], v[80:83]
v_mfma_f32_16x16x32_bf16 v[84:87], a[156:159], v[156:159], v[84:87]
v_mfma_f32_16x16x32_bf16 v[88:91], a[156:159], v[216:219], v[88:91]
v_mfma_f32_16x16x32_bf16 v[92:95], a[156:159], v[220:223], v[92:95]
ds_write_b128 v5, v[32:35] offset:0
ds_write_b128 v5, v[36:39] offset:4096
ds_write_b128 v5, v[40:43] offset:8192
ds_write_b128 v5, v[44:47] offset:12288
ds_write_b128 v5, v[48:51] offset:1024
ds_write_b128 v5, v[52:55] offset:5120
ds_write_b128 v5, v[56:59] offset:9216
ds_write_b128 v5, v[60:63] offset:13312
ds_write_b128 v5, v[64:67] offset:2048
ds_write_b128 v5, v[68:71] offset:6144
ds_write_b128 v5, v[72:75] offset:10240
ds_write_b128 v5, v[76:79] offset:14336
s_waitcnt lgkmcnt(4)
ds_write_b128 v5, v[80:83] offset:3072
ds_write_b128 v5, v[84:87] offset:7168
ds_write_b128 v5, v[88:91] offset:11264
ds_write_b128 v5, v[92:95] offset:15360
s_waitcnt lgkmcnt(0)
s_barrier
ds_read_b128 v[32:35], v4 offset:0
ds_read_b128 v[48:51], v4 offset:32768
ds_read_b128 v[64:67], v9 offset:0
ds_read_b128 v[80:83], v9 offset:32768
ds_read_b128 v[36:39], v4 offset:1024
ds_read_b128 v[52:55], v4 offset:33792
ds_read_b128 v[68:71], v9 offset:1024
ds_read_b128 v[84:87], v9 offset:33792
ds_read_b128 v[40:43], v4 offset:2048
ds_read_b128 v[56:59], v4 offset:34816
ds_read_b128 v[72:75], v9 offset:2048
ds_read_b128 v[88:91], v9 offset:34816
s_waitcnt lgkmcnt(8)
ds_read_b128 v[44:47], v4 offset:3072
ds_read_b128 v[60:63], v4 offset:35840
ds_read_b128 v[76:79], v9 offset:3072
ds_read_b128 v[92:95], v9 offset:35840
v_pk_add_f32 v[32:33], v[32:33], v[48:49]
v_pk_add_f32 v[64:65], v[64:65], v[80:81]
v_pk_add_f32 v[32:33], v[32:33], v[64:65]
v_cvt_pk_bf16_f32 v33, v32, v33
v_lshlrev_b32 v32, 16, v33
v_and_b32 v33, 0xffff0000, v33
v_pk_mul_f32 v[32:33], v[32:33], v[10:11] op_sel_hi:[1,0]
v_cvt_pk_bf16_f32 v33, v32, v33
v_lshlrev_b32 v32, 16, v33
v_and_b32 v33, 0xffff0000, v33
v_pk_add_f32 v[32:33], v[32:33], v[224:225]
v_cvt_pk_bf16_f32 v24, v32, v33
v_pk_add_f32 v[34:35], v[34:35], v[50:51]
v_pk_add_f32 v[66:67], v[66:67], v[82:83]
v_pk_add_f32 v[34:35], v[34:35], v[66:67]
v_cvt_pk_bf16_f32 v35, v34, v35
v_lshlrev_b32 v34, 16, v35
v_and_b32 v35, 0xffff0000, v35
v_pk_mul_f32 v[34:35], v[34:35], v[10:11] op_sel_hi:[1,0]
v_cvt_pk_bf16_f32 v35, v34, v35
v_lshlrev_b32 v34, 16, v35
v_and_b32 v35, 0xffff0000, v35
v_pk_add_f32 v[34:35], v[34:35], v[232:233]
v_cvt_pk_bf16_f32 v28, v34, v35
s_waitcnt lgkmcnt(8)
v_pk_add_f32 v[36:37], v[36:37], v[52:53]
v_pk_add_f32 v[68:69], v[68:69], v[84:85]
v_pk_add_f32 v[36:37], v[36:37], v[68:69]
v_cvt_pk_bf16_f32 v37, v36, v37
v_lshlrev_b32 v36, 16, v37
v_and_b32 v37, 0xffff0000, v37
v_pk_mul_f32 v[36:37], v[36:37], v[10:11] op_sel_hi:[1,0]
v_cvt_pk_bf16_f32 v37, v36, v37
v_lshlrev_b32 v36, 16, v37
v_and_b32 v37, 0xffff0000, v37
v_pk_add_f32 v[36:37], v[36:37], v[226:227]
v_cvt_pk_bf16_f32 v25, v36, v37
v_pk_add_f32 v[38:39], v[38:39], v[54:55]
v_pk_add_f32 v[70:71], v[70:71], v[86:87]
v_pk_add_f32 v[38:39], v[38:39], v[70:71]
v_cvt_pk_bf16_f32 v39, v38, v39
v_lshlrev_b32 v38, 16, v39
v_and_b32 v39, 0xffff0000, v39
v_pk_mul_f32 v[38:39], v[38:39], v[10:11] op_sel_hi:[1,0]
v_cvt_pk_bf16_f32 v39, v38, v39
v_lshlrev_b32 v38, 16, v39
v_and_b32 v39, 0xffff0000, v39
v_pk_add_f32 v[38:39], v[38:39], v[234:235]
v_cvt_pk_bf16_f32 v29, v38, v39
s_waitcnt lgkmcnt(4)
v_pk_add_f32 v[40:41], v[40:41], v[56:57]
v_pk_add_f32 v[72:73], v[72:73], v[88:89]
v_pk_add_f32 v[40:41], v[40:41], v[72:73]
v_cvt_pk_bf16_f32 v41, v40, v41
v_lshlrev_b32 v40, 16, v41
v_and_b32 v41, 0xffff0000, v41
v_pk_mul_f32 v[40:41], v[40:41], v[10:11] op_sel_hi:[1,0]
v_cvt_pk_bf16_f32 v41, v40, v41
v_lshlrev_b32 v40, 16, v41
v_and_b32 v41, 0xffff0000, v41
v_pk_add_f32 v[40:41], v[40:41], v[228:229]
v_cvt_pk_bf16_f32 v26, v40, v41
v_pk_add_f32 v[42:43], v[42:43], v[58:59]
v_pk_add_f32 v[74:75], v[74:75], v[90:91]
v_pk_add_f32 v[42:43], v[42:43], v[74:75]
v_cvt_pk_bf16_f32 v43, v42, v43
v_lshlrev_b32 v42, 16, v43
v_and_b32 v43, 0xffff0000, v43
v_pk_mul_f32 v[42:43], v[42:43], v[10:11] op_sel_hi:[1,0]
v_cvt_pk_bf16_f32 v43, v42, v43
v_lshlrev_b32 v42, 16, v43
v_and_b32 v43, 0xffff0000, v43
v_pk_add_f32 v[42:43], v[42:43], v[236:237]
v_cvt_pk_bf16_f32 v30, v42, v43
s_waitcnt lgkmcnt(0)
v_pk_add_f32 v[44:45], v[44:45], v[60:61]
v_pk_add_f32 v[76:77], v[76:77], v[92:93]
v_pk_add_f32 v[44:45], v[44:45], v[76:77]
v_cvt_pk_bf16_f32 v45, v44, v45
v_lshlrev_b32 v44, 16, v45
v_and_b32 v45, 0xffff0000, v45
v_pk_mul_f32 v[44:45], v[44:45], v[10:11] op_sel_hi:[1,0]
v_cvt_pk_bf16_f32 v45, v44, v45
v_lshlrev_b32 v44, 16, v45
v_and_b32 v45, 0xffff0000, v45
v_pk_add_f32 v[44:45], v[44:45], v[230:231]
v_cvt_pk_bf16_f32 v27, v44, v45
buffer_store_dwordx4 v[24:27], v2, s[28:31], s11 offen offset:0
v_pk_add_f32 v[46:47], v[46:47], v[62:63]
v_pk_add_f32 v[78:79], v[78:79], v[94:95]
v_pk_add_f32 v[46:47], v[46:47], v[78:79]
v_cvt_pk_bf16_f32 v47, v46, v47
v_lshlrev_b32 v46, 16, v47
v_and_b32 v47, 0xffff0000, v47
v_pk_mul_f32 v[46:47], v[46:47], v[10:11] op_sel_hi:[1,0]
v_cvt_pk_bf16_f32 v47, v46, v47
v_lshlrev_b32 v46, 16, v47
v_and_b32 v47, 0xffff0000, v47
v_pk_add_f32 v[46:47], v[46:47], v[238:239]
v_cvt_pk_bf16_f32 v31, v46, v47
buffer_store_dwordx4 v[28:31], v2, s[28:31], s11 offen offset:16
L_end_KN:
s_endpgm
L_own0_KN:
ds_read_b128 v[228:231], v5 offset:0
ds_read_b128 v[232:235], v5 offset:1024
ds_read_b128 v[236:239], v5 offset:2048
ds_read_b128 v[240:243], v5 offset:3072
ds_read_b128 v[244:247], v5 offset:4096
ds_read_b128 v[248:251], v5 offset:5120
ds_read_b128 v[252:255], v5 offset:6144
s_waitcnt lgkmcnt(0)
v_pk_add_f32 v[228:229], v[228:229], v[232:233]
v_pk_add_f32 v[230:231], v[230:231], v[234:235]
v_pk_add_f32 v[236:237], v[236:237], v[240:241]
v_pk_add_f32 v[238:239], v[238:239], v[242:243]
v_pk_add_f32 v[244:245], v[244:245], v[248:249]
v_pk_add_f32 v[246:247], v[246:247], v[250:251]
v_pk_add_f32 v[228:229], v[228:229], v[236:237]
v_pk_add_f32 v[230:231], v[230:231], v[238:239]
v_pk_add_f32 v[244:245], v[244:245], v[252:253]
v_pk_add_f32 v[246:247], v[246:247], v[254:255]
v_pk_add_f32 v[224:225], v[228:229], v[244:245]
v_pk_add_f32 v[226:227], v[230:231], v[246:247]
ds_read_b128 v[228:231], v5 offset:7168
ds_read_b128 v[232:235], v5 offset:8192
ds_read_b128 v[236:239], v5 offset:9216
ds_read_b128 v[240:243], v5 offset:10240
ds_read_b128 v[244:247], v5 offset:11264
ds_read_b128 v[248:251], v5 offset:12288
ds_read_b128 v[252:255], v5 offset:13312
s_waitcnt lgkmcnt(0)
v_pk_add_f32 v[228:229], v[228:229], v[232:233]
v_pk_add_f32 v[230:231], v[230:231], v[234:235]
v_pk_add_f32 v[236:237], v[236:237], v[240:241]
v_pk_add_f32 v[238:239], v[238:239], v[242:243]
v_pk_add_f32 v[244:245], v[244:245], v[248:249]
v_pk_add_f32 v[246:247], v[246:247], v[250:251]
v_pk_add_f32 v[228:229], v[228:229], v[236:237]
v_pk_add_f32 v[230:231], v[230:231], v[238:239]
v_pk_add_f32 v[244:245], v[244:245], v[252:253]
v_pk_add_f32 v[246:247], v[246:247], v[254:255]
v_pk_add_f32 v[224:225], v[224:225], v[228:229]
v_pk_add_f32 v[226:227], v[226:227], v[230:231]
v_pk_add_f32 v[224:225], v[224:225], v[244:245]
v_pk_add_f32 v[226:227], v[226:227], v[246:247]
v_mov_b32 v228, v224
v_mov_b32 v229, v225
v_mov_b32 v230, v226
v_mov_b32 v231, v227
v_permlane16_swap_b32 v224, v228
v_permlane16_swap_b32 v225, v229
v_permlane16_swap_b32 v226, v230
v_permlane16_swap_b32 v227, v231
v_add_f32 v224, v224, v228
v_add_f32 v225, v225, v229
v_add_f32 v226, v226, v230
v_add_f32 v227, v227, v231
v_mov_b32 v228, v224
v_mov_b32 v229, v225
v_mov_b32 v230, v226
v_mov_b32 v231, v227
v_permlane32_swap_b32 v224, v228
v_permlane32_swap_b32 v225, v229
v_permlane32_swap_b32 v226, v230
v_permlane32_swap_b32 v227, v231
v_add_f32 v224, v224, v228
v_add_f32 v225, v225, v229
v_add_f32 v226, v226, v230
v_add_f32 v227, v227, v231
ds_write_b128 v5, v[224:227] offset:28672
s_and_b32 s54, s44, 0xffff0000
s_xor_b32 s55, s54, 0x80000000
s_xor_b32 s56, s54, 0xffff0000
s_bitcmp1_b32 s54, 31
s_cselect_b32 s55, s55, s56
v_mov_b32 v14, s55
v_mul_f32 v14, 0xbfb8aa3b, v14
v_exp_f32 v14, v14
s_nop 0
v_add_f32 v14, 1.0, v14
v_rcp_f32 v14, v14
s_nop 0
v_cvt_pk_bf16_f32 v14, v14, v14
v_and_b32 v14, 0xffff0000, v14
v_cmp_eq_u32 vcc, s46, v3
s_waitcnt lgkmcnt(0)
s_barrier
ds_read_b128 v[224:227], v4 offset:28672
ds_read_b128 v[228:231], v4 offset:28688
ds_read_b128 v[232:235], v4 offset:61440
ds_read_b128 v[236:239], v4 offset:61456
ds_read_b128 v[240:243], v9 offset:28672
ds_read_b128 v[244:247], v9 offset:28688
ds_read_b128 v[248:251], v9 offset:61440
ds_read_b128 v[252:255], v9 offset:61456
s_waitcnt lgkmcnt(0)
v_pk_add_f32 v[224:225], v[224:225], v[232:233]
v_pk_add_f32 v[240:241], v[240:241], v[248:249]
v_pk_add_f32 v[224:225], v[224:225], v[240:241]
v_cvt_pk_bf16_f32 v225, v224, v225
v_lshlrev_b32 v232, 16, v24
v_and_b32 v233, 0xffff0000, v24
v_lshlrev_b32 v224, 16, v225
v_and_b32 v225, 0xffff0000, v225
v_pk_mul_f32 v[224:225], v[224:225], v[14:15] op_sel_hi:[1,0]
v_cvt_pk_bf16_f32 v225, v224, v225
v_lshlrev_b32 v224, 16, v225
v_and_b32 v225, 0xffff0000, v225
v_pk_add_f32 v[224:225], v[224:225], v[232:233]
v_cvt_pk_bf16_f32 v224, v224, v225
v_cndmask_b32 v24, v24, v224, vcc
v_pk_add_f32 v[226:227], v[226:227], v[234:235]
v_pk_add_f32 v[242:243], v[242:243], v[250:251]
v_pk_add_f32 v[226:227], v[226:227], v[242:243]
v_cvt_pk_bf16_f32 v227, v226, v227
v_lshlrev_b32 v234, 16, v25
v_and_b32 v235, 0xffff0000, v25
v_lshlrev_b32 v226, 16, v227
v_and_b32 v227, 0xffff0000, v227
v_pk_mul_f32 v[226:227], v[226:227], v[14:15] op_sel_hi:[1,0]
v_cvt_pk_bf16_f32 v227, v226, v227
v_lshlrev_b32 v226, 16, v227
v_and_b32 v227, 0xffff0000, v227
v_pk_add_f32 v[226:227], v[226:227], v[234:235]
v_cvt_pk_bf16_f32 v226, v226, v227
v_cndmask_b32 v25, v25, v226, vcc
v_pk_add_f32 v[228:229], v[228:229], v[236:237]
v_pk_add_f32 v[244:245], v[244:245], v[252:253]
v_pk_add_f32 v[228:229], v[228:229], v[244:245]
v_cvt_pk_bf16_f32 v229, v228, v229
v_lshlrev_b32 v236, 16, v26
v_and_b32 v237, 0xffff0000, v26
v_lshlrev_b32 v228, 16, v229
v_and_b32 v229, 0xffff0000, v229
v_pk_mul_f32 v[228:229], v[228:229], v[14:15] op_sel_hi:[1,0]
v_cvt_pk_bf16_f32 v229, v228, v229
v_lshlrev_b32 v228, 16, v229
v_and_b32 v229, 0xffff0000, v229
v_pk_add_f32 v[228:229], v[228:229], v[236:237]
v_cvt_pk_bf16_f32 v228, v228, v229
v_cndmask_b32 v26, v26, v228, vcc
v_pk_add_f32 v[230:231], v[230:231], v[238:239]
v_pk_add_f32 v[246:247], v[246:247], v[254:255]
v_pk_add_f32 v[230:231], v[230:231], v[246:247]
v_cvt_pk_bf16_f32 v231, v230, v231
v_lshlrev_b32 v238, 16, v27
v_and_b32 v239, 0xffff0000, v27
v_lshlrev_b32 v230, 16, v231
v_and_b32 v231, 0xffff0000, v231
v_pk_mul_f32 v[230:231], v[230:231], v[14:15] op_sel_hi:[1,0]
v_cvt_pk_bf16_f32 v231, v230, v231
v_lshlrev_b32 v230, 16, v231
v_and_b32 v231, 0xffff0000, v231
v_pk_add_f32 v[230:231], v[230:231], v[238:239]
v_cvt_pk_bf16_f32 v230, v230, v231
v_cndmask_b32 v27, v27, v230, vcc
ds_read_b128 v[224:227], v4 offset:28704
ds_read_b128 v[228:231], v4 offset:28720
ds_read_b128 v[232:235], v4 offset:61472
ds_read_b128 v[236:239], v4 offset:61488
ds_read_b128 v[240:243], v9 offset:28704
ds_read_b128 v[244:247], v9 offset:28720
ds_read_b128 v[248:251], v9 offset:61472
ds_read_b128 v[252:255], v9 offset:61488
s_waitcnt lgkmcnt(0)
v_pk_add_f32 v[224:225], v[224:225], v[232:233]
v_pk_add_f32 v[240:241], v[240:241], v[248:249]
v_pk_add_f32 v[224:225], v[224:225], v[240:241]
v_cvt_pk_bf16_f32 v225, v224, v225
v_lshlrev_b32 v232, 16, v28
v_and_b32 v233, 0xffff0000, v28
v_lshlrev_b32 v224, 16, v225
v_and_b32 v225, 0xffff0000, v225
v_pk_mul_f32 v[224:225], v[224:225], v[14:15] op_sel_hi:[1,0]
v_cvt_pk_bf16_f32 v225, v224, v225
v_lshlrev_b32 v224, 16, v225
v_and_b32 v225, 0xffff0000, v225
v_pk_add_f32 v[224:225], v[224:225], v[232:233]
v_cvt_pk_bf16_f32 v224, v224, v225
v_cndmask_b32 v28, v28, v224, vcc
v_pk_add_f32 v[226:227], v[226:227], v[234:235]
v_pk_add_f32 v[242:243], v[242:243], v[250:251]
v_pk_add_f32 v[226:227], v[226:227], v[242:243]
v_cvt_pk_bf16_f32 v227, v226, v227
v_lshlrev_b32 v234, 16, v29
v_and_b32 v235, 0xffff0000, v29
v_lshlrev_b32 v226, 16, v227
v_and_b32 v227, 0xffff0000, v227
v_pk_mul_f32 v[226:227], v[226:227], v[14:15] op_sel_hi:[1,0]
v_cvt_pk_bf16_f32 v227, v226, v227
v_lshlrev_b32 v226, 16, v227
v_and_b32 v227, 0xffff0000, v227
v_pk_add_f32 v[226:227], v[226:227], v[234:235]
v_cvt_pk_bf16_f32 v226, v226, v227
v_cndmask_b32 v29, v29, v226, vcc
v_pk_add_f32 v[228:229], v[228:229], v[236:237]
v_pk_add_f32 v[244:245], v[244:245], v[252:253]
v_pk_add_f32 v[228:229], v[228:229], v[244:245]
v_cvt_pk_bf16_f32 v229, v228, v229
v_lshlrev_b32 v236, 16, v30
v_and_b32 v237, 0xffff0000, v30
v_lshlrev_b32 v228, 16, v229
v_and_b32 v229, 0xffff0000, v229
v_pk_mul_f32 v[228:229], v[228:229], v[14:15] op_sel_hi:[1,0]
v_cvt_pk_bf16_f32 v229, v228, v229
v_lshlrev_b32 v228, 16, v229
v_and_b32 v229, 0xffff0000, v229
v_pk_add_f32 v[228:229], v[228:229], v[236:237]
v_cvt_pk_bf16_f32 v228, v228, v229
v_cndmask_b32 v30, v30, v228, vcc
v_pk_add_f32 v[230:231], v[230:231], v[238:239]
v_pk_add_f32 v[246:247], v[246:247], v[254:255]
v_pk_add_f32 v[230:231], v[230:231], v[246:247]
v_cvt_pk_bf16_f32 v231, v230, v231
v_lshlrev_b32 v238, 16, v31
v_and_b32 v239, 0xffff0000, v31
v_lshlrev_b32 v230, 16, v231
v_and_b32 v231, 0xffff0000, v231
v_pk_mul_f32 v[230:231], v[230:231], v[14:15] op_sel_hi:[1,0]
v_cvt_pk_bf16_f32 v231, v230, v231
v_lshlrev_b32 v230, 16, v231
v_and_b32 v231, 0xffff0000, v231
v_pk_add_f32 v[230:231], v[230:231], v[238:239]
v_cvt_pk_bf16_f32 v230, v230, v231
v_cndmask_b32 v31, v31, v230, vcc
s_barrier
s_branch L_ownr0_KN
L_own1_KN:
ds_read_b128 v[228:231], v5 offset:14336
ds_read_b128 v[232:235], v5 offset:15360
ds_read_b128 v[236:239], v5 offset:16384
ds_read_b128 v[240:243], v5 offset:17408
ds_read_b128 v[244:247], v5 offset:18432
ds_read_b128 v[248:251], v5 offset:19456
ds_read_b128 v[252:255], v5 offset:20480
s_waitcnt lgkmcnt(0)
v_pk_add_f32 v[228:229], v[228:229], v[232:233]
v_pk_add_f32 v[230:231], v[230:231], v[234:235]
v_pk_add_f32 v[236:237], v[236:237], v[240:241]
v_pk_add_f32 v[238:239], v[238:239], v[242:243]
v_pk_add_f32 v[244:245], v[244:245], v[248:249]
v_pk_add_f32 v[246:247], v[246:247], v[250:251]
v_pk_add_f32 v[228:229], v[228:229], v[236:237]
v_pk_add_f32 v[230:231], v[230:231], v[238:239]
v_pk_add_f32 v[244:245], v[244:245], v[252:253]
v_pk_add_f32 v[246:247], v[246:247], v[254:255]
v_pk_add_f32 v[224:225], v[228:229], v[244:245]
v_pk_add_f32 v[226:227], v[230:231], v[246:247]
ds_read_b128 v[228:231], v5 offset:21504
ds_read_b128 v[232:235], v5 offset:22528
ds_read_b128 v[236:239], v5 offset:23552
ds_read_b128 v[240:243], v5 offset:24576
ds_read_b128 v[244:247], v5 offset:25600
ds_read_b128 v[248:251], v5 offset:26624
ds_read_b128 v[252:255], v5 offset:27648
s_waitcnt lgkmcnt(0)
v_pk_add_f32 v[228:229], v[228:229], v[232:233]
v_pk_add_f32 v[230:231], v[230:231], v[234:235]
v_pk_add_f32 v[236:237], v[236:237], v[240:241]
v_pk_add_f32 v[238:239], v[238:239], v[242:243]
v_pk_add_f32 v[244:245], v[244:245], v[248:249]
v_pk_add_f32 v[246:247], v[246:247], v[250:251]
v_pk_add_f32 v[228:229], v[228:229], v[236:237]
v_pk_add_f32 v[230:231], v[230:231], v[238:239]
v_pk_add_f32 v[244:245], v[244:245], v[252:253]
v_pk_add_f32 v[246:247], v[246:247], v[254:255]
v_pk_add_f32 v[224:225], v[224:225], v[228:229]
v_pk_add_f32 v[226:227], v[226:227], v[230:231]
v_pk_add_f32 v[224:225], v[224:225], v[244:245]
v_pk_add_f32 v[226:227], v[226:227], v[246:247]
v_mov_b32 v228, v224
v_mov_b32 v229, v225
v_mov_b32 v230, v226
v_mov_b32 v231, v227
v_permlane16_swap_b32 v224, v228
v_permlane16_swap_b32 v225, v229
v_permlane16_swap_b32 v226, v230
v_permlane16_swap_b32 v227, v231
v_add_f32 v224, v224, v228
v_add_f32 v225, v225, v229
v_add_f32 v226, v226, v230
v_add_f32 v227, v227, v231
v_mov_b32 v228, v224
v_mov_b32 v229, v225
v_mov_b32 v230, v226
v_mov_b32 v231, v227
v_permlane32_swap_b32 v224, v228
v_permlane32_swap_b32 v225, v229
v_permlane32_swap_b32 v226, v230
v_permlane32_swap_b32 v227, v231
v_add_f32 v224, v224, v228
v_add_f32 v225, v225, v229
v_add_f32 v226, v226, v230
v_add_f32 v227, v227, v231
ds_write_b128 v5, v[224:227] offset:28672
s_and_b32 s54, s45, 0xffff0000
s_xor_b32 s55, s54, 0x80000000
s_xor_b32 s56, s54, 0xffff0000
s_bitcmp1_b32 s54, 31
s_cselect_b32 s55, s55, s56
v_mov_b32 v14, s55
v_mul_f32 v14, 0xbfb8aa3b, v14
v_exp_f32 v14, v14
s_nop 0
v_add_f32 v14, 1.0, v14
v_rcp_f32 v14, v14
s_nop 0
v_cvt_pk_bf16_f32 v14, v14, v14
v_and_b32 v14, 0xffff0000, v14
v_cmp_eq_u32 vcc, s47, v3
s_waitcnt lgkmcnt(0)
s_barrier
ds_read_b128 v[224:227], v4 offset:28672
ds_read_b128 v[228:231], v4 offset:28688
ds_read_b128 v[232:235], v4 offset:61440
ds_read_b128 v[236:239], v4 offset:61456
ds_read_b128 v[240:243], v9 offset:28672
ds_read_b128 v[244:247], v9 offset:28688
ds_read_b128 v[248:251], v9 offset:61440
ds_read_b128 v[252:255], v9 offset:61456
s_waitcnt lgkmcnt(0)
v_pk_add_f32 v[224:225], v[224:225], v[232:233]
v_pk_add_f32 v[240:241], v[240:241], v[248:249]
v_pk_add_f32 v[224:225], v[224:225], v[240:241]
v_cvt_pk_bf16_f32 v225, v224, v225
v_lshlrev_b32 v232, 16, v24
v_and_b32 v233, 0xffff0000, v24
v_lshlrev_b32 v224, 16, v225
v_and_b32 v225, 0xffff0000, v225
v_pk_mul_f32 v[224:225], v[224:225], v[14:15] op_sel_hi:[1,0]
v_cvt_pk_bf16_f32 v225, v224, v225
v_lshlrev_b32 v224, 16, v225
v_and_b32 v225, 0xffff0000, v225
v_pk_add_f32 v[224:225], v[224:225], v[232:233]
v_cvt_pk_bf16_f32 v224, v224, v225
v_cndmask_b32 v24, v24, v224, vcc
v_pk_add_f32 v[226:227], v[226:227], v[234:235]
v_pk_add_f32 v[242:243], v[242:243], v[250:251]
v_pk_add_f32 v[226:227], v[226:227], v[242:243]
v_cvt_pk_bf16_f32 v227, v226, v227
v_lshlrev_b32 v234, 16, v25
v_and_b32 v235, 0xffff0000, v25
v_lshlrev_b32 v226, 16, v227
v_and_b32 v227, 0xffff0000, v227
v_pk_mul_f32 v[226:227], v[226:227], v[14:15] op_sel_hi:[1,0]
v_cvt_pk_bf16_f32 v227, v226, v227
v_lshlrev_b32 v226, 16, v227
v_and_b32 v227, 0xffff0000, v227
v_pk_add_f32 v[226:227], v[226:227], v[234:235]
v_cvt_pk_bf16_f32 v226, v226, v227
v_cndmask_b32 v25, v25, v226, vcc
v_pk_add_f32 v[228:229], v[228:229], v[236:237]
v_pk_add_f32 v[244:245], v[244:245], v[252:253]
v_pk_add_f32 v[228:229], v[228:229], v[244:245]
v_cvt_pk_bf16_f32 v229, v228, v229
v_lshlrev_b32 v236, 16, v26
v_and_b32 v237, 0xffff0000, v26
v_lshlrev_b32 v228, 16, v229
v_and_b32 v229, 0xffff0000, v229
v_pk_mul_f32 v[228:229], v[228:229], v[14:15] op_sel_hi:[1,0]
v_cvt_pk_bf16_f32 v229, v228, v229
v_lshlrev_b32 v228, 16, v229
v_and_b32 v229, 0xffff0000, v229
v_pk_add_f32 v[228:229], v[228:229], v[236:237]
v_cvt_pk_bf16_f32 v228, v228, v229
v_cndmask_b32 v26, v26, v228, vcc
v_pk_add_f32 v[230:231], v[230:231], v[238:239]
v_pk_add_f32 v[246:247], v[246:247], v[254:255]
v_pk_add_f32 v[230:231], v[230:231], v[246:247]
v_cvt_pk_bf16_f32 v231, v230, v231
v_lshlrev_b32 v238, 16, v27
v_and_b32 v239, 0xffff0000, v27
v_lshlrev_b32 v230, 16, v231
v_and_b32 v231, 0xffff0000, v231
v_pk_mul_f32 v[230:231], v[230:231], v[14:15] op_sel_hi:[1,0]
v_cvt_pk_bf16_f32 v231, v230, v231
v_lshlrev_b32 v230, 16, v231
v_and_b32 v231, 0xffff0000, v231
v_pk_add_f32 v[230:231], v[230:231], v[238:239]
v_cvt_pk_bf16_f32 v230, v230, v231
v_cndmask_b32 v27, v27, v230, vcc
ds_read_b128 v[224:227], v4 offset:28704
ds_read_b128 v[228:231], v4 offset:28720
ds_read_b128 v[232:235], v4 offset:61472
ds_read_b128 v[236:239], v4 offset:61488
ds_read_b128 v[240:243], v9 offset:28704
ds_read_b128 v[244:247], v9 offset:28720
ds_read_b128 v[248:251], v9 offset:61472
ds_read_b128 v[252:255], v9 offset:61488
s_waitcnt lgkmcnt(0)
v_pk_add_f32 v[224:225], v[224:225], v[232:233]
v_pk_add_f32 v[240:241], v[240:241], v[248:249]
v_pk_add_f32 v[224:225], v[224:225], v[240:241]
v_cvt_pk_bf16_f32 v225, v224, v225
v_lshlrev_b32 v232, 16, v28
v_and_b32 v233, 0xffff0000, v28
v_lshlrev_b32 v224, 16, v225
v_and_b32 v225, 0xffff0000, v225
v_pk_mul_f32 v[224:225], v[224:225], v[14:15] op_sel_hi:[1,0]
v_cvt_pk_bf16_f32 v225, v224, v225
v_lshlrev_b32 v224, 16, v225
v_and_b32 v225, 0xffff0000, v225
v_pk_add_f32 v[224:225], v[224:225], v[232:233]
v_cvt_pk_bf16_f32 v224, v224, v225
v_cndmask_b32 v28, v28, v224, vcc
v_pk_add_f32 v[226:227], v[226:227], v[234:235]
v_pk_add_f32 v[242:243], v[242:243], v[250:251]
v_pk_add_f32 v[226:227], v[226:227], v[242:243]
v_cvt_pk_bf16_f32 v227, v226, v227
v_lshlrev_b32 v234, 16, v29
v_and_b32 v235, 0xffff0000, v29
v_lshlrev_b32 v226, 16, v227
v_and_b32 v227, 0xffff0000, v227
v_pk_mul_f32 v[226:227], v[226:227], v[14:15] op_sel_hi:[1,0]
v_cvt_pk_bf16_f32 v227, v226, v227
v_lshlrev_b32 v226, 16, v227
v_and_b32 v227, 0xffff0000, v227
v_pk_add_f32 v[226:227], v[226:227], v[234:235]
v_cvt_pk_bf16_f32 v226, v226, v227
v_cndmask_b32 v29, v29, v226, vcc
v_pk_add_f32 v[228:229], v[228:229], v[236:237]
v_pk_add_f32 v[244:245], v[244:245], v[252:253]
v_pk_add_f32 v[228:229], v[228:229], v[244:245]
v_cvt_pk_bf16_f32 v229, v228, v229
v_lshlrev_b32 v236, 16, v30
v_and_b32 v237, 0xffff0000, v30
v_lshlrev_b32 v228, 16, v229
v_and_b32 v229, 0xffff0000, v229
v_pk_mul_f32 v[228:229], v[228:229], v[14:15] op_sel_hi:[1,0]
v_cvt_pk_bf16_f32 v229, v228, v229
v_lshlrev_b32 v228, 16, v229
v_and_b32 v229, 0xffff0000, v229
v_pk_add_f32 v[228:229], v[228:229], v[236:237]
v_cvt_pk_bf16_f32 v228, v228, v229
v_cndmask_b32 v30, v30, v228, vcc
v_pk_add_f32 v[230:231], v[230:231], v[238:239]
v_pk_add_f32 v[246:247], v[246:247], v[254:255]
v_pk_add_f32 v[230:231], v[230:231], v[246:247]
v_cvt_pk_bf16_f32 v231, v230, v231
v_lshlrev_b32 v238, 16, v31
v_and_b32 v239, 0xffff0000, v31
v_lshlrev_b32 v230, 16, v231
v_and_b32 v231, 0xffff0000, v231
v_pk_mul_f32 v[230:231], v[230:231], v[14:15] op_sel_hi:[1,0]
v_cvt_pk_bf16_f32 v231, v230, v231
v_lshlrev_b32 v230, 16, v231
v_and_b32 v231, 0xffff0000, v231
v_pk_add_f32 v[230:231], v[230:231], v[238:239]
v_cvt_pk_bf16_f32 v230, v230, v231
v_cndmask_b32 v31, v31, v230, vcc
s_barrier
s_branch L_ownr1_KN
L_wstub_KN:
s_mov_b32 s17, 0
L_wspin_KN:
s_sleep 8
buffer_load_dword v24, v29, s[36:39], 0 offen offset:12 sc0 sc1
s_waitcnt vmcnt(0)
v_cmp_eq_u32 vcc, 0, v24
s_and_b32 s48, vcc_hi, 0xff
s_or_b32 s48, s48, vcc_lo
s_cbranch_scc0 L_wback_KN
s_add_u32 s17, s17, 1
s_cmp_lt_u32 s17, 0x20000
s_cbranch_scc1 L_wspin_KN
s_branch L_wback_KN
L_cstub_KN:
s_mov_b32 s17, 0
L_cspin_KN:
s_sleep 8
buffer_load_dword v11, v21, s[36:39], s14 offen sc0 sc1
s_waitcnt vmcnt(0)
v_cmp_eq_u32 vcc, 0, v11
s_cmp_eq_u32 vcc_hi, 0
s_cbranch_scc1 L_cback_KN
s_add_u32 s17, s17, 1
s_cmp_lt_u32 s17, 0x20000
s_cbranch_scc1 L_cspin_KN
s_branch L_cback_KN
L_estub_KN:
s_waitcnt vmcnt(0)
s_mov_b64 exec, 1
buffer_store_dword v31, v21, s[36:39], s17 offen sc1
s_mov_b64 exec, -1
s_mov_b64 exec, 1
buffer_store_dword v31, v21, s[36:39], s101 offen sc1
s_mov_b64 exec, -1
s_mov_b32 s49, 0
L_espin_KN:
s_sleep 8
buffer_load_dword v11, v21, s[36:39], s14 offen sc0 sc1
s_waitcnt vmcnt(0)
v_cmp_eq_u32 vcc, 0, v11
s_cmp_eq_u32 vcc_lo, 0
s_cbranch_scc1 L_eback_KN
s_add_u32 s49, s49, 1
s_cmp_lt_u32 s49, 0x20000
s_cbranch_scc1 L_espin_KN
s_branch L_eback_KN
L_ystub_KN:
s_mov_b32 s17, 0
L_yspin_KN:
s_sleep 8
buffer_load_dword v16, v6, s[36:39], 0 offen sc0 sc1
s_waitcnt vmcnt(0)
v_cmp_eq_u32 vcc, 0, v16
s_cbranch_vccz L_yback_KN
s_add_u32 s17, s17, 1
s_cmp_lt_u32 s17, 0x20000
s_cbranch_scc1 L_yspin_KN
s_branch L_yback_KN
L_stub0_KN:
s_call_b64 s[64:65], L_hook_KN
s_branch L_back0_KN
L_stub1_KN:
s_call_b64 s[64:65], L_ev_KN
s_branch L_back1_KN
L_stub2_KN:
s_call_b64 s[64:65], L_hook_KN
s_branch L_back2_KN
L_stub3_KN:
s_call_b64 s[64:65], L_ev_KN
s_branch L_back3_KN
L_stub4_KN:
s_call_b64 s[64:65], L_hook_KN
s_branch L_back4_KN
L_ev_KN:
s_cmp_lt_u32 s44, 27
s_cbranch_scc1 L_ev1_KN
s_cmp_lg_u32 s44, 27
s_cbranch_scc1 L_ev3_KN
s_lshr_b32 s17, s100, 7
s_add_u32 s17, s17, 57262080
buffer_load_dword v24, v21, s[36:39], s17 offen offset:12 sc0 sc1
v_lshlrev_b32 v26, 7, v0
s_branch L_hook_KN
L_ev3_KN:
s_cmp_lg_u32 s44, 29
s_cbranch_scc1 L_ev40_KN
s_waitcnt vmcnt(8)
v_cmp_eq_u32 vcc, 0, v24
s_and_b32 s17, s40, 3
s_mul_i32 s17, s17, 16384
s_add_u32 s17, s17, s100
s_add_u32 s17, s17, 0
s_cmp_lg_u32 vcc_lo, 0
s_cbranch_scc1 L_hook_KN
buffer_load_dword v25, v26, s[36:39], s17 offen
s_add_u32 s17, s17, 8192
buffer_load_dword v25, v26, s[36:39], s17 offen
s_branch L_hook_KN
L_ev40_KN:
s_cmp_lg_u32 s44, 31
s_cbranch_scc1 L_ev1_KN
s_lshl_b32 s48, s41, 2
s_add_u32 s48, s48, s42
v_mov_b32 v29, s48
v_mov_b32 v24, s40
v_cmp_gt_u32 vcc, 32, v0
s_nop 1
v_cndmask_b32 v29, v24, v29, vcc
v_lshl_add_u32 v29, v29, 10, v21
v_add_u32 v29, 57671680, v29
s_cmp_eq_u64 s[32:33], 0
s_cselect_b32 s17, s101, 1073741824
s_cmp_lt_u32 s52, 32
s_cselect_b32 s17, s17, 1073741824
s_cselect_b32 s101, 1073741824, s101
s_waitcnt vmcnt(16)
s_mov_b64 exec, 1
buffer_store_dword v31, v21, s[36:39], s17 offen sc1
s_mov_b64 exec, -1
buffer_load_dword v24, v29, s[36:39], 0 offen offset:12 sc0 sc1
L_ev1_KN:
s_cmp_lg_u32 s44, 15
s_cbranch_scc1 L_ev2_KN
s_waitcnt vmcnt(16)
s_mov_b64 exec, 1
buffer_store_dword v31, v21, s[36:39], s8 offen sc1
s_mov_b64 exec, -1
L_ev2_KN:
s_cmp_lg_u32 s44, 9
s_cbranch_scc1 L_hook_KN
v_accvgpr_read_b32 v11, a160
v_accvgpr_read_b32 v16, a164
v_accvgpr_read_b32 v20, a168
v_accvgpr_read_b32 v29, a172
v_perm_b32 v24, v16, v11, s10
v_perm_b32 v25, v29, v20, s10
v_perm_b32 v26, v16, v11, s11
v_perm_b32 v27, v29, v20, s11
s_nop 0
v_permlane32_swap_b32 v24, v26
v_permlane32_swap_b32 v25, v27
buffer_store_dwordx4 v[24:27], v30, s[36:39], s9 offen offset:0 sc1
v_accvgpr_read_b32 v11, a161
v_accvgpr_read_b32 v16, a165
v_accvgpr_read_b32 v20, a169
v_accvgpr_read_b32 v29, a173
v_perm_b32 v12, v16, v11, s10
v_perm_b32 v13, v29, v20, s10
v_perm_b32 v14, v16, v11, s11
v_perm_b32 v15, v29, v20, s11
s_nop 0
v_permlane32_swap_b32 v12, v14
v_permlane32_swap_b32 v13, v15
buffer_store_dwordx4 v[12:15], v30, s[36:39], s9 offen offset:1024 sc1
v_accvgpr_read_b32 v11, a162
v_accvgpr_read_b32 v16, a166
v_accvgpr_read_b32 v20, a170
v_accvgpr_read_b32 v29, a174
v_perm_b32 v24, v16, v11, s10
v_perm_b32 v25, v29, v20, s10
v_perm_b32 v26, v16, v11, s11
v_perm_b32 v27, v29, v20, s11
s_nop 0
v_permlane32_swap_b32 v24, v26
v_permlane32_swap_b32 v25, v27
buffer_store_dwordx4 v[24:27], v30, s[36:39], s9 offen offset:2048 sc1
v_accvgpr_read_b32 v11, a163
v_accvgpr_read_b32 v16, a167
v_accvgpr_read_b32 v20, a171
v_accvgpr_read_b32 v29, a175
v_perm_b32 v12, v16, v11, s10
v_perm_b32 v13, v29, v20, s10
v_perm_b32 v14, v16, v11, s11
v_perm_b32 v15, v29, v20, s11
s_nop 0
v_permlane32_swap_b32 v12, v14
v_permlane32_swap_b32 v13, v15
buffer_store_dwordx4 v[12:15], v30, s[36:39], s9 offen offset:3072 sc1
s_branch L_hook_KN
L_pstub0_KN:
s_mov_b32 s101, 0
L_pspin0_KN:
s_sleep 4
buffer_load_dword v29, v28, s[36:39], s15 offen offset:4 sc0 sc1
s_waitcnt vmcnt(0)
v_readfirstlane_b32 s48, v29
s_or_b32 s48, s48, s14
s_bitcmp0_b32 s48, 0
s_cbranch_scc0 L_pback0_KN
s_add_u32 s101, s101, 1
s_cmp_lt_u32 s101, 0x20000
s_cbranch_scc1 L_pspin0_KN
s_branch L_pback0_KN
L_pstub1_KN:
s_mov_b32 s101, 0
L_pspin1_KN:
s_sleep 4
buffer_load_dword v29, v28, s[36:39], s15 offen offset:4 sc0 sc1
buffer_load_dword v30, v28, s[36:39], s15 offen offset:8 sc0 sc1
s_waitcnt vmcnt(0)
v_readfirstlane_b32 s48, v29
v_readfirstlane_b32 s17, v30
s_or_b32 s17, s17, s16
s_and_b32 s48, s48, s17
s_or_b32 s48, s48, s14
s_cmp_lg_u32 s48, -1
s_cbranch_scc0 L_pback1_KN
s_add_u32 s101, s101, 1
s_cmp_lt_u32 s101, 0x20000
s_cbranch_scc1 L_pspin1_KN
s_branch L_pback1_KN
L_rstub_KN:
s_mov_b32 s49, 0
L_rspin_KN:
s_sleep 4
buffer_load_dword v29, v33, s[4:7], 0 offen offset:0 sc0 sc1
s_waitcnt vmcnt(0)
v_cmp_ne_u32 vcc, -1, v29
s_add_u32 s49, s49, 1
s_cbranch_vccz L_rback_KN
s_cmp_lt_u32 s49, 0x20000
s_cbranch_scc1 L_rspin_KN
s_branch L_rback_KN
L_spin_KN:
s_mov_b32 s18, 0
L_spinl_KN:
s_sleep 4
buffer_load_dword v29, v28, s[4:7], s101 offen sc0 sc1
s_waitcnt vmcnt(0)
v_readfirstlane_b32 s48, v29
s_add_u32 s18, s18, 1
s_and_b32 s48, s48, s17
s_cmp_eq_u32 s48, s17
s_cbranch_scc1 L_spinx_KN
s_cmp_lt_u32 s18, 0x20000
s_cbranch_scc1 L_spinl_KN
L_spinx_KN:
s_setpc_b64 s[64:65]
L_hook_KN:
s_max_i32 s48, s46, s47
s_lshr_b32 s48, s48, 14
s_cmp_lg_u32 s44, s52
s_cbranch_scc1 L_h1_KN
s_nop 7
v_accvgpr_read_b32 v12, a128
v_accvgpr_read_b32 v14, a132
v_mov_b32 v15, 0x5d800000
v_cmp_nlt_f32 vcc, v12, v15
v_rcp_f32 v12, v12
s_or_b64 s[32:33], s[32:33], vcc
v_cmp_nlt_f32 vcc, v14, v15
v_rcp_f32 v14, v14
s_or_b64 s[32:33], s[32:33], vcc
v_pk_mul_f32 v[128:129], v[128:129], v[12:13] op_sel_hi:[1,0]
v_pk_mul_f32 v[130:131], v[130:131], v[12:13] op_sel_hi:[1,0]
v_pk_mul_f32 v[144:145], v[144:145], v[12:13] op_sel_hi:[1,0]
v_pk_mul_f32 v[146:147], v[146:147], v[12:13] op_sel_hi:[1,0]
v_cvt_pk_bf16_f32 v128, v128, v129
v_cvt_pk_bf16_f32 v129, v130, v131
v_cvt_pk_bf16_f32 v130, v144, v145
v_cvt_pk_bf16_f32 v131, v146, v147
buffer_store_dwordx4 v[128:131], v21, s[36:39], s66 offen offset:0 sc1
v_pk_mul_f32 v[160:161], v[160:161], v[12:13] op_sel_hi:[1,0]
v_pk_mul_f32 v[162:163], v[162:163], v[12:13] op_sel_hi:[1,0]
v_pk_mul_f32 v[176:177], v[176:177], v[12:13] op_sel_hi:[1,0]
v_pk_mul_f32 v[178:179], v[178:179], v[12:13] op_sel_hi:[1,0]
v_cvt_pk_bf16_f32 v160, v160, v161
v_cvt_pk_bf16_f32 v161, v162, v163
v_cvt_pk_bf16_f32 v162, v176, v177
v_cvt_pk_bf16_f32 v163, v178, v179
buffer_store_dwordx4 v[160:163], v21, s[36:39], s66 offen offset:1024 sc1
v_pk_mul_f32 v[192:193], v[192:193], v[12:13] op_sel_hi:[1,0]
v_pk_mul_f32 v[194:195], v[194:195], v[12:13] op_sel_hi:[1,0]
v_pk_mul_f32 v[208:209], v[208:209], v[12:13] op_sel_hi:[1,0]
v_pk_mul_f32 v[210:211], v[210:211], v[12:13] op_sel_hi:[1,0]
v_cvt_pk_bf16_f32 v192, v192, v193
v_cvt_pk_bf16_f32 v193, v194, v195
v_cvt_pk_bf16_f32 v194, v208, v209
v_cvt_pk_bf16_f32 v195, v210, v211
buffer_store_dwordx4 v[192:195], v21, s[36:39], s66 offen offset:2048 sc1
v_pk_mul_f32 v[224:225], v[224:225], v[12:13] op_sel_hi:[1,0]
v_pk_mul_f32 v[226:227], v[226:227], v[12:13] op_sel_hi:[1,0]
v_pk_mul_f32 v[240:241], v[240:241], v[12:13] op_sel_hi:[1,0]
v_pk_mul_f32 v[242:243], v[242:243], v[12:13] op_sel_hi:[1,0]
v_cvt_pk_bf16_f32 v224, v224, v225
v_cvt_pk_bf16_f32 v225, v226, v227
v_cvt_pk_bf16_f32 v226, v240, v241
v_cvt_pk_bf16_f32 v227, v242, v243
buffer_store_dwordx4 v[224:227], v21, s[36:39], s66 offen offset:3072 sc1
s_add_u32 s18, s66, 131072
v_pk_mul_f32 v[132:133], v[132:133], v[14:15] op_sel_hi:[1,0]
v_pk_mul_f32 v[134:135], v[134:135], v[14:15] op_sel_hi:[1,0]
v_pk_mul_f32 v[148:149], v[148:149], v[14:15] op_sel_hi:[1,0]
v_pk_mul_f32 v[150:151], v[150:151], v[14:15] op_sel_hi:[1,0]
v_cvt_pk_bf16_f32 v132, v132, v133
v_cvt_pk_bf16_f32 v133, v134, v135
v_cvt_pk_bf16_f32 v134, v148, v149
v_cvt_pk_bf16_f32 v135, v150, v151
buffer_store_dwordx4 v[132:135], v21, s[36:39], s18 offen offset:0 sc1
v_pk_mul_f32 v[164:165], v[164:165], v[14:15] op_sel_hi:[1,0]
v_pk_mul_f32 v[166:167], v[166:167], v[14:15] op_sel_hi:[1,0]
v_pk_mul_f32 v[180:181], v[180:181], v[14:15] op_sel_hi:[1,0]
v_pk_mul_f32 v[182:183], v[182:183], v[14:15] op_sel_hi:[1,0]
v_cvt_pk_bf16_f32 v164, v164, v165
v_cvt_pk_bf16_f32 v165, v166, v167
v_cvt_pk_bf16_f32 v166, v180, v181
v_cvt_pk_bf16_f32 v167, v182, v183
buffer_store_dwordx4 v[164:167], v21, s[36:39], s18 offen offset:1024 sc1
v_pk_mul_f32 v[196:197], v[196:197], v[14:15] op_sel_hi:[1,0]
v_pk_mul_f32 v[198:199], v[198:199], v[14:15] op_sel_hi:[1,0]
v_pk_mul_f32 v[212:213], v[212:213], v[14:15] op_sel_hi:[1,0]
v_pk_mul_f32 v[214:215], v[214:215], v[14:15] op_sel_hi:[1,0]
v_cvt_pk_bf16_f32 v196, v196, v197
v_cvt_pk_bf16_f32 v197, v198, v199
v_cvt_pk_bf16_f32 v198, v212, v213
v_cvt_pk_bf16_f32 v199, v214, v215
buffer_store_dwordx4 v[196:199], v21, s[36:39], s18 offen offset:2048 sc1
v_pk_mul_f32 v[228:229], v[228:229], v[14:15] op_sel_hi:[1,0]
v_pk_mul_f32 v[230:231], v[230:231], v[14:15] op_sel_hi:[1,0]
v_pk_mul_f32 v[244:245], v[244:245], v[14:15] op_sel_hi:[1,0]
v_pk_mul_f32 v[246:247], v[246:247], v[14:15] op_sel_hi:[1,0]
v_cvt_pk_bf16_f32 v228, v228, v229
v_cvt_pk_bf16_f32 v229, v230, v231
v_cvt_pk_bf16_f32 v230, v244, v245
v_cvt_pk_bf16_f32 v231, v246, v247
buffer_store_dwordx4 v[228:231], v21, s[36:39], s18 offen offset:3072 sc1
v_accvgpr_write_b32 a128, 0
v_accvgpr_write_b32 a129, 0
v_accvgpr_write_b32 a130, 0
v_accvgpr_write_b32 a131, 0
v_accvgpr_write_b32 a132, 0
v_accvgpr_write_b32 a133, 0
v_accvgpr_write_b32 a134, 0
v_accvgpr_write_b32 a135, 0
v_mov_b64 v[128:129], 0
v_mov_b64 v[130:131], 0
v_mov_b64 v[132:133], 0
v_mov_b64 v[134:135], 0
v_mov_b64 v[144:145], 0
v_mov_b64 v[146:147], 0
v_mov_b64 v[148:149], 0
v_mov_b64 v[150:151], 0
v_mov_b64 v[160:161], 0
v_mov_b64 v[162:163], 0
v_mov_b64 v[164:165], 0
v_mov_b64 v[166:167], 0
v_mov_b64 v[176:177], 0
v_mov_b64 v[178:179], 0
v_mov_b64 v[180:181], 0
v_mov_b64 v[182:183], 0
v_mov_b64 v[192:193], 0
v_mov_b64 v[194:195], 0
v_mov_b64 v[196:197], 0
v_mov_b64 v[198:199], 0
v_mov_b64 v[208:209], 0
v_mov_b64 v[210:211], 0
v_mov_b64 v[212:213], 0
v_mov_b64 v[214:215], 0
v_mov_b64 v[224:225], 0
v_mov_b64 v[226:227], 0
v_mov_b64 v[228:229], 0
v_mov_b64 v[230:231], 0
v_mov_b64 v[240:241], 0
v_mov_b64 v[242:243], 0
v_mov_b64 v[244:245], 0
v_mov_b64 v[246:247], 0
L_h1_KN:
s_add_u32 s18, s44, 1
s_cmp_lg_u32 s18, s52
s_cbranch_scc1 L_h2_KN
ds_read_b128 a[64:67], v17 offset:0
ds_read_b128 a[68:71], v17 offset:1024
ds_read_b128 a[72:75], v17 offset:2048
ds_read_b128 a[76:79], v17 offset:3072
ds_read_b128 a[80:83], v17 offset:4096
ds_read_b128 a[84:87], v17 offset:5120
ds_read_b128 a[88:91], v17 offset:6144
ds_read_b128 a[92:95], v17 offset:7168
v_mov_b32 v4, v8
v_mov_b32 v96, v8
v_mov_b32 v97, v8
v_mov_b32 v98, v8
v_mov_b32 v99, v8
v_mov_b32 v112, v8
v_mov_b32 v113, v8
v_mov_b32 v114, v8
v_mov_b32 v115, v8
v_mov_b32 v5, v9
v_mov_b32 v100, v9
v_mov_b32 v101, v9
v_mov_b32 v102, v9
v_mov_b32 v103, v9
v_mov_b32 v116, v9
v_mov_b32 v117, v9
v_mov_b32 v118, v9
v_mov_b32 v119, v9
s_mov_b32 s53, s55
s_waitcnt lgkmcnt(0)
L_h2_KN:
s_cmp_lt_u32 s48, s53
s_cbranch_scc1 L_hd0_KN
s_cmp_eq_u32 s48, s53
s_cbranch_scc1 L_hg0_KN
v_mov_b32 v96, v10
v_mov_b32 v97, v10
v_mov_b32 v98, v10
v_mov_b32 v99, v10
v_mov_b32 v100, v10
v_mov_b32 v101, v10
v_mov_b32 v102, v10
v_mov_b32 v103, v10
v_mov_b32 v112, v10
v_mov_b32 v113, v10
v_mov_b32 v114, v10
v_mov_b32 v115, v10
v_mov_b32 v116, v10
v_mov_b32 v117, v10
v_mov_b32 v118, v10
v_mov_b32 v119, v10
s_branch L_hd0_KN
L_hg0_KN:
v_cndmask_b32 v96, v10, v4, s[56:57]
v_mov_b32 v112, v10
v_cndmask_b32 v116, v10, v5, s[56:57]
v_cndmask_b32 v97, v10, v4, s[58:59]
v_mov_b32 v113, v10
v_cndmask_b32 v117, v10, v5, s[58:59]
v_cndmask_b32 v98, v10, v4, s[60:61]
v_mov_b32 v114, v10
v_cndmask_b32 v118, v10, v5, s[60:61]
v_cndmask_b32 v99, v10, v4, s[62:63]
v_mov_b32 v115, v10
v_cndmask_b32 v119, v10, v5, s[62:63]
L_hd0_KN:
s_cmp_lt_u32 s48, s54
s_cbranch_scc1 L_hd1_KN
s_cmp_eq_u32 s48, s54
s_cbranch_scc1 L_hg1_KN
v_mov_b32 v104, v10
v_mov_b32 v105, v10
v_mov_b32 v106, v10
v_mov_b32 v107, v10
v_mov_b32 v108, v10
v_mov_b32 v109, v10
v_mov_b32 v110, v10
v_mov_b32 v111, v10
v_mov_b32 v120, v10
v_mov_b32 v121, v10
v_mov_b32 v122, v10
v_mov_b32 v123, v10
v_mov_b32 v124, v10
v_mov_b32 v125, v10
v_mov_b32 v126, v10
v_mov_b32 v127, v10
s_branch L_hd1_KN
L_hg1_KN:
v_cndmask_b32 v104, v10, v6, s[56:57]
v_mov_b32 v120, v10
v_cndmask_b32 v124, v10, v7, s[56:57]
v_cndmask_b32 v105, v10, v6, s[58:59]
v_mov_b32 v121, v10
v_cndmask_b32 v125, v10, v7, s[58:59]
v_cndmask_b32 v106, v10, v6, s[60:61]
v_mov_b32 v122, v10
v_cndmask_b32 v126, v10, v7, s[60:61]
v_cndmask_b32 v107, v10, v6, s[62:63]
v_mov_b32 v123, v10
v_cndmask_b32 v127, v10, v7, s[62:63]
L_hd1_KN:
s_nop 1
s_setpc_b64 s[64:65]
L_slow_KN:
s_waitcnt vmcnt(0)
s_cmp_eq_u64 s[32:33], 0
s_cbranch_scc1 L_slow1_KN
s_mov_b32 s12, s19
s_mov_b32 s13, s66
s_call_b64 s[64:65], L_sub_KN
L_slow1_KN:
s_cmp_eq_u64 s[34:35], 0
s_cbranch_scc1 L_fin_KN
s_mov_b32 s12, s54
s_mov_b32 s13, s67
s_call_b64 s[64:65], L_sub_KN
s_branch L_fin_KN
L_sub_KN:
v_and_b32 v16, 15, v0
v_lshrrev_b32 v17, 4, v0
v_lshlrev_b32 v2, 10, v16
v_lshl_or_b32 v2, v17, 4, v2
v_lshlrev_b32 v3, 16, v17
v_lshl_or_b32 v3, v16, 1, v3
v_mov_b32 v128, 0
v_mov_b32 v129, 0
v_mov_b32 v130, 0
v_mov_b32 v131, 0
v_mov_b32 v132, 0
v_mov_b32 v133, 0
v_mov_b32 v134, 0
v_mov_b32 v135, 0
v_mov_b32 v144, 0
v_mov_b32 v145, 0
v_mov_b32 v146, 0
v_mov_b32 v147, 0
v_mov_b32 v148, 0
v_mov_b32 v149, 0
v_mov_b32 v150, 0
v_mov_b32 v151, 0
v_mov_b32 v160, 0
v_mov_b32 v161, 0
v_mov_b32 v162, 0
v_mov_b32 v163, 0
v_mov_b32 v164, 0
v_mov_b32 v165, 0
v_mov_b32 v166, 0
v_mov_b32 v167, 0
v_mov_b32 v176, 0
v_mov_b32 v177, 0
v_mov_b32 v178, 0
v_mov_b32 v179, 0
v_mov_b32 v180, 0
v_mov_b32 v181, 0
v_mov_b32 v182, 0
v_mov_b32 v183, 0
v_mov_b32 v192, 0
v_mov_b32 v193, 0
v_mov_b32 v194, 0
v_mov_b32 v195, 0
v_mov_b32 v196, 0
v_mov_b32 v197, 0
v_mov_b32 v198, 0
v_mov_b32 v199, 0
v_mov_b32 v208, 0
v_mov_b32 v209, 0
v_mov_b32 v210, 0
v_mov_b32 v211, 0
v_mov_b32 v212, 0
v_mov_b32 v213, 0
v_mov_b32 v214, 0
v_mov_b32 v215, 0
v_mov_b32 v224, 0
v_mov_b32 v225, 0
v_mov_b32 v226, 0
v_mov_b32 v227, 0
v_mov_b32 v228, 0
v_mov_b32 v229, 0
v_mov_b32 v230, 0
v_mov_b32 v231, 0
v_mov_b32 v240, 0
v_mov_b32 v241, 0
v_mov_b32 v242, 0
v_mov_b32 v243, 0
v_mov_b32 v244, 0
v_mov_b32 v245, 0
v_mov_b32 v246, 0
v_mov_b32 v247, 0
s_lshl_b32 s14, s12, 15
s_lshl_b32 s15, s40, 8
s_mov_b32 s44, 0
L_sq_KN:
buffer_load_dwordx4 v[64:67], v2, s[20:23], s14 offen
s_add_u32 s48, s14, 16384
buffer_load_dwordx4 v[68:71], v2, s[20:23], s48 offen
buffer_load_ushort v32, v3, s[24:27], s15 offen offset:0
buffer_load_ushort v36, v3, s[24:27], s15 offen offset:32
buffer_load_ushort v40, v3, s[24:27], s15 offen offset:64
buffer_load_ushort v44, v3, s[24:27], s15 offen offset:96
buffer_load_ushort v48, v3, s[24:27], s15 offen offset:128
buffer_load_ushort v52, v3, s[24:27], s15 offen offset:160
buffer_load_ushort v56, v3, s[24:27], s15 offen offset:192
buffer_load_ushort v60, v3, s[24:27], s15 offen offset:224
s_add_u32 s15, s15, 8192
buffer_load_ushort v72, v3, s[24:27], s15 offen offset:0
buffer_load_ushort v73, v3, s[24:27], s15 offen offset:32
buffer_load_ushort v74, v3, s[24:27], s15 offen offset:64
buffer_load_ushort v75, v3, s[24:27], s15 offen offset:96
buffer_load_ushort v76, v3, s[24:27], s15 offen offset:128
buffer_load_ushort v77, v3, s[24:27], s15 offen offset:160
buffer_load_ushort v78, v3, s[24:27], s15 offen offset:192
buffer_load_ushort v79, v3, s[24:27], s15 offen offset:224
s_add_u32 s15, s15, 8192
s_waitcnt vmcnt(0)
v_lshl_or_b32 v32, v72, 16, v32
v_lshl_or_b32 v36, v73, 16, v36
v_lshl_or_b32 v40, v74, 16, v40
v_lshl_or_b32 v44, v75, 16, v44
v_lshl_or_b32 v48, v76, 16, v48
v_lshl_or_b32 v52, v77, 16, v52
v_lshl_or_b32 v56, v78, 16, v56
v_lshl_or_b32 v60, v79, 16, v60
buffer_load_ushort v33, v3, s[24:27], s15 offen offset:0
buffer_load_ushort v37, v3, s[24:27], s15 offen offset:32
buffer_load_ushort v41, v3, s[24:27], s15 offen offset:64
buffer_load_ushort v45, v3, s[24:27], s15 offen offset:96
buffer_load_ushort v49, v3, s[24:27], s15 offen offset:128
buffer_load_ushort v53, v3, s[24:27], s15 offen offset:160
buffer_load_ushort v57, v3, s[24:27], s15 offen offset:192
buffer_load_ushort v61, v3, s[24:27], s15 offen offset:224
s_add_u32 s15, s15, 8192
buffer_load_ushort v72, v3, s[24:27], s15 offen offset:0
buffer_load_ushort v73, v3, s[24:27], s15 offen offset:32
buffer_load_ushort v74, v3, s[24:27], s15 offen offset:64
buffer_load_ushort v75, v3, s[24:27], s15 offen offset:96
buffer_load_ushort v76, v3, s[24:27], s15 offen offset:128
buffer_load_ushort v77, v3, s[24:27], s15 offen offset:160
buffer_load_ushort v78, v3, s[24:27], s15 offen offset:192
buffer_load_ushort v79, v3, s[24:27], s15 offen offset:224
s_add_u32 s15, s15, 8192
s_waitcnt vmcnt(0)
v_lshl_or_b32 v33, v72, 16, v33
v_lshl_or_b32 v37, v73, 16, v37
v_lshl_or_b32 v41, v74, 16, v41
v_lshl_or_b32 v45, v75, 16, v45
v_lshl_or_b32 v49, v76, 16, v49
v_lshl_or_b32 v53, v77, 16, v53
v_lshl_or_b32 v57, v78, 16, v57
v_lshl_or_b32 v61, v79, 16, v61
buffer_load_ushort v34, v3, s[24:27], s15 offen offset:0
buffer_load_ushort v38, v3, s[24:27], s15 offen offset:32
buffer_load_ushort v42, v3, s[24:27], s15 offen offset:64
buffer_load_ushort v46, v3, s[24:27], s15 offen offset:96
buffer_load_ushort v50, v3, s[24:27], s15 offen offset:128
buffer_load_ushort v54, v3, s[24:27], s15 offen offset:160
buffer_load_ushort v58, v3, s[24:27], s15 offen offset:192
buffer_load_ushort v62, v3, s[24:27], s15 offen offset:224
s_add_u32 s15, s15, 8192
buffer_load_ushort v72, v3, s[24:27], s15 offen offset:0
buffer_load_ushort v73, v3, s[24:27], s15 offen offset:32
buffer_load_ushort v74, v3, s[24:27], s15 offen offset:64
buffer_load_ushort v75, v3, s[24:27], s15 offen offset:96
buffer_load_ushort v76, v3, s[24:27], s15 offen offset:128
buffer_load_ushort v77, v3, s[24:27], s15 offen offset:160
buffer_load_ushort v78, v3, s[24:27], s15 offen offset:192
buffer_load_ushort v79, v3, s[24:27], s15 offen offset:224
s_add_u32 s15, s15, 8192
s_waitcnt vmcnt(0)
v_lshl_or_b32 v34, v72, 16, v34
v_lshl_or_b32 v38, v73, 16, v38
v_lshl_or_b32 v42, v74, 16, v42
v_lshl_or_b32 v46, v75, 16, v46
v_lshl_or_b32 v50, v76, 16, v50
v_lshl_or_b32 v54, v77, 16, v54
v_lshl_or_b32 v58, v78, 16, v58
v_lshl_or_b32 v62, v79, 16, v62
buffer_load_ushort v35, v3, s[24:27], s15 offen offset:0
buffer_load_ushort v39, v3, s[24:27], s15 offen offset:32
buffer_load_ushort v43, v3, s[24:27], s15 offen offset:64
buffer_load_ushort v47, v3, s[24:27], s15 offen offset:96
buffer_load_ushort v51, v3, s[24:27], s15 offen offset:128
buffer_load_ushort v55, v3, s[24:27], s15 offen offset:160
buffer_load_ushort v59, v3, s[24:27], s15 offen offset:192
buffer_load_ushort v63, v3, s[24:27], s15 offen offset:224
s_add_u32 s15, s15, 8192
buffer_load_ushort v72, v3, s[24:27], s15 offen offset:0
buffer_load_ushort v73, v3, s[24:27], s15 offen offset:32
buffer_load_ushort v74, v3, s[24:27], s15 offen offset:64
buffer_load_ushort v75, v3, s[24:27], s15 offen offset:96
buffer_load_ushort v76, v3, s[24:27], s15 offen offset:128
buffer_load_ushort v77, v3, s[24:27], s15 offen offset:160
buffer_load_ushort v78, v3, s[24:27], s15 offen offset:192
buffer_load_ushort v79, v3, s[24:27], s15 offen offset:224
s_add_u32 s15, s15, 8192
s_waitcnt vmcnt(0)
v_lshl_or_b32 v35, v72, 16, v35
v_lshl_or_b32 v39, v73, 16, v39
v_lshl_or_b32 v43, v74, 16, v43
v_lshl_or_b32 v47, v75, 16, v47
v_lshl_or_b32 v51, v76, 16, v51
v_lshl_or_b32 v55, v77, 16, v55
v_lshl_or_b32 v59, v78, 16, v59
v_lshl_or_b32 v63, v79, 16, v63
s_nop 1
v_mfma_f32_16x16x32_bf16 v[128:131], v[32:35], v[64:67], v[128:131]
v_mfma_f32_16x16x32_bf16 v[132:135], v[32:35], v[68:71], v[132:135]
v_mfma_f32_16x16x32_bf16 v[144:147], v[36:39], v[64:67], v[144:147]
v_mfma_f32_16x16x32_bf16 v[148:151], v[36:39], v[68:71], v[148:151]
v_mfma_f32_16x16x32_bf16 v[160:163], v[40:43], v[64:67], v[160:163]
v_mfma_f32_16x16x32_bf16 v[164:167], v[40:43], v[68:71], v[164:167]
v_mfma_f32_16x16x32_bf16 v[176:179], v[44:47], v[64:67], v[176:179]
v_mfma_f32_16x16x32_bf16 v[180:183], v[44:47], v[68:71], v[180:183]
v_mfma_f32_16x16x32_bf16 v[192:195], v[48:51], v[64:67], v[192:195]
v_mfma_f32_16x16x32_bf16 v[196:199], v[48:51], v[68:71], v[196:199]
v_mfma_f32_16x16x32_bf16 v[208:211], v[52:55], v[64:67], v[208:211]
v_mfma_f32_16x16x32_bf16 v[212:215], v[52:55], v[68:71], v[212:215]
v_mfma_f32_16x16x32_bf16 v[224:227], v[56:59], v[64:67], v[224:227]
v_mfma_f32_16x16x32_bf16 v[228:231], v[56:59], v[68:71], v[228:231]
v_mfma_f32_16x16x32_bf16 v[240:243], v[60:63], v[64:67], v[240:243]
v_mfma_f32_16x16x32_bf16 v[244:247], v[60:63], v[68:71], v[244:247]
s_add_u32 s15, s15, 196608
s_add_u32 s14, s14, 64
s_add_u32 s44, s44, 1
s_nop 7
s_cmp_lt_u32 s44, 16
s_cbranch_scc1 L_sq_KN
v_cvt_pk_bf16_f32 v136, v128, v129
v_cvt_pk_bf16_f32 v137, v130, v131
v_cvt_pk_bf16_f32 v138, v144, v145
v_cvt_pk_bf16_f32 v139, v146, v147
v_cvt_pk_bf16_f32 v168, v160, v161
v_cvt_pk_bf16_f32 v169, v162, v163
v_cvt_pk_bf16_f32 v170, v176, v177
v_cvt_pk_bf16_f32 v171, v178, v179
v_cvt_pk_bf16_f32 v200, v192, v193
v_cvt_pk_bf16_f32 v201, v194, v195
v_cvt_pk_bf16_f32 v202, v208, v209
v_cvt_pk_bf16_f32 v203, v210, v211
v_cvt_pk_bf16_f32 v232, v224, v225
v_cvt_pk_bf16_f32 v233, v226, v227
v_cvt_pk_bf16_f32 v234, v240, v241
v_cvt_pk_bf16_f32 v235, v242, v243
v_cvt_pk_bf16_f32 v140, v132, v133
v_cvt_pk_bf16_f32 v141, v134, v135
v_cvt_pk_bf16_f32 v142, v148, v149
v_cvt_pk_bf16_f32 v143, v150, v151
v_cvt_pk_bf16_f32 v172, v164, v165
v_cvt_pk_bf16_f32 v173, v166, v167
v_cvt_pk_bf16_f32 v174, v180, v181
v_cvt_pk_bf16_f32 v175, v182, v183
v_cvt_pk_bf16_f32 v204, v196, v197
v_cvt_pk_bf16_f32 v205, v198, v199
v_cvt_pk_bf16_f32 v206, v212, v213
v_cvt_pk_bf16_f32 v207, v214, v215
v_cvt_pk_bf16_f32 v236, v228, v229
v_cvt_pk_bf16_f32 v237, v230, v231
v_cvt_pk_bf16_f32 v238, v244, v245
v_cvt_pk_bf16_f32 v239, v246, v247
v_mov_b32 v128, 0
v_mov_b32 v129, 0
v_mov_b32 v130, 0
v_mov_b32 v131, 0
v_mov_b32 v132, 0
v_mov_b32 v133, 0
v_mov_b32 v134, 0
v_mov_b32 v135, 0
v_mov_b32 v144, 0
v_mov_b32 v145, 0
v_mov_b32 v146, 0
v_mov_b32 v147, 0
v_mov_b32 v148, 0
v_mov_b32 v149, 0
v_mov_b32 v150, 0
v_mov_b32 v151, 0
v_mov_b32 v160, 0
v_mov_b32 v161, 0
v_mov_b32 v162, 0
v_mov_b32 v163, 0
v_mov_b32 v164, 0
v_mov_b32 v165, 0
v_mov_b32 v166, 0
v_mov_b32 v167, 0
v_mov_b32 v176, 0
v_mov_b32 v177, 0
v_mov_b32 v178, 0
v_mov_b32 v179, 0
v_mov_b32 v180, 0
v_mov_b32 v181, 0
v_mov_b32 v182, 0
v_mov_b32 v183, 0
v_mov_b32 v192, 0
v_mov_b32 v193, 0
v_mov_b32 v194, 0
v_mov_b32 v195, 0
v_mov_b32 v196, 0
v_mov_b32 v197, 0
v_mov_b32 v198, 0
v_mov_b32 v199, 0
v_mov_b32 v208, 0
v_mov_b32 v209, 0
v_mov_b32 v210, 0
v_mov_b32 v211, 0
v_mov_b32 v212, 0
v_mov_b32 v213, 0
v_mov_b32 v214, 0
v_mov_b32 v215, 0
v_mov_b32 v224, 0
v_mov_b32 v225, 0
v_mov_b32 v226, 0
v_mov_b32 v227, 0
v_mov_b32 v228, 0
v_mov_b32 v229, 0
v_mov_b32 v230, 0
v_mov_b32 v231, 0
v_mov_b32 v240, 0
v_mov_b32 v241, 0
v_mov_b32 v242, 0
v_mov_b32 v243, 0
v_mov_b32 v244, 0
v_mov_b32 v245, 0
v_mov_b32 v246, 0
v_mov_b32 v247, 0
v_mov_b32 v4, 0xff800000
v_mov_b32 v6, 0
v_mov_b32 v5, 0xff800000
v_mov_b32 v8, 0
s_lshl_b32 s14, s40, 19
s_mov_b32 s44, 0
L_su_KN:
s_add_u32 s48, s14, 0
buffer_load_dwordx4 v[32:35], v21, s[36:39], s48 offen offset:0
buffer_load_dwordx4 v[36:39], v21, s[36:39], s48 offen offset:1024
buffer_load_dwordx4 v[40:43], v21, s[36:39], s48 offen offset:2048
buffer_load_dwordx4 v[44:47], v21, s[36:39], s48 offen offset:3072
s_add_u32 s48, s14, 16777216
buffer_load_dwordx4 v[64:67], v21, s[36:39], s48 offen offset:0
buffer_load_dwordx4 v[68:71], v21, s[36:39], s48 offen offset:1024
buffer_load_dwordx4 v[72:75], v21, s[36:39], s48 offen offset:2048
buffer_load_dwordx4 v[76:79], v21, s[36:39], s48 offen offset:3072
s_add_u32 s48, s14, 4096
buffer_load_dwordx4 v[48:51], v21, s[36:39], s48 offen offset:0
buffer_load_dwordx4 v[52:55], v21, s[36:39], s48 offen offset:1024
buffer_load_dwordx4 v[56:59], v21, s[36:39], s48 offen offset:2048
buffer_load_dwordx4 v[60:63], v21, s[36:39], s48 offen offset:3072
s_add_u32 s48, s14, 16781312
buffer_load_dwordx4 v[80:83], v21, s[36:39], s48 offen offset:0
buffer_load_dwordx4 v[84:87], v21, s[36:39], s48 offen offset:1024
buffer_load_dwordx4 v[88:91], v21, s[36:39], s48 offen offset:2048
buffer_load_dwordx4 v[92:95], v21, s[36:39], s48 offen offset:3072
s_waitcnt vmcnt(0)
v_mfma_f32_16x16x32_bf16 v[96:99], v[32:35], v[136:139], 0
v_mfma_f32_16x16x32_bf16 v[100:103], v[32:35], v[140:143], 0
v_mfma_f32_16x16x32_bf16 v[104:107], v[48:51], v[136:139], 0
v_mfma_f32_16x16x32_bf16 v[108:111], v[48:51], v[140:143], 0
v_mfma_f32_16x16x32_bf16 v[96:99], v[36:39], v[168:171], v[96:99]
v_mfma_f32_16x16x32_bf16 v[100:103], v[36:39], v[172:175], v[100:103]
v_mfma_f32_16x16x32_bf16 v[104:107], v[52:55], v[168:171], v[104:107]
v_mfma_f32_16x16x32_bf16 v[108:111], v[52:55], v[172:175], v[108:111]
v_mfma_f32_16x16x32_bf16 v[96:99], v[40:43], v[200:203], v[96:99]
v_mfma_f32_16x16x32_bf16 v[100:103], v[40:43], v[204:207], v[100:103]
v_mfma_f32_16x16x32_bf16 v[104:107], v[56:59], v[200:203], v[104:107]
v_mfma_f32_16x16x32_bf16 v[108:111], v[56:59], v[204:207], v[108:111]
v_mfma_f32_16x16x32_bf16 v[96:99], v[44:47], v[232:235], v[96:99]
v_mfma_f32_16x16x32_bf16 v[100:103], v[44:47], v[236:239], v[100:103]
v_mfma_f32_16x16x32_bf16 v[104:107], v[60:63], v[232:235], v[104:107]
v_mfma_f32_16x16x32_bf16 v[108:111], v[60:63], v[236:239], v[108:111]
s_nop 7
s_cmp_lg_u32 s44, s12
s_cbranch_scc1 L_snd_KN
v_cndmask_b32 v96, v10, v96, s[56:57]
v_mov_b32 v104, v10
v_cndmask_b32 v108, v10, v108, s[56:57]
v_cndmask_b32 v97, v10, v97, s[58:59]
v_mov_b32 v105, v10
v_cndmask_b32 v109, v10, v109, s[58:59]
v_cndmask_b32 v98, v10, v98, s[60:61]
v_mov_b32 v106, v10
v_cndmask_b32 v110, v10, v110, s[60:61]
v_cndmask_b32 v99, v10, v99, s[62:63]
v_mov_b32 v107, v10
v_cndmask_b32 v111, v10, v111, s[62:63]
L_snd_KN:
v_max3_f32 v16, v96, v97, v98
v_max3_f32 v16, v16, v99, v104
v_max3_f32 v16, v16, v105, v106
v_max3_f32 v16, v16, v107, v4
v_mov_b32 v17, v16
s_nop 1
v_permlane16_swap_b32 v16, v17
s_nop 1
v_max_f32 v16, v16, v17
v_mov_b32 v17, v16
s_nop 1
v_permlane32_swap_b32 v16, v17
s_nop 1
v_max_f32 v16, v16, v17
v_sub_f32 v12, v4, v16
v_exp_f32 v12, v12
v_mov_b32 v4, v16
v_mul_f32 v6, v6, v12
v_sub_f32 v96, v96, v16
v_sub_f32 v97, v97, v16
v_sub_f32 v98, v98, v16
v_sub_f32 v99, v99, v16
v_exp_f32 v96, v96
v_exp_f32 v97, v97
v_exp_f32 v98, v98
v_exp_f32 v99, v99
s_nop 0
v_add_f32 v6, v6, v96
v_add_f32 v6, v6, v97
v_add_f32 v6, v6, v98
v_add_f32 v6, v6, v99
v_sub_f32 v104, v104, v16
v_sub_f32 v105, v105, v16
v_sub_f32 v106, v106, v16
v_sub_f32 v107, v107, v16
v_exp_f32 v104, v104
v_exp_f32 v105, v105
v_exp_f32 v106, v106
v_exp_f32 v107, v107
s_nop 0
v_add_f32 v6, v6, v104
v_add_f32 v6, v6, v105
v_add_f32 v6, v6, v106
v_add_f32 v6, v6, v107
v_cvt_pk_bf16_f32 v112, v96, v97
v_cvt_pk_bf16_f32 v113, v98, v99
v_cvt_pk_bf16_f32 v114, v104, v105
v_cvt_pk_bf16_f32 v115, v106, v107
v_mul_f32 v128, v128, v12
v_mul_f32 v129, v129, v12
v_mul_f32 v130, v130, v12
v_mul_f32 v131, v131, v12
v_mul_f32 v144, v144, v12
v_mul_f32 v145, v145, v12
v_mul_f32 v146, v146, v12
v_mul_f32 v147, v147, v12
v_mul_f32 v160, v160, v12
v_mul_f32 v161, v161, v12
v_mul_f32 v162, v162, v12
v_mul_f32 v163, v163, v12
v_mul_f32 v176, v176, v12
v_mul_f32 v177, v177, v12
v_mul_f32 v178, v178, v12
v_mul_f32 v179, v179, v12
v_mul_f32 v192, v192, v12
v_mul_f32 v193, v193, v12
v_mul_f32 v194, v194, v12
v_mul_f32 v195, v195, v12
v_mul_f32 v208, v208, v12
v_mul_f32 v209, v209, v12
v_mul_f32 v210, v210, v12
v_mul_f32 v211, v211, v12
v_mul_f32 v224, v224, v12
v_mul_f32 v225, v225, v12
v_mul_f32 v226, v226, v12
v_mul_f32 v227, v227, v12
v_mul_f32 v240, v240, v12
v_mul_f32 v241, v241, v12
v_mul_f32 v242, v242, v12
v_mul_f32 v243, v243, v12
v_max3_f32 v16, v100, v101, v102
v_max3_f32 v16, v16, v103, v108
v_max3_f32 v16, v16, v109, v110
v_max3_f32 v16, v16, v111, v5
v_mov_b32 v17, v16
s_nop 1
v_permlane16_swap_b32 v16, v17
s_nop 1
v_max_f32 v16, v16, v17
v_mov_b32 v17, v16
s_nop 1
v_permlane32_swap_b32 v16, v17
s_nop 1
v_max_f32 v16, v16, v17
v_sub_f32 v14, v5, v16
v_exp_f32 v14, v14
v_mov_b32 v5, v16
v_mul_f32 v8, v8, v14
v_sub_f32 v100, v100, v16
v_sub_f32 v101, v101, v16
v_sub_f32 v102, v102, v16
v_sub_f32 v103, v103, v16
v_exp_f32 v100, v100
v_exp_f32 v101, v101
v_exp_f32 v102, v102
v_exp_f32 v103, v103
s_nop 0
v_add_f32 v8, v8, v100
v_add_f32 v8, v8, v101
v_add_f32 v8, v8, v102
v_add_f32 v8, v8, v103
v_sub_f32 v108, v108, v16
v_sub_f32 v109, v109, v16
v_sub_f32 v110, v110, v16
v_sub_f32 v111, v111, v16
v_exp_f32 v108, v108
v_exp_f32 v109, v109
v_exp_f32 v110, v110
v_exp_f32 v111, v111
s_nop 0
v_add_f32 v8, v8, v108
v_add_f32 v8, v8, v109
v_add_f32 v8, v8, v110
v_add_f32 v8, v8, v111
v_cvt_pk_bf16_f32 v116, v100, v101
v_cvt_pk_bf16_f32 v117, v102, v103
v_cvt_pk_bf16_f32 v118, v108, v109
v_cvt_pk_bf16_f32 v119, v110, v111
v_mul_f32 v132, v132, v14
v_mul_f32 v133, v133, v14
v_mul_f32 v134, v134, v14
v_mul_f32 v135, v135, v14
v_mul_f32 v148, v148, v14
v_mul_f32 v149, v149, v14
v_mul_f32 v150, v150, v14
v_mul_f32 v151, v151, v14
v_mul_f32 v164, v164, v14
v_mul_f32 v165, v165, v14
v_mul_f32 v166, v166, v14
v_mul_f32 v167, v167, v14
v_mul_f32 v180, v180, v14
v_mul_f32 v181, v181, v14
v_mul_f32 v182, v182, v14
v_mul_f32 v183, v183, v14
v_mul_f32 v196, v196, v14
v_mul_f32 v197, v197, v14
v_mul_f32 v198, v198, v14
v_mul_f32 v199, v199, v14
v_mul_f32 v212, v212, v14
v_mul_f32 v213, v213, v14
v_mul_f32 v214, v214, v14
v_mul_f32 v215, v215, v14
v_mul_f32 v228, v228, v14
v_mul_f32 v229, v229, v14
v_mul_f32 v230, v230, v14
v_mul_f32 v231, v231, v14
v_mul_f32 v244, v244, v14
v_mul_f32 v245, v245, v14
v_mul_f32 v246, v246, v14
v_mul_f32 v247, v247, v14
s_nop 1
v_mfma_f32_16x16x32_bf16 v[128:131], v[64:67], v[112:115], v[128:131]
v_mfma_f32_16x16x32_bf16 v[132:135], v[64:67], v[116:119], v[132:135]
v_mfma_f32_16x16x32_bf16 v[144:147], v[68:71], v[112:115], v[144:147]
v_mfma_f32_16x16x32_bf16 v[148:151], v[68:71], v[116:119], v[148:151]
v_mfma_f32_16x16x32_bf16 v[160:163], v[72:75], v[112:115], v[160:163]
v_mfma_f32_16x16x32_bf16 v[164:167], v[72:75], v[116:119], v[164:167]
v_mfma_f32_16x16x32_bf16 v[176:179], v[76:79], v[112:115], v[176:179]
v_mfma_f32_16x16x32_bf16 v[180:183], v[76:79], v[116:119], v[180:183]
v_mfma_f32_16x16x32_bf16 v[192:195], v[80:83], v[112:115], v[192:195]
v_mfma_f32_16x16x32_bf16 v[196:199], v[80:83], v[116:119], v[196:199]
v_mfma_f32_16x16x32_bf16 v[208:211], v[84:87], v[112:115], v[208:211]
v_mfma_f32_16x16x32_bf16 v[212:215], v[84:87], v[116:119], v[212:215]
v_mfma_f32_16x16x32_bf16 v[224:227], v[88:91], v[112:115], v[224:227]
v_mfma_f32_16x16x32_bf16 v[228:231], v[88:91], v[116:119], v[228:231]
v_mfma_f32_16x16x32_bf16 v[240:243], v[92:95], v[112:115], v[240:243]
v_mfma_f32_16x16x32_bf16 v[244:247], v[92:95], v[116:119], v[244:247]
s_add_u32 s14, s14, 8192
s_add_u32 s44, s44, 1
s_nop 7
s_cmp_le_u32 s44, s12
s_cbranch_scc1 L_su_KN
v_mov_b32 v17, v6
s_nop 1
v_permlane16_swap_b32 v6, v17
s_nop 1
v_add_f32 v6, v6, v17
v_mov_b32 v17, v6
s_nop 1
v_permlane32_swap_b32 v6, v17
s_nop 1
v_add_f32 v6, v6, v17
v_mov_b32 v17, v8
s_nop 1
v_permlane16_swap_b32 v8, v17
s_nop 1
v_add_f32 v8, v8, v17
v_mov_b32 v17, v8
s_nop 1
v_permlane32_swap_b32 v8, v17
s_nop 1
v_add_f32 v8, v8, v17
v_cmp_nlt_f32 vcc, v6, v15
v_rcp_f32 v6, v6
s_or_b64 s[14:15], s[14:15], vcc
v_cmp_nlt_f32 vcc, v8, v15
v_rcp_f32 v8, v8
s_or_b64 s[14:15], s[14:15], vcc
v_pk_mul_f32 v[128:129], v[128:129], v[6:7] op_sel_hi:[1,0]
v_pk_mul_f32 v[130:131], v[130:131], v[6:7] op_sel_hi:[1,0]
v_pk_mul_f32 v[144:145], v[144:145], v[6:7] op_sel_hi:[1,0]
v_pk_mul_f32 v[146:147], v[146:147], v[6:7] op_sel_hi:[1,0]
v_cvt_pk_bf16_f32 v128, v128, v129
v_cvt_pk_bf16_f32 v129, v130, v131
v_cvt_pk_bf16_f32 v130, v144, v145
v_cvt_pk_bf16_f32 v131, v146, v147
buffer_store_dwordx4 v[128:131], v21, s[36:39], s13 offen offset:0 sc1
v_pk_mul_f32 v[160:161], v[160:161], v[6:7] op_sel_hi:[1,0]
v_pk_mul_f32 v[162:163], v[162:163], v[6:7] op_sel_hi:[1,0]
v_pk_mul_f32 v[176:177], v[176:177], v[6:7] op_sel_hi:[1,0]
v_pk_mul_f32 v[178:179], v[178:179], v[6:7] op_sel_hi:[1,0]
v_cvt_pk_bf16_f32 v160, v160, v161
v_cvt_pk_bf16_f32 v161, v162, v163
v_cvt_pk_bf16_f32 v162, v176, v177
v_cvt_pk_bf16_f32 v163, v178, v179
buffer_store_dwordx4 v[160:163], v21, s[36:39], s13 offen offset:1024 sc1
v_pk_mul_f32 v[192:193], v[192:193], v[6:7] op_sel_hi:[1,0]
v_pk_mul_f32 v[194:195], v[194:195], v[6:7] op_sel_hi:[1,0]
v_pk_mul_f32 v[208:209], v[208:209], v[6:7] op_sel_hi:[1,0]
v_pk_mul_f32 v[210:211], v[210:211], v[6:7] op_sel_hi:[1,0]
v_cvt_pk_bf16_f32 v192, v192, v193
v_cvt_pk_bf16_f32 v193, v194, v195
v_cvt_pk_bf16_f32 v194, v208, v209
v_cvt_pk_bf16_f32 v195, v210, v211
buffer_store_dwordx4 v[192:195], v21, s[36:39], s13 offen offset:2048 sc1
v_pk_mul_f32 v[224:225], v[224:225], v[6:7] op_sel_hi:[1,0]
v_pk_mul_f32 v[226:227], v[226:227], v[6:7] op_sel_hi:[1,0]
v_pk_mul_f32 v[240:241], v[240:241], v[6:7] op_sel_hi:[1,0]
v_pk_mul_f32 v[242:243], v[242:243], v[6:7] op_sel_hi:[1,0]
v_cvt_pk_bf16_f32 v224, v224, v225
v_cvt_pk_bf16_f32 v225, v226, v227
v_cvt_pk_bf16_f32 v226, v240, v241
v_cvt_pk_bf16_f32 v227, v242, v243
buffer_store_dwordx4 v[224:227], v21, s[36:39], s13 offen offset:3072 sc1
s_add_u32 s18, s13, 131072
v_pk_mul_f32 v[132:133], v[132:133], v[8:9] op_sel_hi:[1,0]
v_pk_mul_f32 v[134:135], v[134:135], v[8:9] op_sel_hi:[1,0]
v_pk_mul_f32 v[148:149], v[148:149], v[8:9] op_sel_hi:[1,0]
v_pk_mul_f32 v[150:151], v[150:151], v[8:9] op_sel_hi:[1,0]
v_cvt_pk_bf16_f32 v132, v132, v133
v_cvt_pk_bf16_f32 v133, v134, v135
v_cvt_pk_bf16_f32 v134, v148, v149
v_cvt_pk_bf16_f32 v135, v150, v151
buffer_store_dwordx4 v[132:135], v21, s[36:39], s18 offen offset:0 sc1
v_pk_mul_f32 v[164:165], v[164:165], v[8:9] op_sel_hi:[1,0]
v_pk_mul_f32 v[166:167], v[166:167], v[8:9] op_sel_hi:[1,0]
v_pk_mul_f32 v[180:181], v[180:181], v[8:9] op_sel_hi:[1,0]
v_pk_mul_f32 v[182:183], v[182:183], v[8:9] op_sel_hi:[1,0]
v_cvt_pk_bf16_f32 v164, v164, v165
v_cvt_pk_bf16_f32 v165, v166, v167
v_cvt_pk_bf16_f32 v166, v180, v181
v_cvt_pk_bf16_f32 v167, v182, v183
buffer_store_dwordx4 v[164:167], v21, s[36:39], s18 offen offset:1024 sc1
v_pk_mul_f32 v[196:197], v[196:197], v[8:9] op_sel_hi:[1,0]
v_pk_mul_f32 v[198:199], v[198:199], v[8:9] op_sel_hi:[1,0]
v_pk_mul_f32 v[212:213], v[212:213], v[8:9] op_sel_hi:[1,0]
v_pk_mul_f32 v[214:215], v[214:215], v[8:9] op_sel_hi:[1,0]
v_cvt_pk_bf16_f32 v196, v196, v197
v_cvt_pk_bf16_f32 v197, v198, v199
v_cvt_pk_bf16_f32 v198, v212, v213
v_cvt_pk_bf16_f32 v199, v214, v215
buffer_store_dwordx4 v[196:199], v21, s[36:39], s18 offen offset:2048 sc1
v_pk_mul_f32 v[228:229], v[228:229], v[8:9] op_sel_hi:[1,0]
v_pk_mul_f32 v[230:231], v[230:231], v[8:9] op_sel_hi:[1,0]
v_pk_mul_f32 v[244:245], v[244:245], v[8:9] op_sel_hi:[1,0]
v_pk_mul_f32 v[246:247], v[246:247], v[8:9] op_sel_hi:[1,0]
v_cvt_pk_bf16_f32 v228, v228, v229
v_cvt_pk_bf16_f32 v229, v230, v231
v_cvt_pk_bf16_f32 v230, v244, v245
v_cvt_pk_bf16_f32 v231, v246, v247
buffer_store_dwordx4 v[228:231], v21, s[36:39], s18 offen offset:3072 sc1
s_waitcnt vmcnt(0)
s_setpc_b64 s[64:65]
L_last_KN:
.section .rodata,"a"
.p2align 6
.amdhsa_kernel gated_mix__compressed_kv_cla__moe_arch_mod__prompt_kernel
  .amdhsa_next_free_vgpr 512
  .amdhsa_next_free_sgpr 102
  .amdhsa_accum_offset 256
  .amdhsa_group_segment_fixed_size 0
  .amdhsa_kernarg_size 120
  .amdhsa_user_sgpr_count 2
  .amdhsa_user_sgpr_kernarg_segment_ptr 1
  .amdhsa_system_sgpr_workgroup_id_x 1
  .amdhsa_float_denorm_mode_32 3
.end_amdhsa_kernel
.text
```
